```python
import torch

def _softmax(x, axis=-1):
    return torch.softmax(x, dim=axis)
def _gelu(x):
    return torch.nn.functional.gelu(x, approximate="tanh")
def _silu(x):
    return torch.nn.functional.silu(x)
def _sigmoid(x):
    return torch.sigmoid(x)
def _layernorm(x, axis=-1, eps=1e-5):
    m = x.mean(dim=axis, keepdim=True)
    v = x.var(dim=axis, keepdim=True, unbiased=False)
    return (x - m) / torch.sqrt(v + eps)
def _scatter_add(tgt, idx, src, axis=0):
    return tgt.clone().index_add_(axis, idx, src)
def _segment_sum(src, seg, n):
    out = torch.zeros((n,) + src.shape[1:], dtype=src.dtype)
    return out.index_add_(0, seg, src)
def _pad(x, pw):
    flat = tuple(v for pair in reversed(pw) for v in pair)
    return torch.nn.functional.pad(x, flat)

kernel_name = 'sequential_preLN__mha_block__moe_arch_mod__prompt'

def setup_inputs():

    _w = (lambda a: (lambda t: t.to(torch.bfloat16) if t.is_floating_point() else t)(torch.as_tensor(a)))
    def _A_setup():
        B, S, D, H = 1, 2048, 640, 32
        return {
            "x": _w((lambda *s: torch.randn(*s, dtype=torch.bfloat16) * 0.05)(B, S, D)),
            "wqkv": _w((lambda *s: torch.randn(*s, dtype=torch.bfloat16) * 0.05)(D, 3 * D)),
            "wo": _w((lambda *s: torch.randn(*s, dtype=torch.bfloat16) * 0.05)(D, D)),
        }
    _A_in = _A_setup()

    def _B_setup():
        B, S, D, F, C = 1, 2048, 640, 1536, 2
        return {
            "x": _w((lambda *s: torch.randn(*s, dtype=torch.bfloat16) * 0.05)(B, S, D)),
            "w_r": _w((lambda *s: torch.randn(*s, dtype=torch.bfloat16) * 0.05)(D)),
            "w_gate": _w((lambda *s: torch.randn(*s, dtype=torch.bfloat16) * 0.05)(D, F)),
            "w_up": _w((lambda *s: torch.randn(*s, dtype=torch.bfloat16) * 0.05)(D, F)),
            "w_down": _w((lambda *s: torch.randn(*s, dtype=torch.bfloat16) * 0.05)(F, D)),
        }
    _B_in = _B_setup()

    return {
        "A_x": _A_in["x"],
        "A_wqkv": _A_in["wqkv"],
        "A_wo": _A_in["wo"],
        "B_x": _B_in["x"],
        "B_w_r": _B_in["w_r"],
        "B_w_gate": _B_in["w_gate"],
        "B_w_up": _B_in["w_up"],
        "B_w_down": _B_in["w_down"],
    }

def reference(A_x, A_wqkv, A_wo, B_x, B_w_r, B_w_gate, B_w_up, B_w_down):
    def _A_ref(x, wqkv, wo):
        B, S, D = x.shape
        H = 32
        Dh = D // H
        qkv = (lambda x, *d: x.permute(*d))((x @ wqkv).reshape(B, S, 3, H, Dh), 2, 0, 3, 1, 4)
        q, k, v = qkv[0], qkv[1], qkv[2]
        scores = torch.einsum("bhqd,bhkd->bhqk", q, k) * (Dh ** -0.5)
        p = _softmax(scores, axis=-1)
        o = torch.einsum("bhqk,bhkd->bhqd", p, v)
        return (lambda x, *d: x.permute(*d))(o, 0, 2, 1, 3).reshape(B, S, D) @ wo

    def _B_ref(x, w_r, w_gate, w_up, w_down):
        B, S, D = x.shape
        C = 2
        r = x @ w_r
        idx = torch.argsort(-r, axis=-1)[:, :C]
        idx_e = (lambda x, n, axis: torch.repeat_interleave(x, n, dim=axis))(idx.reshape(B, C, 1), D, axis=2)
        x_sel = (lambda x, i, axis: torch.take_along_dim(x, i, dim=axis))(x, idx_e, axis=1)
        g = _silu(x_sel @ w_gate)
        u = x_sel @ w_up
        y = (g * u) @ w_down
        r_sel = _sigmoid((lambda x, i, axis: torch.take_along_dim(x, i, dim=axis))(r, idx, axis=1))
        y = y * r_sel.reshape(B, C, 1)
        b_off = (torch.arange(B) * S).reshape(B, 1)
        flat_idx = (idx + b_off).reshape(B * C)
        zero = (x * 0.0).reshape(B * S, D)
        upd = _scatter_add(zero, flat_idx, y.reshape(B * C, D), axis=0)
        return x + upd.reshape(B, S, D)

    x = A_x
    h = x + _A_ref(_layernorm(x, axis=-1), A_wqkv, A_wo)
    h2 = h + _B_ref(_layernorm(h, axis=-1), B_w_r, B_w_gate, B_w_up, B_w_down)
    return h2
```

```asm
; @launch grid=(256,1,1) block=(256,1,1) lds=163840
.amdgcn_target "amdgcn-amd-amdhsa--gfx950"
.text
.globl sequential_preLN__mha_block__moe_arch_mod__prompt_kernel
.p2align 8
.type sequential_preLN__mha_block__moe_arch_mod__prompt_kernel,@function
sequential_preLN__mha_block__moe_arch_mod__prompt_kernel:
    s_load_dwordx2 s[4:5], s[0:1], 0
    s_load_dwordx2 s[8:9], s[0:1], 8
    s_load_dwordx2 s[12:13], s[0:1], 80
    s_load_dwordx2 s[16:17], s[0:1], 72
    s_cmp_ge_u32 s2, 256
    s_cbranch_scc1 sequential_preLN__mha_block__moe_arch_mod__prompt_kernel_done
    v_lshrrev_b32 v2, 6, v0
    v_and_b32 v1, 63, v0
    v_readfirstlane_b32 s40, v2
    v_mov_b32 v2, 0
    s_getpc_b64 s[20:21]
    s_mov_b32 s22, CODE_END-sequential_preLN__mha_block__moe_arch_mod__prompt_kernel-256
    s_mov_b32 s23, 0x20000
    s_bfe_u32 s44, s2, 0x40003
    s_lshl_b32 s44, s44, 12
    v_lshrrev_b32 v3, 3, v0
    v_lshl_add_u32 v3, v3, 7, s44
    buffer_load_dword v255, v3, s[20:23], 0 offen
    s_mov_b32 s6, 2621440
    s_mov_b32 s7, 0x20000
    s_mov_b32 s10, 2457600
    s_mov_b32 s11, 0x20000
    s_mov_b32 s14, 16777216
    s_mov_b32 s15, 0x20000
    s_mov_b32 s18, 256
    s_mov_b32 s19, 0x20000
    s_lshr_b32 s44, s2, 3
    s_and_b32 s48, s2, 3
    s_lshl_b32 s48, s48, 2
    s_and_b32 s45, s44, 3
    s_add_u32 s48, s48, s45
    s_and_b32 s49, s2, 4
    s_lshl_b32 s49, s49, 1
    s_lshr_b32 s45, s44, 2
    s_add_u32 s49, s49, s45
    s_lshl_b32 s44, s48, 7
    s_lshl_b32 s45, s40, 5
    s_add_u32 s58, s44, s45
    s_mul_i32 s44, s58, 1280
    s_cmp_ge_u32 s49, 15
    s_cbranch_scc1 sequential_preLN__mha_block__moe_arch_mod__prompt_kernel_S
    v_lshrrev_b32 v3, 3, v1
    v_mul_u32_u24 v3, 1280, v3
    v_add_u32 v3, s44, v3
    v_lshrrev_b32 v4, 4, v1
    v_and_b32 v5, 7, v1
    v_xor_b32 v5, v5, v4
    v_lshlrev_b32 v5, 4, v5
    v_add_u32 v10, v3, v5
    v_xor_b32 v5, 64, v5
    v_add_u32 v11, v3, v5
    v_add_u32 v11, 9216, v11
    v_add_u32 v12, 18432, v10
    v_add_u32 v13, 18432, v11
    s_mul_i32 s44, s40, 61440
    s_lshl_b32 s45, s49, 8
    s_add_u32 s44, s44, s45
    v_mul_u32_u24 v3, 3840, v4
    v_add_u32 v3, s44, v3
    v_bfe_u32 v5, v1, 2, 2
    v_xor_b32 v5, v5, v4
    v_lshlrev_b32 v5, 6, v5
    v_and_b32 v6, 3, v1
    v_lshl_add_u32 v5, v6, 4, v5
    v_add_u32 v14, v3, v5
    v_add_u32 v15, 14336, v14
    v_add_u32 v16, 28672, v14
    v_add_u32 v17, 43008, v14
    s_lshl_b32 s52, s40, 12
    s_waitcnt lgkmcnt(0)
    s_add_u32 m0, s52, 0
    s_movk_i32 s53, 0
    buffer_load_dwordx4 v10, s[4:7], s53 offen offset:0 lds
    buffer_load_dwordx4 v11, s[4:7], s53 offen offset:1024 lds
    buffer_load_dwordx4 v12, s[4:7], s53 offen offset:2048 lds
    buffer_load_dwordx4 v13, s[4:7], s53 offen offset:3072 lds
    s_add_u32 m0, s52, 16384
    s_mov_b32 s54, 0
    buffer_load_dwordx4 v14, s[8:11], s54 offen offset:0 lds
    buffer_load_dwordx4 v15, s[8:11], s54 offen offset:1024 lds
    buffer_load_dwordx4 v16, s[8:11], s54 offen offset:2048 lds
    buffer_load_dwordx4 v17, s[8:11], s54 offen offset:3072 lds
    s_lshr_b32 s44, s2, 3
    s_lshl_b32 s44, s44, 2
    s_add_u32 s44, s44, s40
    s_lshr_b32 s45, s44, 1
    s_mul_i32 s45, s45, 3840
    s_and_b32 s46, s44, 1
    s_lshl_b32 s46, s46, 10
    s_add_u32 s45, s45, s46
    s_and_b32 s46, s2, 4
    s_lshl_b32 s55, s46, 9
    s_add_u32 s45, s45, s55
    s_mul_i32 s55, s46, 640
    s_and_b32 s46, s2, 3
    s_lshl_b32 s46, s46, 7
    s_add_u32 s44, s44, s46
    s_mul_i32 s44, s44, 5120
    s_add_u32 s44, s44, s55
    s_lshl_b32 s46, s46, 1
    s_add_u32 s45, s45, s46
    s_mov_b32 s46, 245760
    v_and_b32 v67, 1, v1
    v_lshrrev_b32 v66, 1, v1
    v_mul_u32_u24 v65, 1280, v67
    v_lshl_add_u32 v65, v66, 7, v65
    v_add_u32 v65, s44, v65
    v_mul_u32_u24 v66, s46, v66
    v_lshl_add_u32 v66, v67, 7, v66
    v_add_u32 v66, s45, v66
    s_bfm_b64 exec, 18, 2
    buffer_load_dword v67, v66, s[8:11], 0 offen
    buffer_load_dword v67, v65, s[4:7], 0 offen
    s_mov_b64 exec, -1
    s_add_u32 m0, s52, 32768
    s_movk_i32 s53, 128
    buffer_load_dwordx4 v10, s[4:7], s53 offen offset:0 lds
    buffer_load_dwordx4 v11, s[4:7], s53 offen offset:1024 lds
    buffer_load_dwordx4 v12, s[4:7], s53 offen offset:2048 lds
    buffer_load_dwordx4 v13, s[4:7], s53 offen offset:3072 lds
    s_and_b32 s50, s40, 1
    s_lshr_b32 s51, s40, 1
    v_and_b32 v7, 31, v1
    v_lshrrev_b32 v9, 5, v1
    v_lshrrev_b32 v3, 1, v7
    v_xor_b32 v3, v3, v7
    v_and_b32 v3, 4, v3
    v_mul_u32_u24 v4, 3, v3
    v_xor_b32 v8, v4, v7
    v_bfe_u32 v3, v1, 3, 1
    v_xor_b32 v3, v3, v9
    v_bfe_u32 v4, v1, 1, 1
    v_or_b32 v3, v3, v4
    v_bfe_u32 v4, v1, 2, 1
    v_lshl_or_b32 v3, v3, 1, v4
    v_mov_b32 v4, 0x3f803f80
    v_cmp_eq_u32 vcc, 0, v3
    v_and_b32 v5, 1, v1
    v_mul_u32_u24 v5, 0xaaaa, v5
    v_cndmask_b32 v36, v2, v4, vcc
    v_cndmask_b32 v37, v2, v4, vcc
    v_cmp_eq_u32 vcc, 1, v3
    v_add_u32 v40, 0x4444, v5
    v_mov_b32 v52, 0
    v_cndmask_b32 v38, v2, v4, vcc
    v_cndmask_b32 v39, v2, v4, vcc
    v_mov_b32 v53, 0
    v_mov_b32 v54, 0
    v_mov_b32 v55, 0
    s_cmp_ge_u32 s49, 10
    s_cbranch_scc1 sequential_preLN__mha_block__moe_arch_mod__prompt_kernel_V
    s_branch sequential_preLN__mha_block__moe_arch_mod__prompt_kernel_Q
sequential_preLN__mha_block__moe_arch_mod__prompt_kernel_S:
    v_lshrrev_b32 v4, 4, v1
    v_and_b32 v5, 15, v1
    v_mul_u32_u24 v3, 1280, v4
    v_lshl_add_u32 v3, v5, 4, v3
    s_memrealtime s[60:61]
    s_waitcnt lgkmcnt(0)
    s_cmp_lg_u32 s58, 0
    s_cbranch_scc1 A_nononce_1
    s_lshl_b32 s53, s60, 5
    s_or_b32 s53, s53, 1
    v_mov_b32 v41, s53
    s_mov_b64 exec, 1
    buffer_store_dword v41, v2, s[16:19], 0 offen sc1
    s_mov_b64 exec, -1
A_nononce_1:
    s_mov_b32 s54, s44
    buffer_load_dwordx4 v[68:71], v3, s[4:7], s54 offen offset:0
    buffer_load_dwordx4 v[72:75], v3, s[4:7], s54 offen offset:256
    buffer_load_dwordx4 v[76:79], v3, s[4:7], s54 offen offset:512
    buffer_load_dwordx4 v[80:83], v3, s[4:7], s54 offen offset:768
    buffer_load_dwordx4 v[84:87], v3, s[4:7], s54 offen offset:1024
    s_add_u32 s54, s54, 5120
    buffer_load_dwordx4 v[88:91], v3, s[4:7], s54 offen offset:0
    buffer_load_dwordx4 v[92:95], v3, s[4:7], s54 offen offset:256
    buffer_load_dwordx4 v[96:99], v3, s[4:7], s54 offen offset:512
    buffer_load_dwordx4 v[100:103], v3, s[4:7], s54 offen offset:768
    buffer_load_dwordx4 v[104:107], v3, s[4:7], s54 offen offset:1024
    s_add_u32 s54, s54, 5120
    s_lshr_b32 s44, s2, 3
    s_lshl_b32 s44, s44, 2
    s_add_u32 s44, s44, s40
    s_lshr_b32 s45, s44, 1
    s_mul_i32 s45, s45, 3840
    s_and_b32 s46, s44, 1
    s_lshl_b32 s46, s46, 10
    s_add_u32 s45, s45, s46
    s_and_b32 s46, s2, 4
    s_lshl_b32 s55, s46, 9
    s_add_u32 s45, s45, s55
    s_mul_i32 s55, s46, 640
    s_and_b32 s46, s2, 3
    s_lshl_b32 s46, s46, 7
    s_add_u32 s44, s44, s46
    s_mul_i32 s44, s44, 5120
    s_add_u32 s44, s44, s55
    s_lshl_b32 s46, s46, 1
    s_add_u32 s45, s45, s46
    s_mov_b32 s46, 245760
    v_and_b32 v67, 1, v1
    v_lshrrev_b32 v66, 1, v1
    v_mul_u32_u24 v65, 1280, v67
    v_lshl_add_u32 v65, v66, 7, v65
    v_add_u32 v65, s44, v65
    v_mul_u32_u24 v66, s46, v66
    v_lshl_add_u32 v66, v67, 7, v66
    v_add_u32 v66, s45, v66
    s_bfm_b64 exec, 18, 2
    buffer_load_dword v67, v66, s[8:11], 0 offen
    s_mov_b64 exec, -1
    buffer_load_dwordx4 v[108:111], v3, s[4:7], s54 offen offset:0
    buffer_load_dwordx4 v[112:115], v3, s[4:7], s54 offen offset:256
    buffer_load_dwordx4 v[116:119], v3, s[4:7], s54 offen offset:512
    buffer_load_dwordx4 v[120:123], v3, s[4:7], s54 offen offset:768
    buffer_load_dwordx4 v[124:127], v3, s[4:7], s54 offen offset:1024
    s_add_u32 s54, s54, 5120
    buffer_load_dwordx4 v[128:131], v3, s[4:7], s54 offen offset:0
    buffer_load_dwordx4 v[132:135], v3, s[4:7], s54 offen offset:256
    buffer_load_dwordx4 v[136:139], v3, s[4:7], s54 offen offset:512
    buffer_load_dwordx4 v[140:143], v3, s[4:7], s54 offen offset:768
    buffer_load_dwordx4 v[144:147], v3, s[4:7], s54 offen offset:1024
    s_add_u32 s54, s54, 5120
    buffer_load_dwordx4 v[148:151], v3, s[4:7], s54 offen offset:0
    buffer_load_dwordx4 v[152:155], v3, s[4:7], s54 offen offset:256
    buffer_load_dwordx4 v[156:159], v3, s[4:7], s54 offen offset:512
    buffer_load_dwordx4 v[160:163], v3, s[4:7], s54 offen offset:768
    buffer_load_dwordx4 v[164:167], v3, s[4:7], s54 offen offset:1024
    s_add_u32 s54, s54, 5120
    buffer_load_dwordx4 v[168:171], v3, s[4:7], s54 offen offset:0
    buffer_load_dwordx4 v[172:175], v3, s[4:7], s54 offen offset:256
    buffer_load_dwordx4 v[176:179], v3, s[4:7], s54 offen offset:512
    buffer_load_dwordx4 v[180:183], v3, s[4:7], s54 offen offset:768
    buffer_load_dwordx4 v[184:187], v3, s[4:7], s54 offen offset:1024
    s_add_u32 s54, s54, 5120
    buffer_load_dwordx4 v[188:191], v3, s[4:7], s54 offen offset:0
    buffer_load_dwordx4 v[192:195], v3, s[4:7], s54 offen offset:256
    buffer_load_dwordx4 v[196:199], v3, s[4:7], s54 offen offset:512
    buffer_load_dwordx4 v[200:203], v3, s[4:7], s54 offen offset:768
    buffer_load_dwordx4 v[204:207], v3, s[4:7], s54 offen offset:1024
    s_add_u32 s54, s54, 5120
    buffer_load_dwordx4 v[208:211], v3, s[4:7], s54 offen offset:0
    buffer_load_dwordx4 v[212:215], v3, s[4:7], s54 offen offset:256
    buffer_load_dwordx4 v[216:219], v3, s[4:7], s54 offen offset:512
    buffer_load_dwordx4 v[220:223], v3, s[4:7], s54 offen offset:768
    buffer_load_dwordx4 v[224:227], v3, s[4:7], s54 offen offset:1024
    s_add_u32 s54, s54, 5120
    s_mul_i32 s46, s2, 12288
    s_mul_i32 s45, s40, 3072
    s_add_u32 s46, s46, s45
    s_add_u32 s46, s46, 8912896
    v_lshl_add_u32 v64, v1, 4, s46
    v_mov_b32 v60, -1
    v_mov_b32 v61, -1
    v_mov_b32 v62, -1
    v_mov_b32 v63, -1
    s_mov_b32 s45, 0x3f803f80
    v_mov_b32 v10, 0
    v_mov_b32 v11, 0
    v_mov_b32 v12, 0
    v_mov_b32 v13, 0
    v_mov_b32 v14, 0
    v_mov_b32 v15, 0
    v_mov_b32 v16, 0
    v_mov_b32 v17, 0
    v_mov_b32 v18, 0
    v_mov_b32 v19, 0
    v_mov_b32 v20, 0
    v_mov_b32 v21, 0
    v_mov_b32 v22, 0
    v_mov_b32 v23, 0
    v_mov_b32 v24, 0
    v_mov_b32 v25, 0
    s_waitcnt vmcnt(30)
    v_dot2_f32_bf16 v10, v68, s45, v10
    v_dot2_f32_bf16 v11, v68, v68, v11
    v_dot2_f32_bf16 v12, v88, s45, v12
    v_dot2_f32_bf16 v13, v88, v88, v13
    v_dot2_f32_bf16 v10, v69, s45, v10
    v_dot2_f32_bf16 v11, v69, v69, v11
    v_dot2_f32_bf16 v12, v89, s45, v12
    v_dot2_f32_bf16 v13, v89, v89, v13
    v_dot2_f32_bf16 v10, v70, s45, v10
    v_dot2_f32_bf16 v11, v70, v70, v11
    v_dot2_f32_bf16 v12, v90, s45, v12
    v_dot2_f32_bf16 v13, v90, v90, v13
    v_dot2_f32_bf16 v10, v71, s45, v10
    v_dot2_f32_bf16 v11, v71, v71, v11
    v_dot2_f32_bf16 v12, v91, s45, v12
    v_dot2_f32_bf16 v13, v91, v91, v13
    v_dot2_f32_bf16 v10, v72, s45, v10
    v_dot2_f32_bf16 v11, v72, v72, v11
    v_dot2_f32_bf16 v12, v92, s45, v12
    v_dot2_f32_bf16 v13, v92, v92, v13
    v_dot2_f32_bf16 v10, v73, s45, v10
    v_dot2_f32_bf16 v11, v73, v73, v11
    v_dot2_f32_bf16 v12, v93, s45, v12
    v_dot2_f32_bf16 v13, v93, v93, v13
    v_dot2_f32_bf16 v10, v74, s45, v10
    v_dot2_f32_bf16 v11, v74, v74, v11
    v_dot2_f32_bf16 v12, v94, s45, v12
    v_dot2_f32_bf16 v13, v94, v94, v13
    v_dot2_f32_bf16 v10, v75, s45, v10
    v_dot2_f32_bf16 v11, v75, v75, v11
    v_dot2_f32_bf16 v12, v95, s45, v12
    v_dot2_f32_bf16 v13, v95, v95, v13
    v_dot2_f32_bf16 v10, v76, s45, v10
    v_dot2_f32_bf16 v11, v76, v76, v11
    v_dot2_f32_bf16 v12, v96, s45, v12
    v_dot2_f32_bf16 v13, v96, v96, v13
    v_dot2_f32_bf16 v10, v77, s45, v10
    v_dot2_f32_bf16 v11, v77, v77, v11
    v_dot2_f32_bf16 v12, v97, s45, v12
    v_dot2_f32_bf16 v13, v97, v97, v13
    v_dot2_f32_bf16 v10, v78, s45, v10
    v_dot2_f32_bf16 v11, v78, v78, v11
    v_dot2_f32_bf16 v12, v98, s45, v12
    v_dot2_f32_bf16 v13, v98, v98, v13
    v_dot2_f32_bf16 v10, v79, s45, v10
    v_dot2_f32_bf16 v11, v79, v79, v11
    v_dot2_f32_bf16 v12, v99, s45, v12
    v_dot2_f32_bf16 v13, v99, v99, v13
    v_dot2_f32_bf16 v10, v80, s45, v10
    v_dot2_f32_bf16 v11, v80, v80, v11
    v_dot2_f32_bf16 v12, v100, s45, v12
    v_dot2_f32_bf16 v13, v100, v100, v13
    v_dot2_f32_bf16 v10, v81, s45, v10
    v_dot2_f32_bf16 v11, v81, v81, v11
    v_dot2_f32_bf16 v12, v101, s45, v12
    v_dot2_f32_bf16 v13, v101, v101, v13
    v_dot2_f32_bf16 v10, v82, s45, v10
    v_dot2_f32_bf16 v11, v82, v82, v11
    v_dot2_f32_bf16 v12, v102, s45, v12
    v_dot2_f32_bf16 v13, v102, v102, v13
    v_dot2_f32_bf16 v10, v83, s45, v10
    v_dot2_f32_bf16 v11, v83, v83, v11
    v_dot2_f32_bf16 v12, v103, s45, v12
    v_dot2_f32_bf16 v13, v103, v103, v13
    v_dot2_f32_bf16 v10, v84, s45, v10
    v_dot2_f32_bf16 v11, v84, v84, v11
    v_dot2_f32_bf16 v12, v104, s45, v12
    v_dot2_f32_bf16 v13, v104, v104, v13
    v_dot2_f32_bf16 v10, v85, s45, v10
    v_dot2_f32_bf16 v11, v85, v85, v11
    v_dot2_f32_bf16 v12, v105, s45, v12
    v_dot2_f32_bf16 v13, v105, v105, v13
    v_dot2_f32_bf16 v10, v86, s45, v10
    v_dot2_f32_bf16 v11, v86, v86, v11
    v_dot2_f32_bf16 v12, v106, s45, v12
    v_dot2_f32_bf16 v13, v106, v106, v13
    v_dot2_f32_bf16 v10, v87, s45, v10
    v_dot2_f32_bf16 v11, v87, v87, v11
    v_dot2_f32_bf16 v12, v107, s45, v12
    v_dot2_f32_bf16 v13, v107, v107, v13
    s_waitcnt vmcnt(20)
    v_dot2_f32_bf16 v14, v108, s45, v14
    v_dot2_f32_bf16 v15, v108, v108, v15
    v_dot2_f32_bf16 v16, v128, s45, v16
    v_dot2_f32_bf16 v17, v128, v128, v17
    v_dot2_f32_bf16 v14, v109, s45, v14
    v_dot2_f32_bf16 v15, v109, v109, v15
    v_dot2_f32_bf16 v16, v129, s45, v16
    v_dot2_f32_bf16 v17, v129, v129, v17
    v_dot2_f32_bf16 v14, v110, s45, v14
    v_dot2_f32_bf16 v15, v110, v110, v15
    v_dot2_f32_bf16 v16, v130, s45, v16
    v_dot2_f32_bf16 v17, v130, v130, v17
    v_dot2_f32_bf16 v14, v111, s45, v14
    v_dot2_f32_bf16 v15, v111, v111, v15
    v_dot2_f32_bf16 v16, v131, s45, v16
    v_dot2_f32_bf16 v17, v131, v131, v17
    v_dot2_f32_bf16 v14, v112, s45, v14
    v_dot2_f32_bf16 v15, v112, v112, v15
    v_dot2_f32_bf16 v16, v132, s45, v16
    v_dot2_f32_bf16 v17, v132, v132, v17
    v_dot2_f32_bf16 v14, v113, s45, v14
    v_dot2_f32_bf16 v15, v113, v113, v15
    v_dot2_f32_bf16 v16, v133, s45, v16
    v_dot2_f32_bf16 v17, v133, v133, v17
    v_dot2_f32_bf16 v14, v114, s45, v14
    v_dot2_f32_bf16 v15, v114, v114, v15
    v_dot2_f32_bf16 v16, v134, s45, v16
    v_dot2_f32_bf16 v17, v134, v134, v17
    v_dot2_f32_bf16 v14, v115, s45, v14
    v_dot2_f32_bf16 v15, v115, v115, v15
    v_dot2_f32_bf16 v16, v135, s45, v16
    v_dot2_f32_bf16 v17, v135, v135, v17
    v_dot2_f32_bf16 v14, v116, s45, v14
    v_dot2_f32_bf16 v15, v116, v116, v15
    v_dot2_f32_bf16 v16, v136, s45, v16
    v_dot2_f32_bf16 v17, v136, v136, v17
    v_dot2_f32_bf16 v14, v117, s45, v14
    v_dot2_f32_bf16 v15, v117, v117, v15
    v_dot2_f32_bf16 v16, v137, s45, v16
    v_dot2_f32_bf16 v17, v137, v137, v17
    v_dot2_f32_bf16 v14, v118, s45, v14
    v_dot2_f32_bf16 v15, v118, v118, v15
    v_dot2_f32_bf16 v16, v138, s45, v16
    v_dot2_f32_bf16 v17, v138, v138, v17
    v_dot2_f32_bf16 v14, v119, s45, v14
    v_dot2_f32_bf16 v15, v119, v119, v15
    v_dot2_f32_bf16 v16, v139, s45, v16
    v_dot2_f32_bf16 v17, v139, v139, v17
    v_dot2_f32_bf16 v14, v120, s45, v14
    v_dot2_f32_bf16 v15, v120, v120, v15
    v_dot2_f32_bf16 v16, v140, s45, v16
    v_dot2_f32_bf16 v17, v140, v140, v17
    v_dot2_f32_bf16 v14, v121, s45, v14
    v_dot2_f32_bf16 v15, v121, v121, v15
    v_dot2_f32_bf16 v16, v141, s45, v16
    v_dot2_f32_bf16 v17, v141, v141, v17
    v_dot2_f32_bf16 v14, v122, s45, v14
    v_dot2_f32_bf16 v15, v122, v122, v15
    v_dot2_f32_bf16 v16, v142, s45, v16
    v_dot2_f32_bf16 v17, v142, v142, v17
    v_dot2_f32_bf16 v14, v123, s45, v14
    v_dot2_f32_bf16 v15, v123, v123, v15
    v_dot2_f32_bf16 v16, v143, s45, v16
    v_dot2_f32_bf16 v17, v143, v143, v17
    v_dot2_f32_bf16 v14, v124, s45, v14
    v_dot2_f32_bf16 v15, v124, v124, v15
    v_dot2_f32_bf16 v16, v144, s45, v16
    v_dot2_f32_bf16 v17, v144, v144, v17
    v_dot2_f32_bf16 v14, v125, s45, v14
    v_dot2_f32_bf16 v15, v125, v125, v15
    v_dot2_f32_bf16 v16, v145, s45, v16
    v_dot2_f32_bf16 v17, v145, v145, v17
    v_dot2_f32_bf16 v14, v126, s45, v14
    v_dot2_f32_bf16 v15, v126, v126, v15
    v_dot2_f32_bf16 v16, v146, s45, v16
    v_dot2_f32_bf16 v17, v146, v146, v17
    v_dot2_f32_bf16 v14, v127, s45, v14
    v_dot2_f32_bf16 v15, v127, v127, v15
    v_dot2_f32_bf16 v16, v147, s45, v16
    v_dot2_f32_bf16 v17, v147, v147, v17
    s_waitcnt vmcnt(10)
    v_dot2_f32_bf16 v18, v148, s45, v18
    v_dot2_f32_bf16 v19, v148, v148, v19
    v_dot2_f32_bf16 v20, v168, s45, v20
    v_dot2_f32_bf16 v21, v168, v168, v21
    v_dot2_f32_bf16 v18, v149, s45, v18
    v_dot2_f32_bf16 v19, v149, v149, v19
    v_dot2_f32_bf16 v20, v169, s45, v20
    v_dot2_f32_bf16 v21, v169, v169, v21
    v_dot2_f32_bf16 v18, v150, s45, v18
    v_dot2_f32_bf16 v19, v150, v150, v19
    v_dot2_f32_bf16 v20, v170, s45, v20
    v_dot2_f32_bf16 v21, v170, v170, v21
    v_dot2_f32_bf16 v18, v151, s45, v18
    v_dot2_f32_bf16 v19, v151, v151, v19
    v_dot2_f32_bf16 v20, v171, s45, v20
    v_dot2_f32_bf16 v21, v171, v171, v21
    v_dot2_f32_bf16 v18, v152, s45, v18
    v_dot2_f32_bf16 v19, v152, v152, v19
    v_dot2_f32_bf16 v20, v172, s45, v20
    v_dot2_f32_bf16 v21, v172, v172, v21
    v_dot2_f32_bf16 v18, v153, s45, v18
    v_dot2_f32_bf16 v19, v153, v153, v19
    v_dot2_f32_bf16 v20, v173, s45, v20
    v_dot2_f32_bf16 v21, v173, v173, v21
    v_dot2_f32_bf16 v18, v154, s45, v18
    v_dot2_f32_bf16 v19, v154, v154, v19
    v_dot2_f32_bf16 v20, v174, s45, v20
    v_dot2_f32_bf16 v21, v174, v174, v21
    v_dot2_f32_bf16 v18, v155, s45, v18
    v_dot2_f32_bf16 v19, v155, v155, v19
    v_dot2_f32_bf16 v20, v175, s45, v20
    v_dot2_f32_bf16 v21, v175, v175, v21
    v_dot2_f32_bf16 v18, v156, s45, v18
    v_dot2_f32_bf16 v19, v156, v156, v19
    v_dot2_f32_bf16 v20, v176, s45, v20
    v_dot2_f32_bf16 v21, v176, v176, v21
    v_dot2_f32_bf16 v18, v157, s45, v18
    v_dot2_f32_bf16 v19, v157, v157, v19
    v_dot2_f32_bf16 v20, v177, s45, v20
    v_dot2_f32_bf16 v21, v177, v177, v21
    v_dot2_f32_bf16 v18, v158, s45, v18
    v_dot2_f32_bf16 v19, v158, v158, v19
    v_dot2_f32_bf16 v20, v178, s45, v20
    v_dot2_f32_bf16 v21, v178, v178, v21
    v_dot2_f32_bf16 v18, v159, s45, v18
    v_dot2_f32_bf16 v19, v159, v159, v19
    v_dot2_f32_bf16 v20, v179, s45, v20
    v_dot2_f32_bf16 v21, v179, v179, v21
    v_dot2_f32_bf16 v18, v160, s45, v18
    v_dot2_f32_bf16 v19, v160, v160, v19
    v_dot2_f32_bf16 v20, v180, s45, v20
    v_dot2_f32_bf16 v21, v180, v180, v21
    v_dot2_f32_bf16 v18, v161, s45, v18
    v_dot2_f32_bf16 v19, v161, v161, v19
    v_dot2_f32_bf16 v20, v181, s45, v20
    v_dot2_f32_bf16 v21, v181, v181, v21
    v_dot2_f32_bf16 v18, v162, s45, v18
    v_dot2_f32_bf16 v19, v162, v162, v19
    v_dot2_f32_bf16 v20, v182, s45, v20
    v_dot2_f32_bf16 v21, v182, v182, v21
    v_dot2_f32_bf16 v18, v163, s45, v18
    v_dot2_f32_bf16 v19, v163, v163, v19
    v_dot2_f32_bf16 v20, v183, s45, v20
    v_dot2_f32_bf16 v21, v183, v183, v21
    v_dot2_f32_bf16 v18, v164, s45, v18
    v_dot2_f32_bf16 v19, v164, v164, v19
    v_dot2_f32_bf16 v20, v184, s45, v20
    v_dot2_f32_bf16 v21, v184, v184, v21
    v_dot2_f32_bf16 v18, v165, s45, v18
    v_dot2_f32_bf16 v19, v165, v165, v19
    v_dot2_f32_bf16 v20, v185, s45, v20
    v_dot2_f32_bf16 v21, v185, v185, v21
    v_dot2_f32_bf16 v18, v166, s45, v18
    v_dot2_f32_bf16 v19, v166, v166, v19
    v_dot2_f32_bf16 v20, v186, s45, v20
    v_dot2_f32_bf16 v21, v186, v186, v21
    v_dot2_f32_bf16 v18, v167, s45, v18
    v_dot2_f32_bf16 v19, v167, v167, v19
    v_dot2_f32_bf16 v20, v187, s45, v20
    v_dot2_f32_bf16 v21, v187, v187, v21
    s_waitcnt vmcnt(0)
    buffer_load_dword v41, v2, s[16:19], 0 offen sc1
    v_dot2_f32_bf16 v22, v188, s45, v22
    v_dot2_f32_bf16 v23, v188, v188, v23
    v_dot2_f32_bf16 v24, v208, s45, v24
    v_dot2_f32_bf16 v25, v208, v208, v25
    v_dot2_f32_bf16 v22, v189, s45, v22
    v_dot2_f32_bf16 v23, v189, v189, v23
    v_dot2_f32_bf16 v24, v209, s45, v24
    v_dot2_f32_bf16 v25, v209, v209, v25
    v_dot2_f32_bf16 v22, v190, s45, v22
    v_dot2_f32_bf16 v23, v190, v190, v23
    v_dot2_f32_bf16 v24, v210, s45, v24
    v_dot2_f32_bf16 v25, v210, v210, v25
    v_dot2_f32_bf16 v22, v191, s45, v22
    v_dot2_f32_bf16 v23, v191, v191, v23
    v_dot2_f32_bf16 v24, v211, s45, v24
    v_dot2_f32_bf16 v25, v211, v211, v25
    v_dot2_f32_bf16 v22, v192, s45, v22
    v_dot2_f32_bf16 v23, v192, v192, v23
    v_dot2_f32_bf16 v24, v212, s45, v24
    v_dot2_f32_bf16 v25, v212, v212, v25
    v_dot2_f32_bf16 v22, v193, s45, v22
    v_dot2_f32_bf16 v23, v193, v193, v23
    v_dot2_f32_bf16 v24, v213, s45, v24
    v_dot2_f32_bf16 v25, v213, v213, v25
    v_dot2_f32_bf16 v22, v194, s45, v22
    v_dot2_f32_bf16 v23, v194, v194, v23
    v_dot2_f32_bf16 v24, v214, s45, v24
    v_dot2_f32_bf16 v25, v214, v214, v25
    v_dot2_f32_bf16 v22, v195, s45, v22
    v_dot2_f32_bf16 v23, v195, v195, v23
    v_dot2_f32_bf16 v24, v215, s45, v24
    v_dot2_f32_bf16 v25, v215, v215, v25
    v_dot2_f32_bf16 v22, v196, s45, v22
    v_dot2_f32_bf16 v23, v196, v196, v23
    v_dot2_f32_bf16 v24, v216, s45, v24
    v_dot2_f32_bf16 v25, v216, v216, v25
    v_dot2_f32_bf16 v22, v197, s45, v22
    v_dot2_f32_bf16 v23, v197, v197, v23
    v_dot2_f32_bf16 v24, v217, s45, v24
    v_dot2_f32_bf16 v25, v217, v217, v25
    v_dot2_f32_bf16 v22, v198, s45, v22
    v_dot2_f32_bf16 v23, v198, v198, v23
    v_dot2_f32_bf16 v24, v218, s45, v24
    v_dot2_f32_bf16 v25, v218, v218, v25
    v_dot2_f32_bf16 v22, v199, s45, v22
    v_dot2_f32_bf16 v23, v199, v199, v23
    v_dot2_f32_bf16 v24, v219, s45, v24
    v_dot2_f32_bf16 v25, v219, v219, v25
    v_dot2_f32_bf16 v22, v200, s45, v22
    v_dot2_f32_bf16 v23, v200, v200, v23
    v_dot2_f32_bf16 v24, v220, s45, v24
    v_dot2_f32_bf16 v25, v220, v220, v25
    v_dot2_f32_bf16 v22, v201, s45, v22
    v_dot2_f32_bf16 v23, v201, v201, v23
    v_dot2_f32_bf16 v24, v221, s45, v24
    v_dot2_f32_bf16 v25, v221, v221, v25
    v_dot2_f32_bf16 v22, v202, s45, v22
    v_dot2_f32_bf16 v23, v202, v202, v23
    v_dot2_f32_bf16 v24, v222, s45, v24
    v_dot2_f32_bf16 v25, v222, v222, v25
    v_dot2_f32_bf16 v22, v203, s45, v22
    v_dot2_f32_bf16 v23, v203, v203, v23
    v_dot2_f32_bf16 v24, v223, s45, v24
    v_dot2_f32_bf16 v25, v223, v223, v25
    v_dot2_f32_bf16 v22, v204, s45, v22
    v_dot2_f32_bf16 v23, v204, v204, v23
    v_dot2_f32_bf16 v24, v224, s45, v24
    v_dot2_f32_bf16 v25, v224, v224, v25
    v_dot2_f32_bf16 v22, v205, s45, v22
    v_dot2_f32_bf16 v23, v205, v205, v23
    v_dot2_f32_bf16 v24, v225, s45, v24
    v_dot2_f32_bf16 v25, v225, v225, v25
    v_dot2_f32_bf16 v22, v206, s45, v22
    v_dot2_f32_bf16 v23, v206, v206, v23
    v_dot2_f32_bf16 v24, v226, s45, v24
    v_dot2_f32_bf16 v25, v226, v226, v25
    v_dot2_f32_bf16 v22, v207, s45, v22
    v_dot2_f32_bf16 v23, v207, v207, v23
    v_dot2_f32_bf16 v24, v227, s45, v24
    v_dot2_f32_bf16 v25, v227, v227, v25
    v_add_f32_dpp v10, v10, v10 row_ror:8 row_mask:0xf bank_mask:0xf
    v_add_f32_dpp v11, v11, v11 row_ror:8 row_mask:0xf bank_mask:0xf
    v_add_f32_dpp v12, v12, v12 row_ror:8 row_mask:0xf bank_mask:0xf
    v_add_f32_dpp v13, v13, v13 row_ror:8 row_mask:0xf bank_mask:0xf
    v_add_f32_dpp v14, v14, v14 row_ror:8 row_mask:0xf bank_mask:0xf
    v_add_f32_dpp v15, v15, v15 row_ror:8 row_mask:0xf bank_mask:0xf
    v_add_f32_dpp v16, v16, v16 row_ror:8 row_mask:0xf bank_mask:0xf
    v_add_f32_dpp v17, v17, v17 row_ror:8 row_mask:0xf bank_mask:0xf
    v_add_f32_dpp v18, v18, v18 row_ror:8 row_mask:0xf bank_mask:0xf
    v_add_f32_dpp v19, v19, v19 row_ror:8 row_mask:0xf bank_mask:0xf
    v_add_f32_dpp v20, v20, v20 row_ror:8 row_mask:0xf bank_mask:0xf
    v_add_f32_dpp v21, v21, v21 row_ror:8 row_mask:0xf bank_mask:0xf
    v_add_f32_dpp v22, v22, v22 row_ror:8 row_mask:0xf bank_mask:0xf
    v_add_f32_dpp v23, v23, v23 row_ror:8 row_mask:0xf bank_mask:0xf
    v_add_f32_dpp v24, v24, v24 row_ror:8 row_mask:0xf bank_mask:0xf
    v_add_f32_dpp v25, v25, v25 row_ror:8 row_mask:0xf bank_mask:0xf
    v_add_f32_dpp v10, v10, v10 row_ror:4 row_mask:0xf bank_mask:0xf
    v_add_f32_dpp v11, v11, v11 row_ror:4 row_mask:0xf bank_mask:0xf
    v_add_f32_dpp v12, v12, v12 row_ror:4 row_mask:0xf bank_mask:0xf
    v_add_f32_dpp v13, v13, v13 row_ror:4 row_mask:0xf bank_mask:0xf
    v_add_f32_dpp v14, v14, v14 row_ror:4 row_mask:0xf bank_mask:0xf
    v_add_f32_dpp v15, v15, v15 row_ror:4 row_mask:0xf bank_mask:0xf
    v_add_f32_dpp v16, v16, v16 row_ror:4 row_mask:0xf bank_mask:0xf
    v_add_f32_dpp v17, v17, v17 row_ror:4 row_mask:0xf bank_mask:0xf
    v_add_f32_dpp v18, v18, v18 row_ror:4 row_mask:0xf bank_mask:0xf
    v_add_f32_dpp v19, v19, v19 row_ror:4 row_mask:0xf bank_mask:0xf
    v_add_f32_dpp v20, v20, v20 row_ror:4 row_mask:0xf bank_mask:0xf
    v_add_f32_dpp v21, v21, v21 row_ror:4 row_mask:0xf bank_mask:0xf
    v_add_f32_dpp v22, v22, v22 row_ror:4 row_mask:0xf bank_mask:0xf
    v_add_f32_dpp v23, v23, v23 row_ror:4 row_mask:0xf bank_mask:0xf
    v_add_f32_dpp v24, v24, v24 row_ror:4 row_mask:0xf bank_mask:0xf
    v_add_f32_dpp v25, v25, v25 row_ror:4 row_mask:0xf bank_mask:0xf
    v_add_f32_dpp v10, v10, v10 row_ror:2 row_mask:0xf bank_mask:0xf
    v_add_f32_dpp v11, v11, v11 row_ror:2 row_mask:0xf bank_mask:0xf
    v_add_f32_dpp v12, v12, v12 row_ror:2 row_mask:0xf bank_mask:0xf
    v_add_f32_dpp v13, v13, v13 row_ror:2 row_mask:0xf bank_mask:0xf
    v_add_f32_dpp v14, v14, v14 row_ror:2 row_mask:0xf bank_mask:0xf
    v_add_f32_dpp v15, v15, v15 row_ror:2 row_mask:0xf bank_mask:0xf
    v_add_f32_dpp v16, v16, v16 row_ror:2 row_mask:0xf bank_mask:0xf
    v_add_f32_dpp v17, v17, v17 row_ror:2 row_mask:0xf bank_mask:0xf
    v_add_f32_dpp v18, v18, v18 row_ror:2 row_mask:0xf bank_mask:0xf
    v_add_f32_dpp v19, v19, v19 row_ror:2 row_mask:0xf bank_mask:0xf
    v_add_f32_dpp v20, v20, v20 row_ror:2 row_mask:0xf bank_mask:0xf
    v_add_f32_dpp v21, v21, v21 row_ror:2 row_mask:0xf bank_mask:0xf
    v_add_f32_dpp v22, v22, v22 row_ror:2 row_mask:0xf bank_mask:0xf
    v_add_f32_dpp v23, v23, v23 row_ror:2 row_mask:0xf bank_mask:0xf
    v_add_f32_dpp v24, v24, v24 row_ror:2 row_mask:0xf bank_mask:0xf
    v_add_f32_dpp v25, v25, v25 row_ror:2 row_mask:0xf bank_mask:0xf
    v_add_f32_dpp v10, v10, v10 row_ror:1 row_mask:0xf bank_mask:0xf
    v_add_f32_dpp v11, v11, v11 row_ror:1 row_mask:0xf bank_mask:0xf
    v_add_f32_dpp v12, v12, v12 row_ror:1 row_mask:0xf bank_mask:0xf
    v_add_f32_dpp v13, v13, v13 row_ror:1 row_mask:0xf bank_mask:0xf
    v_add_f32_dpp v14, v14, v14 row_ror:1 row_mask:0xf bank_mask:0xf
    v_add_f32_dpp v15, v15, v15 row_ror:1 row_mask:0xf bank_mask:0xf
    v_add_f32_dpp v16, v16, v16 row_ror:1 row_mask:0xf bank_mask:0xf
    v_add_f32_dpp v17, v17, v17 row_ror:1 row_mask:0xf bank_mask:0xf
    v_add_f32_dpp v18, v18, v18 row_ror:1 row_mask:0xf bank_mask:0xf
    v_add_f32_dpp v19, v19, v19 row_ror:1 row_mask:0xf bank_mask:0xf
    v_add_f32_dpp v20, v20, v20 row_ror:1 row_mask:0xf bank_mask:0xf
    v_add_f32_dpp v21, v21, v21 row_ror:1 row_mask:0xf bank_mask:0xf
    v_add_f32_dpp v22, v22, v22 row_ror:1 row_mask:0xf bank_mask:0xf
    v_add_f32_dpp v23, v23, v23 row_ror:1 row_mask:0xf bank_mask:0xf
    v_add_f32_dpp v24, v24, v24 row_ror:1 row_mask:0xf bank_mask:0xf
    v_add_f32_dpp v25, v25, v25 row_ror:1 row_mask:0xf bank_mask:0xf
    v_cmp_eq_u32 vcc, 1, v5
    s_nop 1
    v_cndmask_b32 v10, v10, v12, vcc
    v_cndmask_b32 v11, v11, v13, vcc
    v_cmp_eq_u32 vcc, 2, v5
    s_nop 1
    v_cndmask_b32 v10, v10, v14, vcc
    v_cndmask_b32 v11, v11, v15, vcc
    v_cmp_eq_u32 vcc, 3, v5
    s_nop 1
    v_cndmask_b32 v10, v10, v16, vcc
    v_cndmask_b32 v11, v11, v17, vcc
    v_cmp_eq_u32 vcc, 4, v5
    s_nop 1
    v_cndmask_b32 v10, v10, v18, vcc
    v_cndmask_b32 v11, v11, v19, vcc
    v_cmp_eq_u32 vcc, 5, v5
    s_nop 1
    v_cndmask_b32 v10, v10, v20, vcc
    v_cndmask_b32 v11, v11, v21, vcc
    v_cmp_eq_u32 vcc, 6, v5
    s_nop 1
    v_cndmask_b32 v10, v10, v22, vcc
    v_cndmask_b32 v11, v11, v23, vcc
    v_cmp_eq_u32 vcc, 7, v5
    s_nop 1
    v_cndmask_b32 v10, v10, v24, vcc
    v_cndmask_b32 v11, v11, v25, vcc
    v_mul_f32 v10, 0x3acccccd, v10
    v_mul_f32 v3, v10, v10
    v_mov_b32 v6, 0x3acccccd
    v_fma_f32 v3, v11, v6, -v3
    v_max_f32 v3, 0, v3
    v_add_f32 v3, 0x3727c5ac, v3
    v_rsq_f32 v56, v3
    v_lshl_add_u32 v3, v5, 2, v4
    v_mul_f32 v57, v10, v56
    v_add_u32 v3, s58, v3
    v_lshlrev_b32 v3, 4, v3
    v_add_u32 v3, 12058624, v3
    s_mov_b32 s47, 65536
    s_branch A_non_ck_3
A_non_2:
    buffer_load_dword v41, v2, s[16:19], 0 offen sc1
A_non_ck_3:
    s_sub_u32 s47, s47, 1
    s_waitcnt vmcnt(0)
    s_cbranch_scc1 A_non_ok_4
    v_cmp_eq_u32 vcc, 0, v41
    s_cbranch_vccnz A_non_2
A_non_ok_4:
    v_readfirstlane_b32 s41, v41
    v_mov_b32 v58, v41
    v_mov_b32 v59, v41
    s_mov_b32 exec_lo, 0x00ff00ff
    s_mov_b32 exec_hi, 0x00ff00ff
    buffer_store_dwordx4 v[56:59], v3, s[12:15], 0 offen sc1
    s_mov_b64 exec, -1
    buffer_store_dwordx4 v[60:63], v64, s[12:15], 0 offen offset:0 sc1
    buffer_store_dwordx4 v[60:63], v64, s[12:15], 0 offen offset:1024 sc1
    buffer_store_dwordx4 v[60:63], v64, s[12:15], 0 offen offset:2048 sc1
    s_branch sequential_preLN__mha_block__moe_arch_mod__prompt_kernel_edge
.p2align 12
sequential_preLN__mha_block__moe_arch_mod__prompt_kernel_Q:
    s_lshl_b32 s44, s50, 13
    s_lshl_b32 s45, s50, 1
    v_bfe_u32 v3, v7, 1, 3
    v_xor_b32 v3, v3, v9
    v_xor_b32 v3, s45, v3
    v_lshlrev_b32 v3, 4, v3
    v_lshl_add_u32 v3, v7, 7, v3
    v_add_u32 v18, s44, v3
    s_lshl_b32 s44, s51, 1
    v_bfe_u32 v3, v1, 2, 2
    v_xor_b32 v4, s44, v3
    v_lshlrev_b32 v4, 6, v4
    v_lshl_add_u32 v3, v9, 3, v3
    v_lshl_add_u32 v4, v3, 8, v4
    v_bfe_u32 v3, v1, 4, 1
    v_lshl_add_u32 v4, v3, 5, v4
    v_and_b32 v3, 3, v1
    v_lshrrev_b32 v5, 1, v3
    v_and_b32 v3, 1, v3
    v_lshl_add_u32 v3, v3, 1, v5
    v_lshl_add_u32 v4, v3, 3, v4
    s_lshl_b32 s44, s50, 12
    s_add_u32 s44, s44, 16384
    v_add_u32 v26, s44, v4
    v_xor_b32 v28, 64, v26
    v_xor_b32 v27, 4096, v26
    v_xor_b32 v29, 4096, v28
    v_xor_b32 v19, 32, v18
    v_xor_b32 v20, 64, v18
    v_xor_b32 v21, 96, v18
    s_mov_b64 exec, 0
    s_branch PAD_Q
RET_Q:
    s_mov_b64 exec, -1
    s_waitcnt vmcnt(6)
    s_barrier
    ds_read_b128 v[68:71], v18 offset:0
    ds_read_b64_tr_b16 v[76:77], v26 offset:0
    ds_read_b64_tr_b16 v[78:79], v26 offset:1024
    ds_read_b128 v[72:75], v18 offset:4096
    ds_read_b64_tr_b16 v[80:81], v28 offset:0
    ds_read_b64_tr_b16 v[82:83], v28 offset:1024
.p2align 3
    s_waitcnt lgkmcnt(0)
    v_mfma_f32_32x32x16_bf16 v[100:115], v[76:79], v[68:71], 0
    ds_read_b128 v[84:87], v19 offset:0
    ds_read_b64_tr_b16 v[92:93], v27 offset:0
    ds_read_b64_tr_b16 v[94:95], v27 offset:1024
    v_mfma_f32_32x32x16_bf16 v[132:147], v[76:79], v[72:75], 0
    ds_read_b128 v[88:91], v19 offset:4096
    ds_read_b64_tr_b16 v[96:97], v29 offset:0
    ds_read_b64_tr_b16 v[98:99], v29 offset:1024
    s_add_u32 m0, s52, 49152
    s_mov_b32 s54, 245760
    buffer_load_dwordx4 v14, s[8:11], s54 offen offset:0 lds
    v_mfma_f32_32x32x16_bf16 v[116:131], v[80:83], v[68:71], 0
    buffer_load_dwordx4 v15, s[8:11], s54 offen offset:1024 lds
    v_add_u32 v22, 65536, v18
    v_add_u32 v23, 65536, v19
    v_mfma_f32_32x32x16_bf16 v[148:163], v[80:83], v[72:75], 0
    buffer_load_dwordx4 v16, s[8:11], s54 offen offset:2048 lds
    v_add_u32 v24, 65536, v20
    v_add_u32 v25, 65536, v21
    v_smfmac_f32_16x16x64_bf16 v[52:55], v[36:39], v[76:83], v40
    s_waitcnt lgkmcnt(0)
    v_mfma_f32_32x32x16_bf16 v[100:115], v[92:95], v[84:87], v[100:115]
    ds_read_b128 v[68:71], v20 offset:0
    ds_read_b64_tr_b16 v[76:77], v26 offset:8192
    ds_read_b64_tr_b16 v[78:79], v26 offset:9216
    v_mfma_f32_32x32x16_bf16 v[132:147], v[92:95], v[88:91], v[132:147]
    ds_read_b128 v[72:75], v20 offset:4096
    ds_read_b64_tr_b16 v[80:81], v28 offset:8192
    ds_read_b64_tr_b16 v[82:83], v28 offset:9216
    buffer_load_dwordx4 v17, s[8:11], s54 offen offset:3072 lds
    v_mfma_f32_32x32x16_bf16 v[116:131], v[96:99], v[84:87], v[116:131]
    s_add_u32 m0, s52, 65536
    s_movk_i32 s53, 256
    buffer_load_dwordx4 v10, s[4:7], s53 offen offset:0 lds
    v_add_u32 v30, 65536, v26
    v_add_u32 v31, 65536, v27
    v_mfma_f32_32x32x16_bf16 v[148:163], v[96:99], v[88:91], v[148:163]
    buffer_load_dwordx4 v11, s[4:7], s53 offen offset:1024 lds
    v_add_u32 v32, 65536, v28
    v_add_u32 v33, 65536, v29
    s_waitcnt lgkmcnt(0)
    v_mfma_f32_32x32x16_bf16 v[100:115], v[76:79], v[68:71], v[100:115]
    ds_read_b128 v[84:87], v21 offset:0
    ds_read_b64_tr_b16 v[92:93], v27 offset:8192
    ds_read_b64_tr_b16 v[94:95], v27 offset:9216
    v_mfma_f32_32x32x16_bf16 v[132:147], v[76:79], v[72:75], v[132:147]
    ds_read_b128 v[88:91], v21 offset:4096
    ds_read_b64_tr_b16 v[96:97], v29 offset:8192
    ds_read_b64_tr_b16 v[98:99], v29 offset:9216
    buffer_load_dwordx4 v12, s[4:7], s53 offen offset:2048 lds
    v_mfma_f32_32x32x16_bf16 v[116:131], v[80:83], v[68:71], v[116:131]
    buffer_load_dwordx4 v13, s[4:7], s53 offen offset:3072 lds
    s_mul_i32 s46, s2, 12288
    s_mul_i32 s45, s40, 3072
    v_mfma_f32_32x32x16_bf16 v[148:163], v[80:83], v[72:75], v[148:163]
    s_add_u32 m0, s52, 81920
    s_mov_b32 s54, 491520
    buffer_load_dwordx4 v14, s[8:11], s54 offen offset:0 lds
    s_add_u32 s46, s46, s45
    s_add_u32 s46, s46, 8912896
    v_smfmac_f32_16x16x64_bf16 v[52:55], v[36:39], v[76:83], v40
    s_waitcnt vmcnt(5) lgkmcnt(0)
    s_barrier
    v_mfma_f32_32x32x16_bf16 v[100:115], v[92:95], v[84:87], v[100:115]
    ds_read_b128 v[68:71], v18 offset:32768
    ds_read_b64_tr_b16 v[76:77], v26 offset:32768
    ds_read_b64_tr_b16 v[78:79], v26 offset:33792
    v_mfma_f32_32x32x16_bf16 v[132:147], v[92:95], v[88:91], v[132:147]
    ds_read_b128 v[72:75], v18 offset:36864
    ds_read_b64_tr_b16 v[80:81], v28 offset:32768
    ds_read_b64_tr_b16 v[82:83], v28 offset:33792
    buffer_load_dwordx4 v15, s[8:11], s54 offen offset:1024 lds
    v_mfma_f32_32x32x16_bf16 v[116:131], v[96:99], v[84:87], v[116:131]
    buffer_load_dwordx4 v16, s[8:11], s54 offen offset:2048 lds
    v_lshl_add_u32 v64, v1, 4, s46
    v_mov_b32 v60, -1
    v_mfma_f32_32x32x16_bf16 v[148:163], v[96:99], v[88:91], v[148:163]
    buffer_load_dwordx4 v17, s[8:11], s54 offen offset:3072 lds
    v_mov_b32 v61, -1
    v_mov_b32 v62, -1
    s_waitcnt lgkmcnt(0)
    v_mfma_f32_32x32x16_bf16 v[100:115], v[76:79], v[68:71], v[100:115]
    ds_read_b128 v[84:87], v19 offset:32768
    ds_read_b64_tr_b16 v[92:93], v27 offset:32768
    ds_read_b64_tr_b16 v[94:95], v27 offset:33792
    v_mfma_f32_32x32x16_bf16 v[132:147], v[76:79], v[72:75], v[132:147]
    ds_read_b128 v[88:91], v19 offset:36864
    ds_read_b64_tr_b16 v[96:97], v29 offset:32768
    ds_read_b64_tr_b16 v[98:99], v29 offset:33792
    s_add_u32 m0, s52, 98304
    s_movk_i32 s53, 384
    buffer_load_dwordx4 v10, s[4:7], s53 offen offset:0 lds
    v_mfma_f32_32x32x16_bf16 v[116:131], v[80:83], v[68:71], v[116:131]
    buffer_load_dwordx4 v11, s[4:7], s53 offen offset:1024 lds
    v_mov_b32 v63, -1
    v_add_u32 v42, s58, v7
    v_mfma_f32_32x32x16_bf16 v[148:163], v[80:83], v[72:75], v[148:163]
    buffer_load_dwordx4 v12, s[4:7], s53 offen offset:2048 lds
    v_lshlrev_b32 v42, 4, v42
    v_add_u32 v42, 12058624, v42
    v_smfmac_f32_16x16x64_bf16 v[52:55], v[36:39], v[76:83], v40
    s_waitcnt lgkmcnt(0)
    v_mfma_f32_32x32x16_bf16 v[100:115], v[92:95], v[84:87], v[100:115]
    ds_read_b128 v[68:71], v20 offset:32768
    ds_read_b64_tr_b16 v[76:77], v26 offset:40960
    ds_read_b64_tr_b16 v[78:79], v26 offset:41984
    v_mfma_f32_32x32x16_bf16 v[132:147], v[92:95], v[88:91], v[132:147]
    ds_read_b128 v[72:75], v20 offset:36864
    ds_read_b64_tr_b16 v[80:81], v28 offset:40960
    ds_read_b64_tr_b16 v[82:83], v28 offset:41984
    buffer_load_dwordx4 v13, s[4:7], s53 offen offset:3072 lds
    v_mfma_f32_32x32x16_bf16 v[116:131], v[96:99], v[84:87], v[116:131]
    s_add_u32 m0, s52, 114688
    s_mov_b32 s54, 737280
    buffer_load_dwordx4 v14, s[8:11], s54 offen offset:0 lds
    s_lshl_b32 s44, s40, 7
    s_add_u32 s44, s44, 131072
    v_mfma_f32_32x32x16_bf16 v[148:163], v[96:99], v[88:91], v[148:163]
    buffer_load_dwordx4 v15, s[8:11], s54 offen offset:1024 lds
    v_lshl_add_u32 v45, v7, 2, s44
    s_lshl_b32 s45, s51, 8
    s_waitcnt lgkmcnt(0)
    v_mfma_f32_32x32x16_bf16 v[100:115], v[76:79], v[68:71], v[100:115]
    ds_read_b128 v[84:87], v21 offset:32768
    ds_read_b64_tr_b16 v[92:93], v27 offset:40960
    ds_read_b64_tr_b16 v[94:95], v27 offset:41984
    v_mfma_f32_32x32x16_bf16 v[132:147], v[76:79], v[72:75], v[132:147]
    ds_read_b128 v[88:91], v21 offset:36864
    ds_read_b64_tr_b16 v[96:97], v29 offset:40960
    ds_read_b64_tr_b16 v[98:99], v29 offset:41984
    buffer_load_dwordx4 v16, s[8:11], s54 offen offset:2048 lds
    v_mfma_f32_32x32x16_bf16 v[116:131], v[80:83], v[68:71], v[116:131]
    buffer_load_dwordx4 v17, s[8:11], s54 offen offset:3072 lds
    s_add_u32 s45, s45, 132096
    s_lshl_b32 s46, s50, 9
    v_mfma_f32_32x32x16_bf16 v[148:163], v[80:83], v[72:75], v[148:163]
    s_add_u32 m0, s52, 0
    s_movk_i32 s53, 512
    buffer_load_dwordx4 v10, s[4:7], s53 offen offset:0 lds
    s_add_u32 s46, s46, s45
    v_lshl_add_u32 v6, v9, 5, v8
    v_smfmac_f32_16x16x64_bf16 v[52:55], v[36:39], v[76:83], v40
    s_waitcnt vmcnt(9) lgkmcnt(0)
    s_barrier
    v_mfma_f32_32x32x16_bf16 v[100:115], v[92:95], v[84:87], v[100:115]
    ds_read_b128 v[68:71], v22 offset:0
    ds_read_b64_tr_b16 v[76:77], v30 offset:0
    ds_read_b64_tr_b16 v[78:79], v30 offset:1024
    v_mfma_f32_32x32x16_bf16 v[132:147], v[92:95], v[88:91], v[132:147]
    ds_read_b128 v[72:75], v22 offset:4096
    ds_read_b64_tr_b16 v[80:81], v32 offset:0
    ds_read_b64_tr_b16 v[82:83], v32 offset:1024
    buffer_load_dwordx4 v11, s[4:7], s53 offen offset:1024 lds
    v_mfma_f32_32x32x16_bf16 v[116:131], v[96:99], v[84:87], v[116:131]
    buffer_load_dwordx4 v12, s[4:7], s53 offen offset:2048 lds
    v_lshl_add_u32 v46, v6, 2, s46
    v_xor_b32 v47, 512, v46
    v_mfma_f32_32x32x16_bf16 v[148:163], v[96:99], v[88:91], v[148:163]
    buffer_load_dwordx4 v13, s[4:7], s53 offen offset:3072 lds
    s_lshl_b32 s46, s40, 8
    s_add_u32 s46, s46, 133120
    s_waitcnt lgkmcnt(0)
    v_mfma_f32_32x32x16_bf16 v[100:115], v[76:79], v[68:71], v[100:115]
    ds_read_b128 v[84:87], v23 offset:0
    ds_read_b64_tr_b16 v[92:93], v31 offset:0
    ds_read_b64_tr_b16 v[94:95], v31 offset:1024
    v_mfma_f32_32x32x16_bf16 v[132:147], v[76:79], v[72:75], v[132:147]
    ds_read_b128 v[88:91], v23 offset:4096
    ds_read_b64_tr_b16 v[96:97], v33 offset:0
    ds_read_b64_tr_b16 v[98:99], v33 offset:1024
    s_add_u32 m0, s52, 16384
    s_mov_b32 s54, 983040
    buffer_load_dwordx4 v14, s[8:11], s54 offen offset:0 lds
    v_mfma_f32_32x32x16_bf16 v[116:131], v[80:83], v[68:71], v[116:131]
    buffer_load_dwordx4 v15, s[8:11], s54 offen offset:1024 lds
    v_lshl_add_u32 v48, v6, 2, s46
    s_lshl_b32 s44, s50, 8
    v_mfma_f32_32x32x16_bf16 v[148:163], v[80:83], v[72:75], v[148:163]
    buffer_load_dwordx4 v16, s[8:11], s54 offen offset:2048 lds
    s_add_u32 s44, s44, 131072
    v_lshl_add_u32 v49, v7, 2, s44
    v_smfmac_f32_16x16x64_bf16 v[52:55], v[36:39], v[76:83], v40
    s_waitcnt lgkmcnt(0)
    v_mfma_f32_32x32x16_bf16 v[100:115], v[92:95], v[84:87], v[100:115]
    ds_read_b128 v[68:71], v24 offset:0
    ds_read_b64_tr_b16 v[76:77], v30 offset:8192
    ds_read_b64_tr_b16 v[78:79], v30 offset:9216
    v_mfma_f32_32x32x16_bf16 v[132:147], v[92:95], v[88:91], v[132:147]
    ds_read_b128 v[72:75], v24 offset:4096
    ds_read_b64_tr_b16 v[80:81], v32 offset:8192
    ds_read_b64_tr_b16 v[82:83], v32 offset:9216
    buffer_load_dwordx4 v17, s[8:11], s54 offen offset:3072 lds
    v_mfma_f32_32x32x16_bf16 v[116:131], v[96:99], v[84:87], v[116:131]
    s_add_u32 m0, s52, 32768
    s_movk_i32 s53, 640
    buffer_load_dwordx4 v10, s[4:7], s53 offen offset:0 lds
    v_lshl_add_u32 v50, v9, 5, s46
    s_cmp_lt_u32 s49, 5
    s_cselect_b32 s57, 0x3ea52b5c, 1.0
    v_mfma_f32_32x32x16_bf16 v[148:163], v[96:99], v[88:91], v[148:163]
    buffer_load_dwordx4 v11, s[4:7], s53 offen offset:1024 lds
    s_lshl_b32 s44, s49, 4
    s_lshl_b32 s45, s51, 3
    s_waitcnt lgkmcnt(0)
    v_mfma_f32_32x32x16_bf16 v[100:115], v[76:79], v[68:71], v[100:115]
    ds_read_b128 v[84:87], v25 offset:0
    ds_read_b64_tr_b16 v[92:93], v31 offset:8192
    ds_read_b64_tr_b16 v[94:95], v31 offset:9216
    v_mfma_f32_32x32x16_bf16 v[132:147], v[76:79], v[72:75], v[132:147]
    ds_read_b128 v[88:91], v25 offset:4096
    ds_read_b64_tr_b16 v[96:97], v33 offset:8192
    ds_read_b64_tr_b16 v[98:99], v33 offset:9216
    buffer_load_dwordx4 v12, s[4:7], s53 offen offset:2048 lds
    v_mfma_f32_32x32x16_bf16 v[116:131], v[80:83], v[68:71], v[116:131]
    buffer_load_dwordx4 v13, s[4:7], s53 offen offset:3072 lds
    s_add_u32 s44, s44, s45
    s_mul_i32 s44, s44, 34048
    v_mfma_f32_32x32x16_bf16 v[148:163], v[80:83], v[72:75], v[148:163]
    s_add_u32 m0, s52, 49152
    s_mov_b32 s54, 1228800
    buffer_load_dwordx4 v14, s[8:11], s54 offen offset:0 lds
    s_lshl_b32 s45, s48, 11
    s_add_u32 s44, s44, s45
    v_smfmac_f32_16x16x64_bf16 v[52:55], v[36:39], v[76:83], v40
    s_waitcnt vmcnt(13) lgkmcnt(0)
    s_barrier
    v_mfma_f32_32x32x16_bf16 v[100:115], v[92:95], v[84:87], v[100:115]
    ds_read_b128 v[68:71], v22 offset:32768
    ds_read_b64_tr_b16 v[76:77], v30 offset:32768
    ds_read_b64_tr_b16 v[78:79], v30 offset:33792
    v_mfma_f32_32x32x16_bf16 v[132:147], v[92:95], v[88:91], v[132:147]
    ds_read_b128 v[72:75], v22 offset:36864
    ds_read_b64_tr_b16 v[80:81], v32 offset:32768
    ds_read_b64_tr_b16 v[82:83], v32 offset:33792
    buffer_load_dwordx4 v15, s[8:11], s54 offen offset:1024 lds
    v_mfma_f32_32x32x16_bf16 v[116:131], v[96:99], v[84:87], v[116:131]
    buffer_load_dwordx4 v16, s[8:11], s54 offen offset:2048 lds
    s_lshl_b32 s45, s50, 10
    s_add_u32 s44, s44, s45
    v_mfma_f32_32x32x16_bf16 v[148:163], v[96:99], v[88:91], v[148:163]
    buffer_load_dwordx4 v17, s[8:11], s54 offen offset:3072 lds
    v_mul_u32_u24 v3, 34048, v9
    v_lshl_add_u32 v3, v7, 4, v3
    s_waitcnt lgkmcnt(0)
    v_mfma_f32_32x32x16_bf16 v[100:115], v[76:79], v[68:71], v[100:115]
    ds_read_b128 v[84:87], v23 offset:32768
    ds_read_b64_tr_b16 v[92:93], v31 offset:32768
    ds_read_b64_tr_b16 v[94:95], v31 offset:33792
    v_mfma_f32_32x32x16_bf16 v[132:147], v[76:79], v[72:75], v[132:147]
    ds_read_b128 v[88:91], v23 offset:36864
    ds_read_b64_tr_b16 v[96:97], v33 offset:32768
    ds_read_b64_tr_b16 v[98:99], v33 offset:33792
    s_add_u32 m0, s52, 65536
    s_movk_i32 s53, 768
    buffer_load_dwordx4 v10, s[4:7], s53 offen offset:0 lds
    v_mfma_f32_32x32x16_bf16 v[116:131], v[80:83], v[68:71], v[116:131]
    buffer_load_dwordx4 v11, s[4:7], s53 offen offset:1024 lds
    v_add_u32 v43, s44, v3
    v_add_u32 v44, 136192, v43
    v_mfma_f32_32x32x16_bf16 v[148:163], v[80:83], v[72:75], v[148:163]
    buffer_load_dwordx4 v12, s[4:7], s53 offen offset:2048 lds
    s_mov_b32 s56, 68096
    v_smfmac_f32_16x16x64_bf16 v[52:55], v[36:39], v[76:83], v40
    s_waitcnt lgkmcnt(0)
    v_mfma_f32_32x32x16_bf16 v[100:115], v[92:95], v[84:87], v[100:115]
    ds_read_b128 v[68:71], v24 offset:32768
    ds_read_b64_tr_b16 v[76:77], v30 offset:40960
    ds_read_b64_tr_b16 v[78:79], v30 offset:41984
    v_mfma_f32_32x32x16_bf16 v[132:147], v[92:95], v[88:91], v[132:147]
    ds_read_b128 v[72:75], v24 offset:36864
    ds_read_b64_tr_b16 v[80:81], v32 offset:40960
    ds_read_b64_tr_b16 v[82:83], v32 offset:41984
    buffer_load_dwordx4 v13, s[4:7], s53 offen offset:3072 lds
    v_mfma_f32_32x32x16_bf16 v[116:131], v[96:99], v[84:87], v[116:131]
    s_add_u32 m0, s52, 81920
    s_mov_b32 s54, 1474560
    buffer_load_dwordx4 v14, s[8:11], s54 offen offset:0 lds
    v_mfma_f32_32x32x16_bf16 v[148:163], v[96:99], v[88:91], v[148:163]
    buffer_load_dwordx4 v15, s[8:11], s54 offen offset:1024 lds
    s_waitcnt lgkmcnt(0)
    v_mfma_f32_32x32x16_bf16 v[100:115], v[76:79], v[68:71], v[100:115]
    ds_read_b128 v[84:87], v25 offset:32768
    ds_read_b64_tr_b16 v[92:93], v31 offset:40960
    ds_read_b64_tr_b16 v[94:95], v31 offset:41984
    v_mfma_f32_32x32x16_bf16 v[132:147], v[76:79], v[72:75], v[132:147]
    ds_read_b128 v[88:91], v25 offset:36864
    ds_read_b64_tr_b16 v[96:97], v33 offset:40960
    ds_read_b64_tr_b16 v[98:99], v33 offset:41984
    v_mfma_f32_32x32x16_bf16 v[116:131], v[80:83], v[68:71], v[116:131]
    buffer_load_dwordx4 v16, s[8:11], s54 offen offset:2048 lds
    v_mfma_f32_32x32x16_bf16 v[148:163], v[80:83], v[72:75], v[148:163]
    buffer_load_dwordx4 v17, s[8:11], s54 offen offset:3072 lds
    v_smfmac_f32_16x16x64_bf16 v[52:55], v[36:39], v[76:83], v40
    s_waitcnt vmcnt(16) lgkmcnt(0)
    s_barrier
    v_mfma_f32_32x32x16_bf16 v[100:115], v[92:95], v[84:87], v[100:115]
    ds_read_b128 v[68:71], v18 offset:0
    ds_read_b64_tr_b16 v[76:77], v26 offset:0
    ds_read_b64_tr_b16 v[78:79], v26 offset:1024
    v_mfma_f32_32x32x16_bf16 v[132:147], v[92:95], v[88:91], v[132:147]
    ds_read_b128 v[72:75], v18 offset:4096
    ds_read_b64_tr_b16 v[80:81], v28 offset:0
    ds_read_b64_tr_b16 v[82:83], v28 offset:1024
    v_mfma_f32_32x32x16_bf16 v[116:131], v[96:99], v[84:87], v[116:131]
    s_add_u32 m0, s52, 98304
    s_movk_i32 s53, 896
    buffer_load_dwordx4 v10, s[4:7], s53 offen offset:0 lds
    v_mfma_f32_32x32x16_bf16 v[148:163], v[96:99], v[88:91], v[148:163]
    buffer_load_dwordx4 v11, s[4:7], s53 offen offset:1024 lds
    s_waitcnt lgkmcnt(0)
    v_mfma_f32_32x32x16_bf16 v[100:115], v[76:79], v[68:71], v[100:115]
    ds_read_b128 v[84:87], v19 offset:0
    ds_read_b64_tr_b16 v[92:93], v27 offset:0
    ds_read_b64_tr_b16 v[94:95], v27 offset:1024
    v_mfma_f32_32x32x16_bf16 v[132:147], v[76:79], v[72:75], v[132:147]
    ds_read_b128 v[88:91], v19 offset:4096
    ds_read_b64_tr_b16 v[96:97], v29 offset:0
    ds_read_b64_tr_b16 v[98:99], v29 offset:1024
    v_mfma_f32_32x32x16_bf16 v[116:131], v[80:83], v[68:71], v[116:131]
    buffer_load_dwordx4 v12, s[4:7], s53 offen offset:2048 lds
    v_mfma_f32_32x32x16_bf16 v[148:163], v[80:83], v[72:75], v[148:163]
    buffer_load_dwordx4 v13, s[4:7], s53 offen offset:3072 lds
    v_smfmac_f32_16x16x64_bf16 v[52:55], v[36:39], v[76:83], v40
    s_waitcnt lgkmcnt(0)
    v_mfma_f32_32x32x16_bf16 v[100:115], v[92:95], v[84:87], v[100:115]
    ds_read_b128 v[68:71], v20 offset:0
    ds_read_b64_tr_b16 v[76:77], v26 offset:8192
    ds_read_b64_tr_b16 v[78:79], v26 offset:9216
    v_mfma_f32_32x32x16_bf16 v[132:147], v[92:95], v[88:91], v[132:147]
    ds_read_b128 v[72:75], v20 offset:4096
    ds_read_b64_tr_b16 v[80:81], v28 offset:8192
    ds_read_b64_tr_b16 v[82:83], v28 offset:9216
    v_mfma_f32_32x32x16_bf16 v[116:131], v[96:99], v[84:87], v[116:131]
    s_add_u32 m0, s52, 114688
    s_mov_b32 s54, 1720320
    buffer_load_dwordx4 v14, s[8:11], s54 offen offset:0 lds
    v_mfma_f32_32x32x16_bf16 v[148:163], v[96:99], v[88:91], v[148:163]
    buffer_load_dwordx4 v15, s[8:11], s54 offen offset:1024 lds
    s_waitcnt lgkmcnt(0)
    v_mfma_f32_32x32x16_bf16 v[100:115], v[76:79], v[68:71], v[100:115]
    ds_read_b128 v[84:87], v21 offset:0
    ds_read_b64_tr_b16 v[92:93], v27 offset:8192
    ds_read_b64_tr_b16 v[94:95], v27 offset:9216
    v_mfma_f32_32x32x16_bf16 v[132:147], v[76:79], v[72:75], v[132:147]
    ds_read_b128 v[88:91], v21 offset:4096
    ds_read_b64_tr_b16 v[96:97], v29 offset:8192
    ds_read_b64_tr_b16 v[98:99], v29 offset:9216
    v_mfma_f32_32x32x16_bf16 v[116:131], v[80:83], v[68:71], v[116:131]
    buffer_load_dwordx4 v16, s[8:11], s54 offen offset:2048 lds
    v_mfma_f32_32x32x16_bf16 v[148:163], v[80:83], v[72:75], v[148:163]
    buffer_load_dwordx4 v17, s[8:11], s54 offen offset:3072 lds
    v_smfmac_f32_16x16x64_bf16 v[52:55], v[36:39], v[76:83], v40
    s_waitcnt vmcnt(16) lgkmcnt(0)
    s_barrier
    v_mfma_f32_32x32x16_bf16 v[100:115], v[92:95], v[84:87], v[100:115]
    ds_read_b128 v[68:71], v18 offset:32768
    ds_read_b64_tr_b16 v[76:77], v26 offset:32768
    ds_read_b64_tr_b16 v[78:79], v26 offset:33792
    v_mfma_f32_32x32x16_bf16 v[132:147], v[92:95], v[88:91], v[132:147]
    ds_read_b128 v[72:75], v18 offset:36864
    ds_read_b64_tr_b16 v[80:81], v28 offset:32768
    ds_read_b64_tr_b16 v[82:83], v28 offset:33792
    v_mfma_f32_32x32x16_bf16 v[116:131], v[96:99], v[84:87], v[116:131]
    s_add_u32 m0, s52, 0
    s_movk_i32 s53, 1024
    buffer_load_dwordx4 v10, s[4:7], s53 offen offset:0 lds
    v_mfma_f32_32x32x16_bf16 v[148:163], v[96:99], v[88:91], v[148:163]
    buffer_load_dwordx4 v11, s[4:7], s53 offen offset:1024 lds
    s_waitcnt lgkmcnt(0)
    v_mfma_f32_32x32x16_bf16 v[100:115], v[76:79], v[68:71], v[100:115]
    ds_read_b128 v[84:87], v19 offset:32768
    ds_read_b64_tr_b16 v[92:93], v27 offset:32768
    ds_read_b64_tr_b16 v[94:95], v27 offset:33792
    v_mfma_f32_32x32x16_bf16 v[132:147], v[76:79], v[72:75], v[132:147]
    ds_read_b128 v[88:91], v19 offset:36864
    ds_read_b64_tr_b16 v[96:97], v29 offset:32768
    ds_read_b64_tr_b16 v[98:99], v29 offset:33792
    v_mfma_f32_32x32x16_bf16 v[116:131], v[80:83], v[68:71], v[116:131]
    buffer_load_dwordx4 v12, s[4:7], s53 offen offset:2048 lds
    v_mfma_f32_32x32x16_bf16 v[148:163], v[80:83], v[72:75], v[148:163]
    buffer_load_dwordx4 v13, s[4:7], s53 offen offset:3072 lds
    v_smfmac_f32_16x16x64_bf16 v[52:55], v[36:39], v[76:83], v40
    s_waitcnt lgkmcnt(0)
    v_mfma_f32_32x32x16_bf16 v[100:115], v[92:95], v[84:87], v[100:115]
    ds_read_b128 v[68:71], v20 offset:32768
    ds_read_b64_tr_b16 v[76:77], v26 offset:40960
    ds_read_b64_tr_b16 v[78:79], v26 offset:41984
    v_mfma_f32_32x32x16_bf16 v[132:147], v[92:95], v[88:91], v[132:147]
    ds_read_b128 v[72:75], v20 offset:36864
    ds_read_b64_tr_b16 v[80:81], v28 offset:40960
    ds_read_b64_tr_b16 v[82:83], v28 offset:41984
    v_mfma_f32_32x32x16_bf16 v[116:131], v[96:99], v[84:87], v[116:131]
    s_add_u32 m0, s52, 16384
    s_mov_b32 s54, 1966080
    buffer_load_dwordx4 v14, s[8:11], s54 offen offset:0 lds
    v_mfma_f32_32x32x16_bf16 v[148:163], v[96:99], v[88:91], v[148:163]
    buffer_load_dwordx4 v15, s[8:11], s54 offen offset:1024 lds
    s_waitcnt lgkmcnt(0)
    v_mfma_f32_32x32x16_bf16 v[100:115], v[76:79], v[68:71], v[100:115]
    ds_read_b128 v[84:87], v21 offset:32768
    ds_read_b64_tr_b16 v[92:93], v27 offset:40960
    ds_read_b64_tr_b16 v[94:95], v27 offset:41984
    v_mfma_f32_32x32x16_bf16 v[132:147], v[76:79], v[72:75], v[132:147]
    ds_read_b128 v[88:91], v21 offset:36864
    ds_read_b64_tr_b16 v[96:97], v29 offset:40960
    ds_read_b64_tr_b16 v[98:99], v29 offset:41984
    v_mfma_f32_32x32x16_bf16 v[116:131], v[80:83], v[68:71], v[116:131]
    buffer_load_dwordx4 v16, s[8:11], s54 offen offset:2048 lds
    v_mfma_f32_32x32x16_bf16 v[148:163], v[80:83], v[72:75], v[148:163]
    buffer_load_dwordx4 v17, s[8:11], s54 offen offset:3072 lds
    v_smfmac_f32_16x16x64_bf16 v[52:55], v[36:39], v[76:83], v40
    s_waitcnt vmcnt(16) lgkmcnt(0)
    s_barrier
    v_mfma_f32_32x32x16_bf16 v[100:115], v[92:95], v[84:87], v[100:115]
    ds_read_b128 v[68:71], v22 offset:0
    ds_read_b64_tr_b16 v[76:77], v30 offset:0
    ds_read_b64_tr_b16 v[78:79], v30 offset:1024
    v_mfma_f32_32x32x16_bf16 v[132:147], v[92:95], v[88:91], v[132:147]
    ds_read_b128 v[72:75], v22 offset:4096
    ds_read_b64_tr_b16 v[80:81], v32 offset:0
    ds_read_b64_tr_b16 v[82:83], v32 offset:1024
    v_mfma_f32_32x32x16_bf16 v[116:131], v[96:99], v[84:87], v[116:131]
    s_add_u32 m0, s52, 32768
    s_movk_i32 s53, 1152
    buffer_load_dwordx4 v10, s[4:7], s53 offen offset:0 lds
    v_mfma_f32_32x32x16_bf16 v[148:163], v[96:99], v[88:91], v[148:163]
    buffer_load_dwordx4 v11, s[4:7], s53 offen offset:1024 lds
    s_waitcnt lgkmcnt(0)
    v_mfma_f32_32x32x16_bf16 v[100:115], v[76:79], v[68:71], v[100:115]
    ds_read_b128 v[84:87], v23 offset:0
    ds_read_b64_tr_b16 v[92:93], v31 offset:0
    ds_read_b64_tr_b16 v[94:95], v31 offset:1024
    v_mfma_f32_32x32x16_bf16 v[132:147], v[76:79], v[72:75], v[132:147]
    ds_read_b128 v[88:91], v23 offset:4096
    ds_read_b64_tr_b16 v[96:97], v33 offset:0
    ds_read_b64_tr_b16 v[98:99], v33 offset:1024
    v_mfma_f32_32x32x16_bf16 v[116:131], v[80:83], v[68:71], v[116:131]
    buffer_load_dwordx4 v12, s[4:7], s53 offen offset:2048 lds
    v_mfma_f32_32x32x16_bf16 v[148:163], v[80:83], v[72:75], v[148:163]
    buffer_load_dwordx4 v13, s[4:7], s53 offen offset:3072 lds
    v_smfmac_f32_16x16x64_bf16 v[52:55], v[36:39], v[76:83], v40
    s_waitcnt lgkmcnt(0)
    v_mfma_f32_32x32x16_bf16 v[100:115], v[92:95], v[84:87], v[100:115]
    ds_read_b128 v[68:71], v24 offset:0
    ds_read_b64_tr_b16 v[76:77], v30 offset:8192
    ds_read_b64_tr_b16 v[78:79], v30 offset:9216
    v_mfma_f32_32x32x16_bf16 v[132:147], v[92:95], v[88:91], v[132:147]
    ds_read_b128 v[72:75], v24 offset:4096
    ds_read_b64_tr_b16 v[80:81], v32 offset:8192
    ds_read_b64_tr_b16 v[82:83], v32 offset:9216
    v_mfma_f32_32x32x16_bf16 v[116:131], v[96:99], v[84:87], v[116:131]
    s_add_u32 m0, s52, 49152
    s_mov_b32 s54, 2211840
    buffer_load_dwordx4 v14, s[8:11], s54 offen offset:0 lds
    v_mfma_f32_32x32x16_bf16 v[148:163], v[96:99], v[88:91], v[148:163]
    buffer_load_dwordx4 v15, s[8:11], s54 offen offset:1024 lds
    s_waitcnt lgkmcnt(0)
    v_mfma_f32_32x32x16_bf16 v[100:115], v[76:79], v[68:71], v[100:115]
    ds_read_b128 v[84:87], v25 offset:0
    ds_read_b64_tr_b16 v[92:93], v31 offset:8192
    ds_read_b64_tr_b16 v[94:95], v31 offset:9216
    v_mfma_f32_32x32x16_bf16 v[132:147], v[76:79], v[72:75], v[132:147]
    ds_read_b128 v[88:91], v25 offset:4096
    ds_read_b64_tr_b16 v[96:97], v33 offset:8192
    ds_read_b64_tr_b16 v[98:99], v33 offset:9216
    v_mfma_f32_32x32x16_bf16 v[116:131], v[80:83], v[68:71], v[116:131]
    buffer_load_dwordx4 v16, s[8:11], s54 offen offset:2048 lds
    v_mfma_f32_32x32x16_bf16 v[148:163], v[80:83], v[72:75], v[148:163]
    buffer_load_dwordx4 v17, s[8:11], s54 offen offset:3072 lds
    v_smfmac_f32_16x16x64_bf16 v[52:55], v[36:39], v[76:83], v40
    s_waitcnt vmcnt(16) lgkmcnt(0)
    s_barrier
    v_mfma_f32_32x32x16_bf16 v[100:115], v[92:95], v[84:87], v[100:115]
    ds_read_b128 v[68:71], v22 offset:32768
    ds_read_b64_tr_b16 v[76:77], v30 offset:32768
    ds_read_b64_tr_b16 v[78:79], v30 offset:33792
    v_mfma_f32_32x32x16_bf16 v[132:147], v[92:95], v[88:91], v[132:147]
    ds_read_b128 v[72:75], v22 offset:36864
    ds_read_b64_tr_b16 v[80:81], v32 offset:32768
    ds_read_b64_tr_b16 v[82:83], v32 offset:33792
    v_mfma_f32_32x32x16_bf16 v[116:131], v[96:99], v[84:87], v[116:131]
    v_mfma_f32_32x32x16_bf16 v[148:163], v[96:99], v[88:91], v[148:163]
    s_waitcnt lgkmcnt(0)
    v_mfma_f32_32x32x16_bf16 v[100:115], v[76:79], v[68:71], v[100:115]
    ds_read_b128 v[84:87], v23 offset:32768
    ds_read_b64_tr_b16 v[92:93], v31 offset:32768
    ds_read_b64_tr_b16 v[94:95], v31 offset:33792
    v_mfma_f32_32x32x16_bf16 v[132:147], v[76:79], v[72:75], v[132:147]
    ds_read_b128 v[88:91], v23 offset:36864
    ds_read_b64_tr_b16 v[96:97], v33 offset:32768
    ds_read_b64_tr_b16 v[98:99], v33 offset:33792
    v_mfma_f32_32x32x16_bf16 v[116:131], v[80:83], v[68:71], v[116:131]
    v_mfma_f32_32x32x16_bf16 v[148:163], v[80:83], v[72:75], v[148:163]
    buffer_store_dwordx4 v[60:63], v64, s[12:15], 0 offen offset:0 sc1
    v_smfmac_f32_16x16x64_bf16 v[52:55], v[36:39], v[76:83], v40
    s_waitcnt lgkmcnt(0)
    v_mfma_f32_32x32x16_bf16 v[100:115], v[92:95], v[84:87], v[100:115]
    ds_read_b128 v[68:71], v24 offset:32768
    ds_read_b64_tr_b16 v[76:77], v30 offset:40960
    ds_read_b64_tr_b16 v[78:79], v30 offset:41984
    v_mfma_f32_32x32x16_bf16 v[132:147], v[92:95], v[88:91], v[132:147]
    ds_read_b128 v[72:75], v24 offset:36864
    ds_read_b64_tr_b16 v[80:81], v32 offset:40960
    ds_read_b64_tr_b16 v[82:83], v32 offset:41984
    v_mfma_f32_32x32x16_bf16 v[116:131], v[96:99], v[84:87], v[116:131]
    v_mfma_f32_32x32x16_bf16 v[148:163], v[96:99], v[88:91], v[148:163]
    buffer_store_dwordx4 v[60:63], v64, s[12:15], 0 offen offset:1024 sc1
    s_waitcnt lgkmcnt(0)
    v_mfma_f32_32x32x16_bf16 v[100:115], v[76:79], v[68:71], v[100:115]
    ds_read_b128 v[84:87], v25 offset:32768
    ds_read_b64_tr_b16 v[92:93], v31 offset:40960
    ds_read_b64_tr_b16 v[94:95], v31 offset:41984
    v_mfma_f32_32x32x16_bf16 v[132:147], v[76:79], v[72:75], v[132:147]
    ds_read_b128 v[88:91], v25 offset:36864
    ds_read_b64_tr_b16 v[96:97], v33 offset:40960
    ds_read_b64_tr_b16 v[98:99], v33 offset:41984
PAD_Q:
    s_cbranch_execz PAD_EQ
    v_mfma_f32_32x32x16_bf16 v[116:131], v[80:83], v[68:71], v[116:131]
    v_mfma_f32_32x32x16_bf16 v[148:163], v[80:83], v[72:75], v[148:163]
    buffer_store_dwordx4 v[60:63], v64, s[12:15], 0 offen offset:2048 sc1
    v_smfmac_f32_16x16x64_bf16 v[52:55], v[36:39], v[76:83], v40
    s_waitcnt vmcnt(11) lgkmcnt(0)
    s_barrier
    v_mfma_f32_32x32x16_bf16 v[100:115], v[92:95], v[84:87], v[100:115]
    ds_read_b128 v[68:71], v18 offset:0
    ds_read_b64_tr_b16 v[76:77], v26 offset:0
    ds_read_b64_tr_b16 v[78:79], v26 offset:1024
    v_mfma_f32_32x32x16_bf16 v[132:147], v[92:95], v[88:91], v[132:147]
    ds_read_b128 v[72:75], v18 offset:4096
    ds_read_b64_tr_b16 v[80:81], v28 offset:0
    ds_read_b64_tr_b16 v[82:83], v28 offset:1024
    v_mfma_f32_32x32x16_bf16 v[116:131], v[96:99], v[84:87], v[116:131]
    v_mfma_f32_32x32x16_bf16 v[148:163], v[96:99], v[88:91], v[148:163]
    s_waitcnt lgkmcnt(0)
    v_mfma_f32_32x32x16_bf16 v[100:115], v[76:79], v[68:71], v[100:115]
    ds_read_b128 v[84:87], v19 offset:0
    ds_read_b64_tr_b16 v[92:93], v27 offset:0
    ds_read_b64_tr_b16 v[94:95], v27 offset:1024
    v_mfma_f32_32x32x16_bf16 v[132:147], v[76:79], v[72:75], v[132:147]
    ds_read_b128 v[88:91], v19 offset:4096
    ds_read_b64_tr_b16 v[96:97], v29 offset:0
    ds_read_b64_tr_b16 v[98:99], v29 offset:1024
    v_mfma_f32_32x32x16_bf16 v[116:131], v[80:83], v[68:71], v[116:131]
    v_mfma_f32_32x32x16_bf16 v[148:163], v[80:83], v[72:75], v[148:163]
    buffer_load_dwordx4 v[56:59], v42, s[12:15], 0 offen sc1
    v_smfmac_f32_16x16x64_bf16 v[52:55], v[36:39], v[76:83], v40
    s_waitcnt lgkmcnt(0)
    v_mfma_f32_32x32x16_bf16 v[100:115], v[92:95], v[84:87], v[100:115]
    ds_read_b128 v[68:71], v20 offset:0
    ds_read_b64_tr_b16 v[76:77], v26 offset:8192
    ds_read_b64_tr_b16 v[78:79], v26 offset:9216
    v_mfma_f32_32x32x16_bf16 v[132:147], v[92:95], v[88:91], v[132:147]
    ds_read_b128 v[72:75], v20 offset:4096
    ds_read_b64_tr_b16 v[80:81], v28 offset:8192
    ds_read_b64_tr_b16 v[82:83], v28 offset:9216
    v_mfma_f32_32x32x16_bf16 v[116:131], v[96:99], v[84:87], v[116:131]
    v_mfma_f32_32x32x16_bf16 v[148:163], v[96:99], v[88:91], v[148:163]
    buffer_load_dword v41, v2, s[16:19], 0 offen sc1
    s_waitcnt lgkmcnt(0)
    v_mfma_f32_32x32x16_bf16 v[100:115], v[76:79], v[68:71], v[100:115]
    ds_read_b128 v[84:87], v21 offset:0
    ds_read_b64_tr_b16 v[92:93], v27 offset:8192
    ds_read_b64_tr_b16 v[94:95], v27 offset:9216
    v_mfma_f32_32x32x16_bf16 v[132:147], v[76:79], v[72:75], v[132:147]
    ds_read_b128 v[88:91], v21 offset:4096
    ds_read_b64_tr_b16 v[96:97], v29 offset:8192
    ds_read_b64_tr_b16 v[98:99], v29 offset:9216
    v_mfma_f32_32x32x16_bf16 v[116:131], v[80:83], v[68:71], v[116:131]
    v_mfma_f32_32x32x16_bf16 v[148:163], v[80:83], v[72:75], v[148:163]
    v_smfmac_f32_16x16x64_bf16 v[52:55], v[36:39], v[76:83], v40
    s_waitcnt vmcnt(5) lgkmcnt(0)
    s_barrier
    v_mfma_f32_32x32x16_bf16 v[100:115], v[92:95], v[84:87], v[100:115]
    ds_read_b128 v[68:71], v18 offset:32768
    ds_read_b64_tr_b16 v[76:77], v26 offset:32768
    ds_read_b64_tr_b16 v[78:79], v26 offset:33792
    v_mfma_f32_32x32x16_bf16 v[132:147], v[92:95], v[88:91], v[132:147]
    ds_read_b128 v[72:75], v18 offset:36864
    ds_read_b64_tr_b16 v[80:81], v28 offset:32768
    ds_read_b64_tr_b16 v[82:83], v28 offset:33792
    v_mfma_f32_32x32x16_bf16 v[116:131], v[96:99], v[84:87], v[116:131]
    v_mfma_f32_32x32x16_bf16 v[148:163], v[96:99], v[88:91], v[148:163]
    s_waitcnt lgkmcnt(0)
    v_smfmac_f32_16x16x64_bf16 v[52:55], v[36:39], v[76:83], v40
    v_mfma_f32_32x32x16_bf16 v[100:115], v[76:79], v[68:71], v[100:115]
    ds_read_b128 v[84:87], v20 offset:32768
    ds_read_b64_tr_b16 v[92:93], v26 offset:40960
    ds_read_b64_tr_b16 v[94:95], v26 offset:41984
    v_mfma_f32_32x32x16_bf16 v[132:147], v[76:79], v[72:75], v[132:147]
    ds_read_b128 v[88:91], v20 offset:36864
    ds_read_b64_tr_b16 v[96:97], v28 offset:40960
    ds_read_b64_tr_b16 v[98:99], v28 offset:41984
    v_mfma_f32_32x32x16_bf16 v[116:131], v[80:83], v[68:71], v[116:131]
    s_waitcnt vmcnt(0)
    v_xor_b32 v3, v58, v41
    v_xor_b32 v4, v59, v41
    v_and_b32 v5, 1, v41
    v_xor_b32 v5, 1, v5
    v_mfma_f32_32x32x16_bf16 v[148:163], v[80:83], v[72:75], v[148:163]
    v_or3_b32 v3, v3, v4, v5
    v_cmp_ne_u32 vcc, 0, v3
    s_cbranch_vccnz A_rsre_6
A_rsok_5:
    s_waitcnt lgkmcnt(0)
    v_smfmac_f32_16x16x64_bf16 v[52:55], v[36:39], v[92:99], v40
    v_mfma_f32_32x32x16_bf16 v[100:115], v[92:95], v[84:87], v[100:115]
    ds_read_b128 v[68:71], v19 offset:32768
    ds_read_b64_tr_b16 v[76:77], v27 offset:32768
    ds_read_b64_tr_b16 v[78:79], v27 offset:33792
    v_mfma_f32_32x32x16_bf16 v[132:147], v[92:95], v[88:91], v[132:147]
    ds_read_b128 v[72:75], v19 offset:36864
    ds_read_b64_tr_b16 v[80:81], v29 offset:32768
    ds_read_b64_tr_b16 v[82:83], v29 offset:33792
    v_mfma_f32_32x32x16_bf16 v[116:131], v[96:99], v[84:87], v[116:131]
    v_mul_f32 v3, s57, v56
    v_mul_f32 v4, s57, v57
    v_add_f32 v5, v52, v53
    ds_write_b32 v45, v3
    ds_write_b32 v45, v4 offset:512
    ds_write_b32 v46, v5
    v_mfma_f32_32x32x16_bf16 v[148:163], v[96:99], v[88:91], v[148:163]
    v_readfirstlane_b32 s41, v41
    s_waitcnt lgkmcnt(0)
    s_barrier
    v_mfma_f32_32x32x16_bf16 v[100:115], v[76:79], v[68:71], v[100:115]
    ds_read_b128 v[84:87], v21 offset:32768
    ds_read_b64_tr_b16 v[92:93], v27 offset:40960
    ds_read_b64_tr_b16 v[94:95], v27 offset:41984
    v_mfma_f32_32x32x16_bf16 v[132:147], v[76:79], v[72:75], v[132:147]
    ds_read_b128 v[88:91], v21 offset:36864
    ds_read_b64_tr_b16 v[96:97], v29 offset:40960
    ds_read_b64_tr_b16 v[98:99], v29 offset:41984
    v_mfma_f32_32x32x16_bf16 v[116:131], v[80:83], v[68:71], v[116:131]
    ds_read_b32 v6, v47
    ds_read_b32 v228, v49
    ds_read_b32 v229, v49 offset:512
    ds_read_b32 v230, v49 offset:128
    ds_read_b32 v231, v49 offset:640
    v_mfma_f32_32x32x16_bf16 v[148:163], v[80:83], v[72:75], v[148:163]
    s_waitcnt lgkmcnt(0)
    v_mfma_f32_32x32x16_bf16 v[100:115], v[92:95], v[84:87], v[100:115]
    v_add_f32 v5, v5, v6
    ds_write_b32 v48, v5
    ds_read_b128 v[164:167], v50 offset:0
    ds_read_b128 v[168:171], v50 offset:16
    v_mfma_f32_32x32x16_bf16 v[132:147], v[92:95], v[88:91], v[132:147]
    ds_read_b128 v[172:175], v50 offset:64
    ds_read_b128 v[176:179], v50 offset:80
    ds_read_b128 v[180:183], v50 offset:128
    ds_read_b128 v[184:187], v50 offset:144
    v_mfma_f32_32x32x16_bf16 v[116:131], v[96:99], v[84:87], v[116:131]
    ds_read_b128 v[188:191], v50 offset:192
    ds_read_b128 v[192:195], v50 offset:208
    v_mfma_f32_32x32x16_bf16 v[148:163], v[96:99], v[88:91], v[148:163]
    s_waitcnt lgkmcnt(0)
    s_nop 1
    v_pk_mul_f32 v[100:101], v[100:101], v[228:229] op_sel_hi:[1,0]
    v_pk_fma_f32 v[100:101], v[164:165], v[228:229], v[100:101] op_sel:[0,1,0] neg_lo:[0,1,0] neg_hi:[0,1,0]
    v_pk_mul_f32 v[102:103], v[102:103], v[228:229] op_sel_hi:[1,0]
    v_pk_fma_f32 v[102:103], v[166:167], v[228:229], v[102:103] op_sel:[0,1,0] neg_lo:[0,1,0] neg_hi:[0,1,0]
    v_pk_mul_f32 v[104:105], v[104:105], v[228:229] op_sel_hi:[1,0]
    v_pk_fma_f32 v[104:105], v[168:169], v[228:229], v[104:105] op_sel:[0,1,0] neg_lo:[0,1,0] neg_hi:[0,1,0]
    v_pk_mul_f32 v[106:107], v[106:107], v[228:229] op_sel_hi:[1,0]
    v_pk_fma_f32 v[106:107], v[170:171], v[228:229], v[106:107] op_sel:[0,1,0] neg_lo:[0,1,0] neg_hi:[0,1,0]
    v_pk_mul_f32 v[108:109], v[108:109], v[228:229] op_sel_hi:[1,0]
    v_pk_fma_f32 v[108:109], v[172:173], v[228:229], v[108:109] op_sel:[0,1,0] neg_lo:[0,1,0] neg_hi:[0,1,0]
    v_pk_mul_f32 v[110:111], v[110:111], v[228:229] op_sel_hi:[1,0]
    v_pk_fma_f32 v[110:111], v[174:175], v[228:229], v[110:111] op_sel:[0,1,0] neg_lo:[0,1,0] neg_hi:[0,1,0]
    v_pk_mul_f32 v[112:113], v[112:113], v[228:229] op_sel_hi:[1,0]
    v_pk_fma_f32 v[112:113], v[176:177], v[228:229], v[112:113] op_sel:[0,1,0] neg_lo:[0,1,0] neg_hi:[0,1,0]
    v_pk_mul_f32 v[114:115], v[114:115], v[228:229] op_sel_hi:[1,0]
    v_pk_fma_f32 v[114:115], v[178:179], v[228:229], v[114:115] op_sel:[0,1,0] neg_lo:[0,1,0] neg_hi:[0,1,0]
    v_cvt_pk_bf16_f32 v100, v100, v101
    v_cvt_pk_bf16_f32 v101, v102, v103
    v_cvt_pk_bf16_f32 v102, v104, v105
    v_cvt_pk_bf16_f32 v103, v106, v107
    v_cvt_pk_bf16_f32 v104, v108, v109
    v_cvt_pk_bf16_f32 v105, v110, v111
    v_cvt_pk_bf16_f32 v106, v112, v113
    v_cvt_pk_bf16_f32 v107, v114, v115
    buffer_store_dwordx4 v[100:103], v43, s[12:15], 0 offen offset:0 sc1
    buffer_store_dwordx4 v[104:107], v43, s[12:15], s56 offen offset:0 sc1
    v_pk_mul_f32 v[132:133], v[132:133], v[230:231] op_sel_hi:[1,0]
    v_pk_fma_f32 v[132:133], v[164:165], v[230:231], v[132:133] op_sel:[0,1,0] neg_lo:[0,1,0] neg_hi:[0,1,0]
    v_pk_mul_f32 v[134:135], v[134:135], v[230:231] op_sel_hi:[1,0]
    v_pk_fma_f32 v[134:135], v[166:167], v[230:231], v[134:135] op_sel:[0,1,0] neg_lo:[0,1,0] neg_hi:[0,1,0]
    v_pk_mul_f32 v[136:137], v[136:137], v[230:231] op_sel_hi:[1,0]
    v_pk_fma_f32 v[136:137], v[168:169], v[230:231], v[136:137] op_sel:[0,1,0] neg_lo:[0,1,0] neg_hi:[0,1,0]
    v_pk_mul_f32 v[138:139], v[138:139], v[230:231] op_sel_hi:[1,0]
    v_pk_fma_f32 v[138:139], v[170:171], v[230:231], v[138:139] op_sel:[0,1,0] neg_lo:[0,1,0] neg_hi:[0,1,0]
    v_pk_mul_f32 v[140:141], v[140:141], v[230:231] op_sel_hi:[1,0]
    v_pk_fma_f32 v[140:141], v[172:173], v[230:231], v[140:141] op_sel:[0,1,0] neg_lo:[0,1,0] neg_hi:[0,1,0]
    v_pk_mul_f32 v[142:143], v[142:143], v[230:231] op_sel_hi:[1,0]
    v_pk_fma_f32 v[142:143], v[174:175], v[230:231], v[142:143] op_sel:[0,1,0] neg_lo:[0,1,0] neg_hi:[0,1,0]
    v_pk_mul_f32 v[144:145], v[144:145], v[230:231] op_sel_hi:[1,0]
    v_pk_fma_f32 v[144:145], v[176:177], v[230:231], v[144:145] op_sel:[0,1,0] neg_lo:[0,1,0] neg_hi:[0,1,0]
    v_pk_mul_f32 v[146:147], v[146:147], v[230:231] op_sel_hi:[1,0]
    v_pk_fma_f32 v[146:147], v[178:179], v[230:231], v[146:147] op_sel:[0,1,0] neg_lo:[0,1,0] neg_hi:[0,1,0]
    v_cvt_pk_bf16_f32 v132, v132, v133
    v_cvt_pk_bf16_f32 v133, v134, v135
    v_cvt_pk_bf16_f32 v134, v136, v137
    v_cvt_pk_bf16_f32 v135, v138, v139
    v_cvt_pk_bf16_f32 v136, v140, v141
    v_cvt_pk_bf16_f32 v137, v142, v143
    v_cvt_pk_bf16_f32 v138, v144, v145
    v_cvt_pk_bf16_f32 v139, v146, v147
    buffer_store_dwordx4 v[132:135], v43, s[12:15], 0 offen offset:512 sc1
    buffer_store_dwordx4 v[136:139], v43, s[12:15], s56 offen offset:512 sc1
    v_pk_mul_f32 v[116:117], v[116:117], v[228:229] op_sel_hi:[1,0]
    v_pk_fma_f32 v[116:117], v[180:181], v[228:229], v[116:117] op_sel:[0,1,0] neg_lo:[0,1,0] neg_hi:[0,1,0]
    v_pk_mul_f32 v[118:119], v[118:119], v[228:229] op_sel_hi:[1,0]
    v_pk_fma_f32 v[118:119], v[182:183], v[228:229], v[118:119] op_sel:[0,1,0] neg_lo:[0,1,0] neg_hi:[0,1,0]
    v_pk_mul_f32 v[120:121], v[120:121], v[228:229] op_sel_hi:[1,0]
    v_pk_fma_f32 v[120:121], v[184:185], v[228:229], v[120:121] op_sel:[0,1,0] neg_lo:[0,1,0] neg_hi:[0,1,0]
    v_pk_mul_f32 v[122:123], v[122:123], v[228:229] op_sel_hi:[1,0]
    v_pk_fma_f32 v[122:123], v[186:187], v[228:229], v[122:123] op_sel:[0,1,0] neg_lo:[0,1,0] neg_hi:[0,1,0]
    v_pk_mul_f32 v[124:125], v[124:125], v[228:229] op_sel_hi:[1,0]
    v_pk_fma_f32 v[124:125], v[188:189], v[228:229], v[124:125] op_sel:[0,1,0] neg_lo:[0,1,0] neg_hi:[0,1,0]
    v_pk_mul_f32 v[126:127], v[126:127], v[228:229] op_sel_hi:[1,0]
    v_pk_fma_f32 v[126:127], v[190:191], v[228:229], v[126:127] op_sel:[0,1,0] neg_lo:[0,1,0] neg_hi:[0,1,0]
    v_pk_mul_f32 v[128:129], v[128:129], v[228:229] op_sel_hi:[1,0]
    v_pk_fma_f32 v[128:129], v[192:193], v[228:229], v[128:129] op_sel:[0,1,0] neg_lo:[0,1,0] neg_hi:[0,1,0]
    v_pk_mul_f32 v[130:131], v[130:131], v[228:229] op_sel_hi:[1,0]
    v_pk_fma_f32 v[130:131], v[194:195], v[228:229], v[130:131] op_sel:[0,1,0] neg_lo:[0,1,0] neg_hi:[0,1,0]
    v_cvt_pk_bf16_f32 v116, v116, v117
    v_cvt_pk_bf16_f32 v117, v118, v119
    v_cvt_pk_bf16_f32 v118, v120, v121
    v_cvt_pk_bf16_f32 v119, v122, v123
    v_cvt_pk_bf16_f32 v120, v124, v125
    v_cvt_pk_bf16_f32 v121, v126, v127
    v_cvt_pk_bf16_f32 v122, v128, v129
    v_cvt_pk_bf16_f32 v123, v130, v131
    buffer_store_dwordx4 v[116:119], v44, s[12:15], 0 offen offset:0 sc1
    buffer_store_dwordx4 v[120:123], v44, s[12:15], s56 offen offset:0 sc1
    v_pk_mul_f32 v[148:149], v[148:149], v[230:231] op_sel_hi:[1,0]
    v_pk_fma_f32 v[148:149], v[180:181], v[230:231], v[148:149] op_sel:[0,1,0] neg_lo:[0,1,0] neg_hi:[0,1,0]
    v_pk_mul_f32 v[150:151], v[150:151], v[230:231] op_sel_hi:[1,0]
    v_pk_fma_f32 v[150:151], v[182:183], v[230:231], v[150:151] op_sel:[0,1,0] neg_lo:[0,1,0] neg_hi:[0,1,0]
    v_pk_mul_f32 v[152:153], v[152:153], v[230:231] op_sel_hi:[1,0]
    v_pk_fma_f32 v[152:153], v[184:185], v[230:231], v[152:153] op_sel:[0,1,0] neg_lo:[0,1,0] neg_hi:[0,1,0]
    v_pk_mul_f32 v[154:155], v[154:155], v[230:231] op_sel_hi:[1,0]
    v_pk_fma_f32 v[154:155], v[186:187], v[230:231], v[154:155] op_sel:[0,1,0] neg_lo:[0,1,0] neg_hi:[0,1,0]
    v_pk_mul_f32 v[156:157], v[156:157], v[230:231] op_sel_hi:[1,0]
    v_pk_fma_f32 v[156:157], v[188:189], v[230:231], v[156:157] op_sel:[0,1,0] neg_lo:[0,1,0] neg_hi:[0,1,0]
    v_pk_mul_f32 v[158:159], v[158:159], v[230:231] op_sel_hi:[1,0]
    v_pk_fma_f32 v[158:159], v[190:191], v[230:231], v[158:159] op_sel:[0,1,0] neg_lo:[0,1,0] neg_hi:[0,1,0]
    v_pk_mul_f32 v[160:161], v[160:161], v[230:231] op_sel_hi:[1,0]
    v_pk_fma_f32 v[160:161], v[192:193], v[230:231], v[160:161] op_sel:[0,1,0] neg_lo:[0,1,0] neg_hi:[0,1,0]
    v_pk_mul_f32 v[162:163], v[162:163], v[230:231] op_sel_hi:[1,0]
    v_pk_fma_f32 v[162:163], v[194:195], v[230:231], v[162:163] op_sel:[0,1,0] neg_lo:[0,1,0] neg_hi:[0,1,0]
    v_cvt_pk_bf16_f32 v148, v148, v149
    v_cvt_pk_bf16_f32 v149, v150, v151
    v_cvt_pk_bf16_f32 v150, v152, v153
    v_cvt_pk_bf16_f32 v151, v154, v155
    v_cvt_pk_bf16_f32 v152, v156, v157
    v_cvt_pk_bf16_f32 v153, v158, v159
    v_cvt_pk_bf16_f32 v154, v160, v161
    v_cvt_pk_bf16_f32 v155, v162, v163
    buffer_store_dwordx4 v[148:151], v44, s[12:15], 0 offen offset:512 sc1
    buffer_store_dwordx4 v[152:155], v44, s[12:15], s56 offen offset:512 sc1
    s_branch sequential_preLN__mha_block__moe_arch_mod__prompt_kernel_edge
END_Q:
.p2align 12
sequential_preLN__mha_block__moe_arch_mod__prompt_kernel_V:
    s_lshl_b32 s44, s50, 13
    s_lshl_b32 s45, s50, 1
    v_bfe_u32 v3, v8, 1, 3
    v_xor_b32 v3, v3, v9
    v_xor_b32 v3, s45, v3
    v_lshlrev_b32 v3, 4, v3
    v_lshl_add_u32 v3, v8, 7, v3
    v_add_u32 v18, s44, v3
    s_lshl_b32 s44, s51, 1
    v_bfe_u32 v3, v1, 2, 2
    v_xor_b32 v4, s44, v3
    v_lshlrev_b32 v4, 6, v4
    v_lshl_add_u32 v3, v9, 3, v3
    v_lshl_add_u32 v4, v3, 8, v4
    v_bfe_u32 v3, v1, 4, 1
    v_lshl_add_u32 v4, v3, 5, v4
    v_and_b32 v3, 3, v1
    v_lshl_add_u32 v4, v3, 3, v4
    s_lshl_b32 s44, s50, 12
    s_add_u32 s44, s44, 16384
    v_add_u32 v26, s44, v4
    v_xor_b32 v28, 64, v26
    v_xor_b32 v27, 4096, v26
    v_xor_b32 v29, 4096, v28
    v_xor_b32 v19, 32, v18
    v_xor_b32 v20, 64, v18
    v_xor_b32 v21, 96, v18
    s_mov_b64 exec, 0
    s_branch PAD_V
RET_V:
    s_mov_b64 exec, -1
    s_waitcnt vmcnt(6)
    s_barrier
    ds_read_b128 v[68:71], v18 offset:0
    ds_read_b64_tr_b16 v[76:77], v26 offset:0
    ds_read_b64_tr_b16 v[78:79], v26 offset:1024
    ds_read_b128 v[72:75], v18 offset:4096
    ds_read_b64_tr_b16 v[80:81], v28 offset:0
    ds_read_b64_tr_b16 v[82:83], v28 offset:1024
.p2align 3
    s_waitcnt lgkmcnt(0)
    v_mfma_f32_32x32x16_bf16 v[100:115], v[68:71], v[76:79], 0
    ds_read_b128 v[84:87], v19 offset:0
    ds_read_b64_tr_b16 v[92:93], v27 offset:0
    ds_read_b64_tr_b16 v[94:95], v27 offset:1024
    v_mfma_f32_32x32x16_bf16 v[132:147], v[72:75], v[76:79], 0
    ds_read_b128 v[88:91], v19 offset:4096
    ds_read_b64_tr_b16 v[96:97], v29 offset:0
    ds_read_b64_tr_b16 v[98:99], v29 offset:1024
    s_add_u32 m0, s52, 49152
    s_mov_b32 s54, 245760
    buffer_load_dwordx4 v14, s[8:11], s54 offen offset:0 lds
    v_mfma_f32_32x32x16_bf16 v[116:131], v[68:71], v[80:83], 0
    buffer_load_dwordx4 v15, s[8:11], s54 offen offset:1024 lds
    v_add_u32 v22, 65536, v18
    v_add_u32 v23, 65536, v19
    v_mfma_f32_32x32x16_bf16 v[148:163], v[72:75], v[80:83], 0
    buffer_load_dwordx4 v16, s[8:11], s54 offen offset:2048 lds
    v_add_u32 v24, 65536, v20
    v_add_u32 v25, 65536, v21
    v_smfmac_f32_16x16x64_bf16 v[52:55], v[36:39], v[76:83], v40
    s_waitcnt lgkmcnt(0)
    v_mfma_f32_32x32x16_bf16 v[100:115], v[84:87], v[92:95], v[100:115]
    ds_read_b128 v[68:71], v20 offset:0
    ds_read_b64_tr_b16 v[76:77], v26 offset:8192
    ds_read_b64_tr_b16 v[78:79], v26 offset:9216
    v_mfma_f32_32x32x16_bf16 v[132:147], v[88:91], v[92:95], v[132:147]
    ds_read_b128 v[72:75], v20 offset:4096
    ds_read_b64_tr_b16 v[80:81], v28 offset:8192
    ds_read_b64_tr_b16 v[82:83], v28 offset:9216
    buffer_load_dwordx4 v17, s[8:11], s54 offen offset:3072 lds
    v_mfma_f32_32x32x16_bf16 v[116:131], v[84:87], v[96:99], v[116:131]
    s_add_u32 m0, s52, 65536
    s_movk_i32 s53, 256
    buffer_load_dwordx4 v10, s[4:7], s53 offen offset:0 lds
    v_add_u32 v30, 65536, v26
    v_add_u32 v31, 65536, v27
    v_mfma_f32_32x32x16_bf16 v[148:163], v[88:91], v[96:99], v[148:163]
    buffer_load_dwordx4 v11, s[4:7], s53 offen offset:1024 lds
    v_add_u32 v32, 65536, v28
    v_add_u32 v33, 65536, v29
    s_waitcnt lgkmcnt(0)
    v_mfma_f32_32x32x16_bf16 v[100:115], v[68:71], v[76:79], v[100:115]
    ds_read_b128 v[84:87], v21 offset:0
    ds_read_b64_tr_b16 v[92:93], v27 offset:8192
    ds_read_b64_tr_b16 v[94:95], v27 offset:9216
    v_mfma_f32_32x32x16_bf16 v[132:147], v[72:75], v[76:79], v[132:147]
    ds_read_b128 v[88:91], v21 offset:4096
    ds_read_b64_tr_b16 v[96:97], v29 offset:8192
    ds_read_b64_tr_b16 v[98:99], v29 offset:9216
    buffer_load_dwordx4 v12, s[4:7], s53 offen offset:2048 lds
    v_mfma_f32_32x32x16_bf16 v[116:131], v[68:71], v[80:83], v[116:131]
    buffer_load_dwordx4 v13, s[4:7], s53 offen offset:3072 lds
    s_mul_i32 s46, s2, 12288
    s_mul_i32 s45, s40, 3072
    v_mfma_f32_32x32x16_bf16 v[148:163], v[72:75], v[80:83], v[148:163]
    s_add_u32 m0, s52, 81920
    s_mov_b32 s54, 491520
    buffer_load_dwordx4 v14, s[8:11], s54 offen offset:0 lds
    s_add_u32 s46, s46, s45
    s_add_u32 s46, s46, 8912896
    v_smfmac_f32_16x16x64_bf16 v[52:55], v[36:39], v[76:83], v40
    s_waitcnt vmcnt(5) lgkmcnt(0)
    s_barrier
    v_mfma_f32_32x32x16_bf16 v[100:115], v[84:87], v[92:95], v[100:115]
    ds_read_b128 v[68:71], v18 offset:32768
    ds_read_b64_tr_b16 v[76:77], v26 offset:32768
    ds_read_b64_tr_b16 v[78:79], v26 offset:33792
    v_mfma_f32_32x32x16_bf16 v[132:147], v[88:91], v[92:95], v[132:147]
    ds_read_b128 v[72:75], v18 offset:36864
    ds_read_b64_tr_b16 v[80:81], v28 offset:32768
    ds_read_b64_tr_b16 v[82:83], v28 offset:33792
    buffer_load_dwordx4 v15, s[8:11], s54 offen offset:1024 lds
    v_mfma_f32_32x32x16_bf16 v[116:131], v[84:87], v[96:99], v[116:131]
    buffer_load_dwordx4 v16, s[8:11], s54 offen offset:2048 lds
    v_lshl_add_u32 v64, v1, 4, s46
    v_mov_b32 v60, -1
    v_mfma_f32_32x32x16_bf16 v[148:163], v[88:91], v[96:99], v[148:163]
    buffer_load_dwordx4 v17, s[8:11], s54 offen offset:3072 lds
    v_mov_b32 v61, -1
    v_mov_b32 v62, -1
    s_waitcnt lgkmcnt(0)
    v_mfma_f32_32x32x16_bf16 v[100:115], v[68:71], v[76:79], v[100:115]
    ds_read_b128 v[84:87], v19 offset:32768
    ds_read_b64_tr_b16 v[92:93], v27 offset:32768
    ds_read_b64_tr_b16 v[94:95], v27 offset:33792
    v_mfma_f32_32x32x16_bf16 v[132:147], v[72:75], v[76:79], v[132:147]
    ds_read_b128 v[88:91], v19 offset:36864
    ds_read_b64_tr_b16 v[96:97], v29 offset:32768
    ds_read_b64_tr_b16 v[98:99], v29 offset:33792
    s_add_u32 m0, s52, 98304
    s_movk_i32 s53, 384
    buffer_load_dwordx4 v10, s[4:7], s53 offen offset:0 lds
    v_mfma_f32_32x32x16_bf16 v[116:131], v[68:71], v[80:83], v[116:131]
    buffer_load_dwordx4 v11, s[4:7], s53 offen offset:1024 lds
    v_mov_b32 v63, -1
    v_add_u32 v42, s58, v7
    v_mfma_f32_32x32x16_bf16 v[148:163], v[72:75], v[80:83], v[148:163]
    buffer_load_dwordx4 v12, s[4:7], s53 offen offset:2048 lds
    v_lshlrev_b32 v42, 4, v42
    v_add_u32 v42, 12058624, v42
    v_smfmac_f32_16x16x64_bf16 v[52:55], v[36:39], v[76:83], v40
    s_waitcnt lgkmcnt(0)
    v_mfma_f32_32x32x16_bf16 v[100:115], v[84:87], v[92:95], v[100:115]
    ds_read_b128 v[68:71], v20 offset:32768
    ds_read_b64_tr_b16 v[76:77], v26 offset:40960
    ds_read_b64_tr_b16 v[78:79], v26 offset:41984
    v_mfma_f32_32x32x16_bf16 v[132:147], v[88:91], v[92:95], v[132:147]
    ds_read_b128 v[72:75], v20 offset:36864
    ds_read_b64_tr_b16 v[80:81], v28 offset:40960
    ds_read_b64_tr_b16 v[82:83], v28 offset:41984
    buffer_load_dwordx4 v13, s[4:7], s53 offen offset:3072 lds
    v_mfma_f32_32x32x16_bf16 v[116:131], v[84:87], v[96:99], v[116:131]
    s_add_u32 m0, s52, 114688
    s_mov_b32 s54, 737280
    buffer_load_dwordx4 v14, s[8:11], s54 offen offset:0 lds
    s_lshl_b32 s44, s40, 7
    s_add_u32 s44, s44, 131072
    v_mfma_f32_32x32x16_bf16 v[148:163], v[88:91], v[96:99], v[148:163]
    buffer_load_dwordx4 v15, s[8:11], s54 offen offset:1024 lds
    v_lshl_add_u32 v45, v7, 2, s44
    s_lshl_b32 s45, s51, 8
    s_waitcnt lgkmcnt(0)
    v_mfma_f32_32x32x16_bf16 v[100:115], v[68:71], v[76:79], v[100:115]
    ds_read_b128 v[84:87], v21 offset:32768
    ds_read_b64_tr_b16 v[92:93], v27 offset:40960
    ds_read_b64_tr_b16 v[94:95], v27 offset:41984
    v_mfma_f32_32x32x16_bf16 v[132:147], v[72:75], v[76:79], v[132:147]
    ds_read_b128 v[88:91], v21 offset:36864
    ds_read_b64_tr_b16 v[96:97], v29 offset:40960
    ds_read_b64_tr_b16 v[98:99], v29 offset:41984
    buffer_load_dwordx4 v16, s[8:11], s54 offen offset:2048 lds
    v_mfma_f32_32x32x16_bf16 v[116:131], v[68:71], v[80:83], v[116:131]
    buffer_load_dwordx4 v17, s[8:11], s54 offen offset:3072 lds
    s_add_u32 s45, s45, 132096
    s_lshl_b32 s46, s50, 9
    v_mfma_f32_32x32x16_bf16 v[148:163], v[72:75], v[80:83], v[148:163]
    s_add_u32 m0, s52, 0
    s_movk_i32 s53, 512
    buffer_load_dwordx4 v10, s[4:7], s53 offen offset:0 lds
    s_add_u32 s46, s46, s45
    v_lshl_add_u32 v6, v9, 5, v7
    v_smfmac_f32_16x16x64_bf16 v[52:55], v[36:39], v[76:83], v40
    s_waitcnt vmcnt(9) lgkmcnt(0)
    s_barrier
    v_mfma_f32_32x32x16_bf16 v[100:115], v[84:87], v[92:95], v[100:115]
    ds_read_b128 v[68:71], v22 offset:0
    ds_read_b64_tr_b16 v[76:77], v30 offset:0
    ds_read_b64_tr_b16 v[78:79], v30 offset:1024
    v_mfma_f32_32x32x16_bf16 v[132:147], v[88:91], v[92:95], v[132:147]
    ds_read_b128 v[72:75], v22 offset:4096
    ds_read_b64_tr_b16 v[80:81], v32 offset:0
    ds_read_b64_tr_b16 v[82:83], v32 offset:1024
    buffer_load_dwordx4 v11, s[4:7], s53 offen offset:1024 lds
    v_mfma_f32_32x32x16_bf16 v[116:131], v[84:87], v[96:99], v[116:131]
    buffer_load_dwordx4 v12, s[4:7], s53 offen offset:2048 lds
    v_lshl_add_u32 v46, v6, 2, s46
    v_xor_b32 v47, 512, v46
    v_mfma_f32_32x32x16_bf16 v[148:163], v[88:91], v[96:99], v[148:163]
    buffer_load_dwordx4 v13, s[4:7], s53 offen offset:3072 lds
    s_lshl_b32 s46, s40, 8
    s_add_u32 s46, s46, 133120
    s_waitcnt lgkmcnt(0)
    v_mfma_f32_32x32x16_bf16 v[100:115], v[68:71], v[76:79], v[100:115]
    ds_read_b128 v[84:87], v23 offset:0
    ds_read_b64_tr_b16 v[92:93], v31 offset:0
    ds_read_b64_tr_b16 v[94:95], v31 offset:1024
    v_mfma_f32_32x32x16_bf16 v[132:147], v[72:75], v[76:79], v[132:147]
    ds_read_b128 v[88:91], v23 offset:4096
    ds_read_b64_tr_b16 v[96:97], v33 offset:0
    ds_read_b64_tr_b16 v[98:99], v33 offset:1024
    s_add_u32 m0, s52, 16384
    s_mov_b32 s54, 983040
    buffer_load_dwordx4 v14, s[8:11], s54 offen offset:0 lds
    v_mfma_f32_32x32x16_bf16 v[116:131], v[68:71], v[80:83], v[116:131]
    buffer_load_dwordx4 v15, s[8:11], s54 offen offset:1024 lds
    v_lshl_add_u32 v48, v6, 2, s46
    s_lshl_b32 s44, s50, 8
    v_mfma_f32_32x32x16_bf16 v[148:163], v[72:75], v[80:83], v[148:163]
    buffer_load_dwordx4 v16, s[8:11], s54 offen offset:2048 lds
    s_add_u32 s44, s44, 131072
    v_lshl_add_u32 v49, v7, 2, s45
    v_smfmac_f32_16x16x64_bf16 v[52:55], v[36:39], v[76:83], v40
    s_waitcnt lgkmcnt(0)
    v_mfma_f32_32x32x16_bf16 v[100:115], v[84:87], v[92:95], v[100:115]
    ds_read_b128 v[68:71], v24 offset:0
    ds_read_b64_tr_b16 v[76:77], v30 offset:8192
    ds_read_b64_tr_b16 v[78:79], v30 offset:9216
    v_mfma_f32_32x32x16_bf16 v[132:147], v[88:91], v[92:95], v[132:147]
    ds_read_b128 v[72:75], v24 offset:4096
    ds_read_b64_tr_b16 v[80:81], v32 offset:8192
    ds_read_b64_tr_b16 v[82:83], v32 offset:9216
    buffer_load_dwordx4 v17, s[8:11], s54 offen offset:3072 lds
    v_mfma_f32_32x32x16_bf16 v[116:131], v[84:87], v[96:99], v[116:131]
    s_add_u32 m0, s52, 32768
    s_movk_i32 s53, 640
    buffer_load_dwordx4 v10, s[4:7], s53 offen offset:0 lds
    v_lshl_add_u32 v50, v9, 5, s44
    s_sub_u32 s44, s49, 10
    v_mfma_f32_32x32x16_bf16 v[148:163], v[88:91], v[96:99], v[148:163]
    buffer_load_dwordx4 v11, s[4:7], s53 offen offset:1024 lds
    s_lshl_b32 s44, s44, 7
    s_lshl_b32 s45, s51, 6
    s_waitcnt lgkmcnt(0)
    v_mfma_f32_32x32x16_bf16 v[100:115], v[68:71], v[76:79], v[100:115]
    ds_read_b128 v[84:87], v25 offset:0
    ds_read_b64_tr_b16 v[92:93], v31 offset:8192
    ds_read_b64_tr_b16 v[94:95], v31 offset:9216
    v_mfma_f32_32x32x16_bf16 v[132:147], v[72:75], v[76:79], v[132:147]
    ds_read_b128 v[88:91], v25 offset:4096
    ds_read_b64_tr_b16 v[96:97], v33 offset:8192
    ds_read_b64_tr_b16 v[98:99], v33 offset:9216
    buffer_load_dwordx4 v12, s[4:7], s53 offen offset:2048 lds
    v_mfma_f32_32x32x16_bf16 v[116:131], v[68:71], v[80:83], v[116:131]
    buffer_load_dwordx4 v13, s[4:7], s53 offen offset:3072 lds
    s_add_u32 s44, s44, s45
    v_add_u32 v3, s44, v7
    v_mfma_f32_32x32x16_bf16 v[148:163], v[72:75], v[80:83], v[148:163]
    s_add_u32 m0, s52, 49152
    s_mov_b32 s54, 1228800
    buffer_load_dwordx4 v14, s[8:11], s54 offen offset:0 lds
    v_add_u32 v4, 32, v3
    s_mov_b32 s45, 84416
    v_smfmac_f32_16x16x64_bf16 v[52:55], v[36:39], v[76:83], v40
    s_waitcnt vmcnt(13) lgkmcnt(0)
    s_barrier
    v_mfma_f32_32x32x16_bf16 v[100:115], v[84:87], v[92:95], v[100:115]
    ds_read_b128 v[68:71], v22 offset:32768
    ds_read_b64_tr_b16 v[76:77], v30 offset:32768
    ds_read_b64_tr_b16 v[78:79], v30 offset:33792
    v_mfma_f32_32x32x16_bf16 v[132:147], v[88:91], v[92:95], v[132:147]
    ds_read_b128 v[72:75], v22 offset:36864
    ds_read_b64_tr_b16 v[80:81], v32 offset:32768
    ds_read_b64_tr_b16 v[82:83], v32 offset:33792
    buffer_load_dwordx4 v15, s[8:11], s54 offen offset:1024 lds
    v_mfma_f32_32x32x16_bf16 v[116:131], v[84:87], v[96:99], v[116:131]
    buffer_load_dwordx4 v16, s[8:11], s54 offen offset:2048 lds
    v_mul_u32_u24 v5, 3277, v3
    v_lshrrev_b32 v5, 16, v5
    v_mfma_f32_32x32x16_bf16 v[148:163], v[88:91], v[96:99], v[148:163]
    buffer_load_dwordx4 v17, s[8:11], s54 offen offset:3072 lds
    v_mul_u32_u24 v5, s45, v5
    v_lshl_add_u32 v43, v3, 4, v5
    s_waitcnt lgkmcnt(0)
    v_mfma_f32_32x32x16_bf16 v[100:115], v[68:71], v[76:79], v[100:115]
    ds_read_b128 v[84:87], v23 offset:32768
    ds_read_b64_tr_b16 v[92:93], v31 offset:32768
    ds_read_b64_tr_b16 v[94:95], v31 offset:33792
    v_mfma_f32_32x32x16_bf16 v[132:147], v[72:75], v[76:79], v[132:147]
    ds_read_b128 v[88:91], v23 offset:36864
    ds_read_b64_tr_b16 v[96:97], v33 offset:32768
    ds_read_b64_tr_b16 v[98:99], v33 offset:33792
    s_add_u32 m0, s52, 65536
    s_movk_i32 s53, 768
    buffer_load_dwordx4 v10, s[4:7], s53 offen offset:0 lds
    v_mfma_f32_32x32x16_bf16 v[116:131], v[68:71], v[80:83], v[116:131]
    buffer_load_dwordx4 v11, s[4:7], s53 offen offset:1024 lds
    v_mul_u32_u24 v5, 3277, v4
    v_lshrrev_b32 v5, 16, v5
    v_mfma_f32_32x32x16_bf16 v[148:163], v[72:75], v[80:83], v[148:163]
    buffer_load_dwordx4 v12, s[4:7], s53 offen offset:2048 lds
    v_mul_u32_u24 v5, s45, v5
    v_lshl_add_u32 v44, v4, 4, v5
    v_smfmac_f32_16x16x64_bf16 v[52:55], v[36:39], v[76:83], v40
    s_waitcnt lgkmcnt(0)
    v_mfma_f32_32x32x16_bf16 v[100:115], v[84:87], v[92:95], v[100:115]
    ds_read_b128 v[68:71], v24 offset:32768
    ds_read_b64_tr_b16 v[76:77], v30 offset:40960
    ds_read_b64_tr_b16 v[78:79], v30 offset:41984
    v_mfma_f32_32x32x16_bf16 v[132:147], v[88:91], v[92:95], v[132:147]
    ds_read_b128 v[72:75], v24 offset:36864
    ds_read_b64_tr_b16 v[80:81], v32 offset:40960
    ds_read_b64_tr_b16 v[82:83], v32 offset:41984
    buffer_load_dwordx4 v13, s[4:7], s53 offen offset:3072 lds
    v_mfma_f32_32x32x16_bf16 v[116:131], v[84:87], v[96:99], v[116:131]
    s_add_u32 m0, s52, 81920
    s_mov_b32 s54, 1474560
    buffer_load_dwordx4 v14, s[8:11], s54 offen offset:0 lds
    s_lshl_b32 s44, s48, 4
    s_lshl_b32 s45, s50, 3
    v_mfma_f32_32x32x16_bf16 v[148:163], v[88:91], v[96:99], v[148:163]
    buffer_load_dwordx4 v15, s[8:11], s54 offen offset:1024 lds
    s_add_u32 s44, s44, s45
    s_mul_i32 s44, s44, 320
    s_waitcnt lgkmcnt(0)
    v_mfma_f32_32x32x16_bf16 v[100:115], v[68:71], v[76:79], v[100:115]
    ds_read_b128 v[84:87], v25 offset:32768
    ds_read_b64_tr_b16 v[92:93], v31 offset:40960
    ds_read_b64_tr_b16 v[94:95], v31 offset:41984
    v_mfma_f32_32x32x16_bf16 v[132:147], v[72:75], v[76:79], v[132:147]
    ds_read_b128 v[88:91], v25 offset:36864
    ds_read_b64_tr_b16 v[96:97], v33 offset:40960
    ds_read_b64_tr_b16 v[98:99], v33 offset:41984
    v_mfma_f32_32x32x16_bf16 v[116:131], v[68:71], v[80:83], v[116:131]
    buffer_load_dwordx4 v16, s[8:11], s54 offen offset:2048 lds
    s_add_u32 s56, s44, 5767168
    v_mul_u32_u24 v5, 320, v9
    v_mfma_f32_32x32x16_bf16 v[148:163], v[72:75], v[80:83], v[148:163]
    buffer_load_dwordx4 v17, s[8:11], s54 offen offset:3072 lds
    v_add_u32 v43, v43, v5
    v_add_u32 v44, v44, v5
    v_smfmac_f32_16x16x64_bf16 v[52:55], v[36:39], v[76:83], v40
    s_waitcnt vmcnt(16) lgkmcnt(0)
    s_barrier
    v_mfma_f32_32x32x16_bf16 v[100:115], v[84:87], v[92:95], v[100:115]
    ds_read_b128 v[68:71], v18 offset:0
    ds_read_b64_tr_b16 v[76:77], v26 offset:0
    ds_read_b64_tr_b16 v[78:79], v26 offset:1024
    v_mfma_f32_32x32x16_bf16 v[132:147], v[88:91], v[92:95], v[132:147]
    ds_read_b128 v[72:75], v18 offset:4096
    ds_read_b64_tr_b16 v[80:81], v28 offset:0
    ds_read_b64_tr_b16 v[82:83], v28 offset:1024
    v_mfma_f32_32x32x16_bf16 v[116:131], v[84:87], v[96:99], v[116:131]
    s_add_u32 m0, s52, 98304
    s_movk_i32 s53, 896
    buffer_load_dwordx4 v10, s[4:7], s53 offen offset:0 lds
    v_mfma_f32_32x32x16_bf16 v[148:163], v[88:91], v[96:99], v[148:163]
    buffer_load_dwordx4 v11, s[4:7], s53 offen offset:1024 lds
    s_waitcnt lgkmcnt(0)
    v_mfma_f32_32x32x16_bf16 v[100:115], v[68:71], v[76:79], v[100:115]
    ds_read_b128 v[84:87], v19 offset:0
    ds_read_b64_tr_b16 v[92:93], v27 offset:0
    ds_read_b64_tr_b16 v[94:95], v27 offset:1024
    v_mfma_f32_32x32x16_bf16 v[132:147], v[72:75], v[76:79], v[132:147]
    ds_read_b128 v[88:91], v19 offset:4096
    ds_read_b64_tr_b16 v[96:97], v29 offset:0
    ds_read_b64_tr_b16 v[98:99], v29 offset:1024
    v_mfma_f32_32x32x16_bf16 v[116:131], v[68:71], v[80:83], v[116:131]
    buffer_load_dwordx4 v12, s[4:7], s53 offen offset:2048 lds
    v_mfma_f32_32x32x16_bf16 v[148:163], v[72:75], v[80:83], v[148:163]
    buffer_load_dwordx4 v13, s[4:7], s53 offen offset:3072 lds
    v_smfmac_f32_16x16x64_bf16 v[52:55], v[36:39], v[76:83], v40
    s_waitcnt lgkmcnt(0)
    v_mfma_f32_32x32x16_bf16 v[100:115], v[84:87], v[92:95], v[100:115]
    ds_read_b128 v[68:71], v20 offset:0
    ds_read_b64_tr_b16 v[76:77], v26 offset:8192
    ds_read_b64_tr_b16 v[78:79], v26 offset:9216
    v_mfma_f32_32x32x16_bf16 v[132:147], v[88:91], v[92:95], v[132:147]
    ds_read_b128 v[72:75], v20 offset:4096
    ds_read_b64_tr_b16 v[80:81], v28 offset:8192
    ds_read_b64_tr_b16 v[82:83], v28 offset:9216
    v_mfma_f32_32x32x16_bf16 v[116:131], v[84:87], v[96:99], v[116:131]
    s_add_u32 m0, s52, 114688
    s_mov_b32 s54, 1720320
    buffer_load_dwordx4 v14, s[8:11], s54 offen offset:0 lds
    v_mfma_f32_32x32x16_bf16 v[148:163], v[88:91], v[96:99], v[148:163]
    buffer_load_dwordx4 v15, s[8:11], s54 offen offset:1024 lds
    s_waitcnt lgkmcnt(0)
    v_mfma_f32_32x32x16_bf16 v[100:115], v[68:71], v[76:79], v[100:115]
    ds_read_b128 v[84:87], v21 offset:0
    ds_read_b64_tr_b16 v[92:93], v27 offset:8192
    ds_read_b64_tr_b16 v[94:95], v27 offset:9216
    v_mfma_f32_32x32x16_bf16 v[132:147], v[72:75], v[76:79], v[132:147]
    ds_read_b128 v[88:91], v21 offset:4096
    ds_read_b64_tr_b16 v[96:97], v29 offset:8192
    ds_read_b64_tr_b16 v[98:99], v29 offset:9216
    v_mfma_f32_32x32x16_bf16 v[116:131], v[68:71], v[80:83], v[116:131]
    buffer_load_dwordx4 v16, s[8:11], s54 offen offset:2048 lds
    v_mfma_f32_32x32x16_bf16 v[148:163], v[72:75], v[80:83], v[148:163]
    buffer_load_dwordx4 v17, s[8:11], s54 offen offset:3072 lds
    v_smfmac_f32_16x16x64_bf16 v[52:55], v[36:39], v[76:83], v40
    s_waitcnt vmcnt(16) lgkmcnt(0)
    s_barrier
    v_mfma_f32_32x32x16_bf16 v[100:115], v[84:87], v[92:95], v[100:115]
    ds_read_b128 v[68:71], v18 offset:32768
    ds_read_b64_tr_b16 v[76:77], v26 offset:32768
    ds_read_b64_tr_b16 v[78:79], v26 offset:33792
    v_mfma_f32_32x32x16_bf16 v[132:147], v[88:91], v[92:95], v[132:147]
    ds_read_b128 v[72:75], v18 offset:36864
    ds_read_b64_tr_b16 v[80:81], v28 offset:32768
    ds_read_b64_tr_b16 v[82:83], v28 offset:33792
    v_mfma_f32_32x32x16_bf16 v[116:131], v[84:87], v[96:99], v[116:131]
    s_add_u32 m0, s52, 0
    s_movk_i32 s53, 1024
    buffer_load_dwordx4 v10, s[4:7], s53 offen offset:0 lds
    v_mfma_f32_32x32x16_bf16 v[148:163], v[88:91], v[96:99], v[148:163]
    buffer_load_dwordx4 v11, s[4:7], s53 offen offset:1024 lds
    s_waitcnt lgkmcnt(0)
    v_mfma_f32_32x32x16_bf16 v[100:115], v[68:71], v[76:79], v[100:115]
    ds_read_b128 v[84:87], v19 offset:32768
    ds_read_b64_tr_b16 v[92:93], v27 offset:32768
    ds_read_b64_tr_b16 v[94:95], v27 offset:33792
    v_mfma_f32_32x32x16_bf16 v[132:147], v[72:75], v[76:79], v[132:147]
    ds_read_b128 v[88:91], v19 offset:36864
    ds_read_b64_tr_b16 v[96:97], v29 offset:32768
    ds_read_b64_tr_b16 v[98:99], v29 offset:33792
    v_mfma_f32_32x32x16_bf16 v[116:131], v[68:71], v[80:83], v[116:131]
    buffer_load_dwordx4 v12, s[4:7], s53 offen offset:2048 lds
    v_mfma_f32_32x32x16_bf16 v[148:163], v[72:75], v[80:83], v[148:163]
    buffer_load_dwordx4 v13, s[4:7], s53 offen offset:3072 lds
    v_smfmac_f32_16x16x64_bf16 v[52:55], v[36:39], v[76:83], v40
    s_waitcnt lgkmcnt(0)
    v_mfma_f32_32x32x16_bf16 v[100:115], v[84:87], v[92:95], v[100:115]
    ds_read_b128 v[68:71], v20 offset:32768
    ds_read_b64_tr_b16 v[76:77], v26 offset:40960
    ds_read_b64_tr_b16 v[78:79], v26 offset:41984
    v_mfma_f32_32x32x16_bf16 v[132:147], v[88:91], v[92:95], v[132:147]
    ds_read_b128 v[72:75], v20 offset:36864
    ds_read_b64_tr_b16 v[80:81], v28 offset:40960
    ds_read_b64_tr_b16 v[82:83], v28 offset:41984
    v_mfma_f32_32x32x16_bf16 v[116:131], v[84:87], v[96:99], v[116:131]
    s_add_u32 m0, s52, 16384
    s_mov_b32 s54, 1966080
    buffer_load_dwordx4 v14, s[8:11], s54 offen offset:0 lds
    v_mfma_f32_32x32x16_bf16 v[148:163], v[88:91], v[96:99], v[148:163]
    buffer_load_dwordx4 v15, s[8:11], s54 offen offset:1024 lds
    s_waitcnt lgkmcnt(0)
    v_mfma_f32_32x32x16_bf16 v[100:115], v[68:71], v[76:79], v[100:115]
    ds_read_b128 v[84:87], v21 offset:32768
    ds_read_b64_tr_b16 v[92:93], v27 offset:40960
    ds_read_b64_tr_b16 v[94:95], v27 offset:41984
    v_mfma_f32_32x32x16_bf16 v[132:147], v[72:75], v[76:79], v[132:147]
    ds_read_b128 v[88:91], v21 offset:36864
    ds_read_b64_tr_b16 v[96:97], v29 offset:40960
    ds_read_b64_tr_b16 v[98:99], v29 offset:41984
    v_mfma_f32_32x32x16_bf16 v[116:131], v[68:71], v[80:83], v[116:131]
    buffer_load_dwordx4 v16, s[8:11], s54 offen offset:2048 lds
    v_mfma_f32_32x32x16_bf16 v[148:163], v[72:75], v[80:83], v[148:163]
    buffer_load_dwordx4 v17, s[8:11], s54 offen offset:3072 lds
    v_smfmac_f32_16x16x64_bf16 v[52:55], v[36:39], v[76:83], v40
    s_waitcnt vmcnt(16) lgkmcnt(0)
    s_barrier
    v_mfma_f32_32x32x16_bf16 v[100:115], v[84:87], v[92:95], v[100:115]
    ds_read_b128 v[68:71], v22 offset:0
    ds_read_b64_tr_b16 v[76:77], v30 offset:0
    ds_read_b64_tr_b16 v[78:79], v30 offset:1024
    v_mfma_f32_32x32x16_bf16 v[132:147], v[88:91], v[92:95], v[132:147]
    ds_read_b128 v[72:75], v22 offset:4096
    ds_read_b64_tr_b16 v[80:81], v32 offset:0
    ds_read_b64_tr_b16 v[82:83], v32 offset:1024
    v_mfma_f32_32x32x16_bf16 v[116:131], v[84:87], v[96:99], v[116:131]
    s_add_u32 m0, s52, 32768
    s_movk_i32 s53, 1152
    buffer_load_dwordx4 v10, s[4:7], s53 offen offset:0 lds
    v_mfma_f32_32x32x16_bf16 v[148:163], v[88:91], v[96:99], v[148:163]
    buffer_load_dwordx4 v11, s[4:7], s53 offen offset:1024 lds
    s_waitcnt lgkmcnt(0)
    v_mfma_f32_32x32x16_bf16 v[100:115], v[68:71], v[76:79], v[100:115]
    ds_read_b128 v[84:87], v23 offset:0
    ds_read_b64_tr_b16 v[92:93], v31 offset:0
    ds_read_b64_tr_b16 v[94:95], v31 offset:1024
    v_mfma_f32_32x32x16_bf16 v[132:147], v[72:75], v[76:79], v[132:147]
    ds_read_b128 v[88:91], v23 offset:4096
    ds_read_b64_tr_b16 v[96:97], v33 offset:0
    ds_read_b64_tr_b16 v[98:99], v33 offset:1024
    v_mfma_f32_32x32x16_bf16 v[116:131], v[68:71], v[80:83], v[116:131]
    buffer_load_dwordx4 v12, s[4:7], s53 offen offset:2048 lds
    v_mfma_f32_32x32x16_bf16 v[148:163], v[72:75], v[80:83], v[148:163]
    buffer_load_dwordx4 v13, s[4:7], s53 offen offset:3072 lds
    v_smfmac_f32_16x16x64_bf16 v[52:55], v[36:39], v[76:83], v40
    s_waitcnt lgkmcnt(0)
    v_mfma_f32_32x32x16_bf16 v[100:115], v[84:87], v[92:95], v[100:115]
    ds_read_b128 v[68:71], v24 offset:0
    ds_read_b64_tr_b16 v[76:77], v30 offset:8192
    ds_read_b64_tr_b16 v[78:79], v30 offset:9216
    v_mfma_f32_32x32x16_bf16 v[132:147], v[88:91], v[92:95], v[132:147]
    ds_read_b128 v[72:75], v24 offset:4096
    ds_read_b64_tr_b16 v[80:81], v32 offset:8192
    ds_read_b64_tr_b16 v[82:83], v32 offset:9216
    v_mfma_f32_32x32x16_bf16 v[116:131], v[84:87], v[96:99], v[116:131]
    s_add_u32 m0, s52, 49152
    s_mov_b32 s54, 2211840
    buffer_load_dwordx4 v14, s[8:11], s54 offen offset:0 lds
    v_mfma_f32_32x32x16_bf16 v[148:163], v[88:91], v[96:99], v[148:163]
    buffer_load_dwordx4 v15, s[8:11], s54 offen offset:1024 lds
    s_waitcnt lgkmcnt(0)
    v_mfma_f32_32x32x16_bf16 v[100:115], v[68:71], v[76:79], v[100:115]
    ds_read_b128 v[84:87], v25 offset:0
    ds_read_b64_tr_b16 v[92:93], v31 offset:8192
    ds_read_b64_tr_b16 v[94:95], v31 offset:9216
    v_mfma_f32_32x32x16_bf16 v[132:147], v[72:75], v[76:79], v[132:147]
    ds_read_b128 v[88:91], v25 offset:4096
    ds_read_b64_tr_b16 v[96:97], v33 offset:8192
    ds_read_b64_tr_b16 v[98:99], v33 offset:9216
    v_mfma_f32_32x32x16_bf16 v[116:131], v[68:71], v[80:83], v[116:131]
    buffer_load_dwordx4 v16, s[8:11], s54 offen offset:2048 lds
    v_mfma_f32_32x32x16_bf16 v[148:163], v[72:75], v[80:83], v[148:163]
    buffer_load_dwordx4 v17, s[8:11], s54 offen offset:3072 lds
    v_smfmac_f32_16x16x64_bf16 v[52:55], v[36:39], v[76:83], v40
    s_waitcnt vmcnt(16) lgkmcnt(0)
    s_barrier
    v_mfma_f32_32x32x16_bf16 v[100:115], v[84:87], v[92:95], v[100:115]
    ds_read_b128 v[68:71], v22 offset:32768
    ds_read_b64_tr_b16 v[76:77], v30 offset:32768
    ds_read_b64_tr_b16 v[78:79], v30 offset:33792
    v_mfma_f32_32x32x16_bf16 v[132:147], v[88:91], v[92:95], v[132:147]
    ds_read_b128 v[72:75], v22 offset:36864
    ds_read_b64_tr_b16 v[80:81], v32 offset:32768
    ds_read_b64_tr_b16 v[82:83], v32 offset:33792
    v_mfma_f32_32x32x16_bf16 v[116:131], v[84:87], v[96:99], v[116:131]
    v_mfma_f32_32x32x16_bf16 v[148:163], v[88:91], v[96:99], v[148:163]
    s_waitcnt lgkmcnt(0)
    v_mfma_f32_32x32x16_bf16 v[100:115], v[68:71], v[76:79], v[100:115]
    ds_read_b128 v[84:87], v23 offset:32768
    ds_read_b64_tr_b16 v[92:93], v31 offset:32768
    ds_read_b64_tr_b16 v[94:95], v31 offset:33792
    v_mfma_f32_32x32x16_bf16 v[132:147], v[72:75], v[76:79], v[132:147]
    ds_read_b128 v[88:91], v23 offset:36864
    ds_read_b64_tr_b16 v[96:97], v33 offset:32768
    ds_read_b64_tr_b16 v[98:99], v33 offset:33792
    v_mfma_f32_32x32x16_bf16 v[116:131], v[68:71], v[80:83], v[116:131]
    v_mfma_f32_32x32x16_bf16 v[148:163], v[72:75], v[80:83], v[148:163]
    buffer_store_dwordx4 v[60:63], v64, s[12:15], 0 offen offset:0 sc1
    v_smfmac_f32_16x16x64_bf16 v[52:55], v[36:39], v[76:83], v40
    s_waitcnt lgkmcnt(0)
    v_mfma_f32_32x32x16_bf16 v[100:115], v[84:87], v[92:95], v[100:115]
    ds_read_b128 v[68:71], v24 offset:32768
    ds_read_b64_tr_b16 v[76:77], v30 offset:40960
    ds_read_b64_tr_b16 v[78:79], v30 offset:41984
    v_mfma_f32_32x32x16_bf16 v[132:147], v[88:91], v[92:95], v[132:147]
    ds_read_b128 v[72:75], v24 offset:36864
    ds_read_b64_tr_b16 v[80:81], v32 offset:40960
    ds_read_b64_tr_b16 v[82:83], v32 offset:41984
    v_mfma_f32_32x32x16_bf16 v[116:131], v[84:87], v[96:99], v[116:131]
    v_mfma_f32_32x32x16_bf16 v[148:163], v[88:91], v[96:99], v[148:163]
    buffer_store_dwordx4 v[60:63], v64, s[12:15], 0 offen offset:1024 sc1
    s_waitcnt lgkmcnt(0)
    v_mfma_f32_32x32x16_bf16 v[100:115], v[68:71], v[76:79], v[100:115]
    ds_read_b128 v[84:87], v25 offset:32768
    ds_read_b64_tr_b16 v[92:93], v31 offset:40960
    ds_read_b64_tr_b16 v[94:95], v31 offset:41984
    v_mfma_f32_32x32x16_bf16 v[132:147], v[72:75], v[76:79], v[132:147]
PAD_V:
    s_cbranch_execz PAD_EV
    ds_read_b128 v[88:91], v25 offset:36864
    ds_read_b64_tr_b16 v[96:97], v33 offset:40960
    ds_read_b64_tr_b16 v[98:99], v33 offset:41984
    v_mfma_f32_32x32x16_bf16 v[116:131], v[68:71], v[80:83], v[116:131]
    v_mfma_f32_32x32x16_bf16 v[148:163], v[72:75], v[80:83], v[148:163]
    buffer_store_dwordx4 v[60:63], v64, s[12:15], 0 offen offset:2048 sc1
    v_smfmac_f32_16x16x64_bf16 v[52:55], v[36:39], v[76:83], v40
    s_waitcnt vmcnt(11) lgkmcnt(0)
    s_barrier
    v_mfma_f32_32x32x16_bf16 v[100:115], v[84:87], v[92:95], v[100:115]
    ds_read_b128 v[68:71], v18 offset:0
    ds_read_b64_tr_b16 v[76:77], v26 offset:0
    ds_read_b64_tr_b16 v[78:79], v26 offset:1024
    v_mfma_f32_32x32x16_bf16 v[132:147], v[88:91], v[92:95], v[132:147]
    ds_read_b128 v[72:75], v18 offset:4096
    ds_read_b64_tr_b16 v[80:81], v28 offset:0
    ds_read_b64_tr_b16 v[82:83], v28 offset:1024
    v_mfma_f32_32x32x16_bf16 v[116:131], v[84:87], v[96:99], v[116:131]
    v_mfma_f32_32x32x16_bf16 v[148:163], v[88:91], v[96:99], v[148:163]
    s_waitcnt lgkmcnt(0)
    v_mfma_f32_32x32x16_bf16 v[100:115], v[68:71], v[76:79], v[100:115]
    ds_read_b128 v[84:87], v19 offset:0
    ds_read_b64_tr_b16 v[92:93], v27 offset:0
    ds_read_b64_tr_b16 v[94:95], v27 offset:1024
    v_mfma_f32_32x32x16_bf16 v[132:147], v[72:75], v[76:79], v[132:147]
    ds_read_b128 v[88:91], v19 offset:4096
    ds_read_b64_tr_b16 v[96:97], v29 offset:0
    ds_read_b64_tr_b16 v[98:99], v29 offset:1024
    v_mfma_f32_32x32x16_bf16 v[116:131], v[68:71], v[80:83], v[116:131]
    v_mfma_f32_32x32x16_bf16 v[148:163], v[72:75], v[80:83], v[148:163]
    buffer_load_dwordx4 v[56:59], v42, s[12:15], 0 offen sc1
    v_smfmac_f32_16x16x64_bf16 v[52:55], v[36:39], v[76:83], v40
    s_waitcnt lgkmcnt(0)
    v_mfma_f32_32x32x16_bf16 v[100:115], v[84:87], v[92:95], v[100:115]
    ds_read_b128 v[68:71], v20 offset:0
    ds_read_b64_tr_b16 v[76:77], v26 offset:8192
    ds_read_b64_tr_b16 v[78:79], v26 offset:9216
    v_mfma_f32_32x32x16_bf16 v[132:147], v[88:91], v[92:95], v[132:147]
    ds_read_b128 v[72:75], v20 offset:4096
    ds_read_b64_tr_b16 v[80:81], v28 offset:8192
    ds_read_b64_tr_b16 v[82:83], v28 offset:9216
    v_mfma_f32_32x32x16_bf16 v[116:131], v[84:87], v[96:99], v[116:131]
    v_mfma_f32_32x32x16_bf16 v[148:163], v[88:91], v[96:99], v[148:163]
    buffer_load_dword v41, v2, s[16:19], 0 offen sc1
    s_waitcnt lgkmcnt(0)
    v_mfma_f32_32x32x16_bf16 v[100:115], v[68:71], v[76:79], v[100:115]
    ds_read_b128 v[84:87], v21 offset:0
    ds_read_b64_tr_b16 v[92:93], v27 offset:8192
    ds_read_b64_tr_b16 v[94:95], v27 offset:9216
    v_mfma_f32_32x32x16_bf16 v[132:147], v[72:75], v[76:79], v[132:147]
    ds_read_b128 v[88:91], v21 offset:4096
    ds_read_b64_tr_b16 v[96:97], v29 offset:8192
    ds_read_b64_tr_b16 v[98:99], v29 offset:9216
    v_mfma_f32_32x32x16_bf16 v[116:131], v[68:71], v[80:83], v[116:131]
    v_mfma_f32_32x32x16_bf16 v[148:163], v[72:75], v[80:83], v[148:163]
    v_smfmac_f32_16x16x64_bf16 v[52:55], v[36:39], v[76:83], v40
    s_waitcnt vmcnt(5) lgkmcnt(0)
    s_barrier
    v_mfma_f32_32x32x16_bf16 v[100:115], v[84:87], v[92:95], v[100:115]
    ds_read_b128 v[68:71], v18 offset:32768
    ds_read_b64_tr_b16 v[76:77], v26 offset:32768
    ds_read_b64_tr_b16 v[78:79], v26 offset:33792
    v_mfma_f32_32x32x16_bf16 v[132:147], v[88:91], v[92:95], v[132:147]
    ds_read_b128 v[72:75], v18 offset:36864
    ds_read_b64_tr_b16 v[80:81], v28 offset:32768
    ds_read_b64_tr_b16 v[82:83], v28 offset:33792
    v_mfma_f32_32x32x16_bf16 v[116:131], v[84:87], v[96:99], v[116:131]
    v_mfma_f32_32x32x16_bf16 v[148:163], v[88:91], v[96:99], v[148:163]
    s_waitcnt lgkmcnt(0)
    v_smfmac_f32_16x16x64_bf16 v[52:55], v[36:39], v[76:83], v40
    v_mfma_f32_32x32x16_bf16 v[100:115], v[68:71], v[76:79], v[100:115]
    ds_read_b128 v[84:87], v20 offset:32768
    ds_read_b64_tr_b16 v[92:93], v26 offset:40960
    ds_read_b64_tr_b16 v[94:95], v26 offset:41984
    v_mfma_f32_32x32x16_bf16 v[132:147], v[72:75], v[76:79], v[132:147]
    ds_read_b128 v[88:91], v20 offset:36864
    ds_read_b64_tr_b16 v[96:97], v28 offset:40960
    ds_read_b64_tr_b16 v[98:99], v28 offset:41984
    v_mfma_f32_32x32x16_bf16 v[116:131], v[68:71], v[80:83], v[116:131]
    s_waitcnt vmcnt(0)
    v_xor_b32 v3, v58, v41
    v_xor_b32 v4, v59, v41
    v_and_b32 v5, 1, v41
    v_xor_b32 v5, 1, v5
    v_mfma_f32_32x32x16_bf16 v[148:163], v[72:75], v[80:83], v[148:163]
    v_or3_b32 v3, v3, v4, v5
    v_cmp_ne_u32 vcc, 0, v3
    s_cbranch_vccnz A_rsre_8
A_rsok_7:
    s_waitcnt lgkmcnt(0)
    v_smfmac_f32_16x16x64_bf16 v[52:55], v[36:39], v[92:99], v40
    v_mfma_f32_32x32x16_bf16 v[100:115], v[84:87], v[92:95], v[100:115]
    ds_read_b128 v[68:71], v19 offset:32768
    ds_read_b64_tr_b16 v[76:77], v27 offset:32768
    ds_read_b64_tr_b16 v[78:79], v27 offset:33792
    v_mfma_f32_32x32x16_bf16 v[132:147], v[88:91], v[92:95], v[132:147]
    ds_read_b128 v[72:75], v19 offset:36864
    ds_read_b64_tr_b16 v[80:81], v29 offset:32768
    ds_read_b64_tr_b16 v[82:83], v29 offset:33792
    v_mfma_f32_32x32x16_bf16 v[116:131], v[84:87], v[96:99], v[116:131]
    v_add_f32 v5, v52, v53
    ds_write_b32 v45, v56
    ds_write_b32 v45, v57 offset:512
    ds_write_b32 v46, v5
    v_mfma_f32_32x32x16_bf16 v[148:163], v[88:91], v[96:99], v[148:163]
    v_readfirstlane_b32 s41, v41
    s_waitcnt lgkmcnt(0)
    s_barrier
    v_mfma_f32_32x32x16_bf16 v[100:115], v[68:71], v[76:79], v[100:115]
    ds_read_b128 v[84:87], v21 offset:32768
    ds_read_b64_tr_b16 v[92:93], v27 offset:40960
    ds_read_b64_tr_b16 v[94:95], v27 offset:41984
    v_mfma_f32_32x32x16_bf16 v[132:147], v[72:75], v[76:79], v[132:147]
    ds_read_b128 v[88:91], v21 offset:36864
    ds_read_b64_tr_b16 v[96:97], v29 offset:40960
    ds_read_b64_tr_b16 v[98:99], v29 offset:41984
    v_mfma_f32_32x32x16_bf16 v[116:131], v[68:71], v[80:83], v[116:131]
    ds_read_b32 v228, v49
    ds_read_b32 v230, v49 offset:128
    ds_read_b32 v229, v49 offset:512
    ds_read_b32 v231, v49 offset:640
    v_mfma_f32_32x32x16_bf16 v[148:163], v[72:75], v[80:83], v[148:163]
    ds_read_b128 v[164:167], v50 offset:0
    ds_read_b128 v[180:183], v50 offset:512
    ds_read_b128 v[168:171], v50 offset:16
    ds_read_b128 v[184:187], v50 offset:528
    s_waitcnt lgkmcnt(0)
    v_mfma_f32_32x32x16_bf16 v[100:115], v[84:87], v[92:95], v[100:115]
    ds_read_b128 v[172:175], v50 offset:64
    ds_read_b128 v[188:191], v50 offset:576
    ds_read_b128 v[176:179], v50 offset:80
    ds_read_b128 v[192:195], v50 offset:592
    v_mfma_f32_32x32x16_bf16 v[132:147], v[88:91], v[92:95], v[132:147]
    ds_read_b128 v[196:199], v50 offset:128
    ds_read_b128 v[212:215], v50 offset:640
    ds_read_b128 v[200:203], v50 offset:144
    ds_read_b128 v[216:219], v50 offset:656
    v_mfma_f32_32x32x16_bf16 v[116:131], v[84:87], v[96:99], v[116:131]
    ds_read_b128 v[204:207], v50 offset:192
    ds_read_b128 v[220:223], v50 offset:704
    ds_read_b128 v[208:211], v50 offset:208
    ds_read_b128 v[224:227], v50 offset:720
    v_mfma_f32_32x32x16_bf16 v[148:163], v[88:91], v[96:99], v[148:163]
    v_add_f32 v228, v228, v229
    v_add_f32 v230, v230, v231
    s_waitcnt lgkmcnt(0)
    s_nop 1
    v_pk_mul_f32 v[100:101], v[100:101], v[164:165]
    v_pk_fma_f32 v[100:101], v[180:181], v[228:229], v[100:101] op_sel_hi:[1,0,1] neg_lo:[0,1,0] neg_hi:[0,1,0]
    v_pk_mul_f32 v[102:103], v[102:103], v[166:167]
    v_pk_fma_f32 v[102:103], v[182:183], v[228:229], v[102:103] op_sel_hi:[1,0,1] neg_lo:[0,1,0] neg_hi:[0,1,0]
    v_pk_mul_f32 v[104:105], v[104:105], v[168:169]
    v_pk_fma_f32 v[104:105], v[184:185], v[228:229], v[104:105] op_sel_hi:[1,0,1] neg_lo:[0,1,0] neg_hi:[0,1,0]
    v_pk_mul_f32 v[106:107], v[106:107], v[170:171]
    v_pk_fma_f32 v[106:107], v[186:187], v[228:229], v[106:107] op_sel_hi:[1,0,1] neg_lo:[0,1,0] neg_hi:[0,1,0]
    v_pk_mul_f32 v[108:109], v[108:109], v[172:173]
    v_pk_fma_f32 v[108:109], v[188:189], v[228:229], v[108:109] op_sel_hi:[1,0,1] neg_lo:[0,1,0] neg_hi:[0,1,0]
    v_pk_mul_f32 v[110:111], v[110:111], v[174:175]
    v_pk_fma_f32 v[110:111], v[190:191], v[228:229], v[110:111] op_sel_hi:[1,0,1] neg_lo:[0,1,0] neg_hi:[0,1,0]
    v_pk_mul_f32 v[112:113], v[112:113], v[176:177]
    v_pk_fma_f32 v[112:113], v[192:193], v[228:229], v[112:113] op_sel_hi:[1,0,1] neg_lo:[0,1,0] neg_hi:[0,1,0]
    v_pk_mul_f32 v[114:115], v[114:115], v[178:179]
    v_pk_fma_f32 v[114:115], v[194:195], v[228:229], v[114:115] op_sel_hi:[1,0,1] neg_lo:[0,1,0] neg_hi:[0,1,0]
    v_cvt_pk_bf16_f32 v100, v100, v101
    v_cvt_pk_bf16_f32 v101, v102, v103
    v_cvt_pk_bf16_f32 v102, v104, v105
    v_cvt_pk_bf16_f32 v103, v106, v107
    v_cvt_pk_bf16_f32 v104, v108, v109
    v_cvt_pk_bf16_f32 v105, v110, v111
    v_cvt_pk_bf16_f32 v106, v112, v113
    v_cvt_pk_bf16_f32 v107, v114, v115
    buffer_store_dwordx4 v[100:103], v43, s[12:15], s56 offen offset:0 sc1
    buffer_store_dwordx4 v[104:107], v43, s[12:15], s56 offen offset:640 sc1
    v_pk_mul_f32 v[132:133], v[132:133], v[196:197]
    v_pk_fma_f32 v[132:133], v[212:213], v[228:229], v[132:133] op_sel_hi:[1,0,1] neg_lo:[0,1,0] neg_hi:[0,1,0]
    v_pk_mul_f32 v[134:135], v[134:135], v[198:199]
    v_pk_fma_f32 v[134:135], v[214:215], v[228:229], v[134:135] op_sel_hi:[1,0,1] neg_lo:[0,1,0] neg_hi:[0,1,0]
    v_pk_mul_f32 v[136:137], v[136:137], v[200:201]
    v_pk_fma_f32 v[136:137], v[216:217], v[228:229], v[136:137] op_sel_hi:[1,0,1] neg_lo:[0,1,0] neg_hi:[0,1,0]
    v_pk_mul_f32 v[138:139], v[138:139], v[202:203]
    v_pk_fma_f32 v[138:139], v[218:219], v[228:229], v[138:139] op_sel_hi:[1,0,1] neg_lo:[0,1,0] neg_hi:[0,1,0]
    v_pk_mul_f32 v[140:141], v[140:141], v[204:205]
    v_pk_fma_f32 v[140:141], v[220:221], v[228:229], v[140:141] op_sel_hi:[1,0,1] neg_lo:[0,1,0] neg_hi:[0,1,0]
    v_pk_mul_f32 v[142:143], v[142:143], v[206:207]
    v_pk_fma_f32 v[142:143], v[222:223], v[228:229], v[142:143] op_sel_hi:[1,0,1] neg_lo:[0,1,0] neg_hi:[0,1,0]
    v_pk_mul_f32 v[144:145], v[144:145], v[208:209]
    v_pk_fma_f32 v[144:145], v[224:225], v[228:229], v[144:145] op_sel_hi:[1,0,1] neg_lo:[0,1,0] neg_hi:[0,1,0]
    v_pk_mul_f32 v[146:147], v[146:147], v[210:211]
    v_pk_fma_f32 v[146:147], v[226:227], v[228:229], v[146:147] op_sel_hi:[1,0,1] neg_lo:[0,1,0] neg_hi:[0,1,0]
    v_cvt_pk_bf16_f32 v132, v132, v133
    v_cvt_pk_bf16_f32 v133, v134, v135
    v_cvt_pk_bf16_f32 v134, v136, v137
    v_cvt_pk_bf16_f32 v135, v138, v139
    v_cvt_pk_bf16_f32 v136, v140, v141
    v_cvt_pk_bf16_f32 v137, v142, v143
    v_cvt_pk_bf16_f32 v138, v144, v145
    v_cvt_pk_bf16_f32 v139, v146, v147
    buffer_store_dwordx4 v[132:135], v43, s[12:15], s56 offen offset:1280 sc1
    buffer_store_dwordx4 v[136:139], v43, s[12:15], s56 offen offset:1920 sc1
    v_pk_mul_f32 v[116:117], v[116:117], v[164:165]
    v_pk_fma_f32 v[116:117], v[180:181], v[230:231], v[116:117] op_sel_hi:[1,0,1] neg_lo:[0,1,0] neg_hi:[0,1,0]
    v_pk_mul_f32 v[118:119], v[118:119], v[166:167]
    v_pk_fma_f32 v[118:119], v[182:183], v[230:231], v[118:119] op_sel_hi:[1,0,1] neg_lo:[0,1,0] neg_hi:[0,1,0]
    v_pk_mul_f32 v[120:121], v[120:121], v[168:169]
    v_pk_fma_f32 v[120:121], v[184:185], v[230:231], v[120:121] op_sel_hi:[1,0,1] neg_lo:[0,1,0] neg_hi:[0,1,0]
    v_pk_mul_f32 v[122:123], v[122:123], v[170:171]
    v_pk_fma_f32 v[122:123], v[186:187], v[230:231], v[122:123] op_sel_hi:[1,0,1] neg_lo:[0,1,0] neg_hi:[0,1,0]
    v_pk_mul_f32 v[124:125], v[124:125], v[172:173]
    v_pk_fma_f32 v[124:125], v[188:189], v[230:231], v[124:125] op_sel_hi:[1,0,1] neg_lo:[0,1,0] neg_hi:[0,1,0]
    v_pk_mul_f32 v[126:127], v[126:127], v[174:175]
    v_pk_fma_f32 v[126:127], v[190:191], v[230:231], v[126:127] op_sel_hi:[1,0,1] neg_lo:[0,1,0] neg_hi:[0,1,0]
    v_pk_mul_f32 v[128:129], v[128:129], v[176:177]
    v_pk_fma_f32 v[128:129], v[192:193], v[230:231], v[128:129] op_sel_hi:[1,0,1] neg_lo:[0,1,0] neg_hi:[0,1,0]
    v_pk_mul_f32 v[130:131], v[130:131], v[178:179]
    v_pk_fma_f32 v[130:131], v[194:195], v[230:231], v[130:131] op_sel_hi:[1,0,1] neg_lo:[0,1,0] neg_hi:[0,1,0]
    v_cvt_pk_bf16_f32 v116, v116, v117
    v_cvt_pk_bf16_f32 v117, v118, v119
    v_cvt_pk_bf16_f32 v118, v120, v121
    v_cvt_pk_bf16_f32 v119, v122, v123
    v_cvt_pk_bf16_f32 v120, v124, v125
    v_cvt_pk_bf16_f32 v121, v126, v127
    v_cvt_pk_bf16_f32 v122, v128, v129
    v_cvt_pk_bf16_f32 v123, v130, v131
    buffer_store_dwordx4 v[116:119], v44, s[12:15], s56 offen offset:0 sc1
    buffer_store_dwordx4 v[120:123], v44, s[12:15], s56 offen offset:640 sc1
    v_pk_mul_f32 v[148:149], v[148:149], v[196:197]
    v_pk_fma_f32 v[148:149], v[212:213], v[230:231], v[148:149] op_sel_hi:[1,0,1] neg_lo:[0,1,0] neg_hi:[0,1,0]
    v_pk_mul_f32 v[150:151], v[150:151], v[198:199]
    v_pk_fma_f32 v[150:151], v[214:215], v[230:231], v[150:151] op_sel_hi:[1,0,1] neg_lo:[0,1,0] neg_hi:[0,1,0]
    v_pk_mul_f32 v[152:153], v[152:153], v[200:201]
    v_pk_fma_f32 v[152:153], v[216:217], v[230:231], v[152:153] op_sel_hi:[1,0,1] neg_lo:[0,1,0] neg_hi:[0,1,0]
    v_pk_mul_f32 v[154:155], v[154:155], v[202:203]
    v_pk_fma_f32 v[154:155], v[218:219], v[230:231], v[154:155] op_sel_hi:[1,0,1] neg_lo:[0,1,0] neg_hi:[0,1,0]
    v_pk_mul_f32 v[156:157], v[156:157], v[204:205]
    v_pk_fma_f32 v[156:157], v[220:221], v[230:231], v[156:157] op_sel_hi:[1,0,1] neg_lo:[0,1,0] neg_hi:[0,1,0]
    v_pk_mul_f32 v[158:159], v[158:159], v[206:207]
    v_pk_fma_f32 v[158:159], v[222:223], v[230:231], v[158:159] op_sel_hi:[1,0,1] neg_lo:[0,1,0] neg_hi:[0,1,0]
    v_pk_mul_f32 v[160:161], v[160:161], v[208:209]
    v_pk_fma_f32 v[160:161], v[224:225], v[230:231], v[160:161] op_sel_hi:[1,0,1] neg_lo:[0,1,0] neg_hi:[0,1,0]
    v_pk_mul_f32 v[162:163], v[162:163], v[210:211]
    v_pk_fma_f32 v[162:163], v[226:227], v[230:231], v[162:163] op_sel_hi:[1,0,1] neg_lo:[0,1,0] neg_hi:[0,1,0]
    v_cvt_pk_bf16_f32 v148, v148, v149
    v_cvt_pk_bf16_f32 v149, v150, v151
    v_cvt_pk_bf16_f32 v150, v152, v153
    v_cvt_pk_bf16_f32 v151, v154, v155
    v_cvt_pk_bf16_f32 v152, v156, v157
    v_cvt_pk_bf16_f32 v153, v158, v159
    v_cvt_pk_bf16_f32 v154, v160, v161
    v_cvt_pk_bf16_f32 v155, v162, v163
    buffer_store_dwordx4 v[148:151], v44, s[12:15], s56 offen offset:1280 sc1
    buffer_store_dwordx4 v[152:155], v44, s[12:15], s56 offen offset:1920 sc1
    s_branch sequential_preLN__mha_block__moe_arch_mod__prompt_kernel_edge
END_V:
.p2align 12
EDGE0:
PAD_EQ:
    s_cbranch_execz RET_Q
PAD_EV:
    s_cbranch_execz RET_V
sequential_preLN__mha_block__moe_arch_mod__prompt_kernel_edge:
    s_load_dwordx2 s[20:21], s[0:1], 64
    s_load_dwordx2 s[32:33], s[0:1], 32
    s_load_dwordx2 s[36:37], s[0:1], 16
    s_and_b32 s45, s2, 7
    s_lshr_b32 s44, s2, 3
    s_mul_i32 s43, s45, 12
    s_add_u32 s43, s43, s44
    s_mul_i32 s46, s45, 5
    s_add_u32 s46, s46, s44
    s_sub_u32 s46, s46, 12
    s_cmp_lt_u32 s44, 17
    s_cselect_b32 s42, 1, 2
    s_cmp_lt_u32 s44, 12
    s_cselect_b32 s42, 0, s42
    s_cselect_b32 s43, s43, s46
    s_cselect_b32 s44, 40, 56
    s_cselect_b32 s45, 48, 56
    s_load_dwordx2 s[24:25], s[0:1], s44
    s_load_dwordx2 s[28:29], s[0:1], s45
    s_mov_b32 s22, 2621440
    s_mov_b32 s23, 0x20000
    s_mov_b32 s26, 1966080
    s_mov_b32 s27, 0x20000
    s_mov_b32 s30, 1966080
    s_mov_b32 s31, 0x20000
    s_mov_b32 s34, 1280
    s_mov_b32 s35, 0x20000
    s_mov_b32 s38, 819200
    s_mov_b32 s39, 0x20000
    s_lshl_b32 s59, s49, 4
    s_add_u32 s59, s59, s48
    s_lshl_b32 s59, s59, 7
    s_add_u32 s59, s59, 12091392
    s_waitcnt lgkmcnt(0)
    s_and_b32 s44, s2, 7
    s_lshl_b32 s48, s44, 2
    s_lshr_b32 s44, s2, 6
    s_add_u32 s48, s48, s44
    s_bfe_u32 s49, s2, 0x30003
    s_mul_i32 s45, s49, 160
    s_lshl_b32 s44, s48, 6
    s_lshl_b32 s46, s40, 4
    s_add_u32 s44, s44, s46
    v_and_b32 v15, 15, v1
    v_add_u32 v12, s44, v15
    v_mul_u32_u24 v3, 1280, v12
    v_lshrrev_b32 v17, 4, v1
    v_mul_u32_u24 v17, 40, v17
    v_add_u32 v17, s45, v17
    v_add_u32 v3, v3, v17
    buffer_load_dwordx4 a[236:239], v3, s[4:7], 0 offen
    buffer_load_dwordx4 a[240:243], v3, s[4:7], 0 offen offset:16
    buffer_load_dwordx2 a[244:245], v3, s[4:7], 0 offen offset:32
    buffer_load_dwordx4 a[246:249], v17, s[32:35], 0 offen
    buffer_load_dwordx4 a[250:253], v17, s[32:35], 0 offen offset:16
    buffer_load_dwordx2 a[254:255], v17, s[32:35], 0 offen offset:32
    s_mul_i32 s44, s40, 204800
    s_add_u32 s44, s44, s45
    v_add_u32 v15, 0, v1
    v_mul_u32_u24 v16, 6554, v15
    v_lshrrev_b32 v16, 16, v16
    v_mul_u32_u24 v17, 1120, v16
    v_lshl_add_u32 v17, v1, 4, v17
    v_add_u32 v34, s44, v17
    v_add_u32 v15, 64, v1
    v_mul_u32_u24 v16, 6554, v15
    v_lshrrev_b32 v16, 16, v16
    v_mul_u32_u24 v17, 1120, v16
    v_lshl_add_u32 v17, v1, 4, v17
    v_add_u32 v35, s44, v17
    v_add_u32 v15, 128, v1
    v_mul_u32_u24 v16, 6554, v15
    v_lshrrev_b32 v16, 16, v16
    v_mul_u32_u24 v17, 1120, v16
    v_lshl_add_u32 v17, v1, 4, v17
    v_add_u32 v36, s44, v17
    v_add_u32 v15, 192, v1
    v_mul_u32_u24 v16, 6554, v15
    v_lshrrev_b32 v16, 16, v16
    v_mul_u32_u24 v17, 1120, v16
    v_lshl_add_u32 v17, v1, 4, v17
    v_add_u32 v37, s44, v17
    v_add_u32 v15, 256, v1
    v_mul_u32_u24 v16, 6554, v15
    v_lshrrev_b32 v16, 16, v16
    v_mul_u32_u24 v17, 1120, v16
    v_lshl_add_u32 v17, v15, 4, v17
    v_add_u32 v38, s44, v17
    s_mul_i32 s100, s40, 25600
    v_lshrrev_b32 v14, 4, v1
    v_bfe_u32 v15, v1, 2, 2
    v_and_b32 v17, 3, v1
    v_lshl_add_u32 v4, v14, 3, v15
    v_lshlrev_b32 v4, 5, v4
    v_lshl_add_u32 v4, v17, 3, v4
    s_mul_i32 s58, s40, 15360
    s_add_u32 s58, s58, 102400
    v_add_u32 v4, s58, v4
    v_mul_u32_u24 v17, 40, v17
    v_mul_u32_u24 v15, 160, v15
    v_add_u32 v17, v17, v15
    v_lshrrev_b32 v15, 1, v14
    v_mul_u32_u24 v13, 3200, v15
    v_add_u32 v13, v17, v13
    v_and_b32 v16, 1, v14
    v_mul_u32_u24 v8, 1920, v16
    v_add_u32 v8, v8, v13
    v_mul_u32_u24 v9, 640, v16
    v_add_u32 v9, v9, v13
    v_add_u32 v9, 640, v9
    v_lshl_add_u32 v16, v15, 2, v16
    v_mul_u32_u24 v10, 3200, v16
    v_add_u32 v10, v10, v17
    v_add_u32 v10, 2560, v10
    v_add_u32 v11, 51200, v10
    s_lshl_b32 s44, s48, 2
    s_add_u32 s44, s44, s40
    s_mul_i32 s44, s44, 20480
    s_add_u32 s44, s44, 8912896
    v_lshl_add_u32 v6, v1, 4, s44
    s_add_u32 s44, s44, 16384
    v_and_b32 v17, 15, v1
    v_lshlrev_b32 v17, 3, v17
    v_lshl_add_u32 v17, v16, 7, v17
    v_add_u32 v7, s44, v17
    v_sub_u32 v12, 2047, v12
    s_lshl_b32 s44, s49, 2
    s_add_u32 s44, s44, s40
    s_sub_u32 s45, s44, 20
    s_cselect_b32 s44, s44, s45
    s_and_b32 s45, s44, 3
    s_lshl_b32 s46, s48, 2
    s_add_u32 s45, s45, s46
    s_mul_i32 s45, s45, 20480
    s_lshr_b32 s46, s44, 2
    s_lshl_b32 s46, s46, 7
    s_cmp_lt_u32 s44, 16
    s_cselect_b32 s46, s46, 16384
    s_cselect_b32 s44, 9, 7
    s_add_u32 s45, s45, s46
    s_add_u32 s45, s45, 8912896
    v_and_b32 v13, 31, v1
    v_lshlrev_b32 v15, s44, v13
    v_add_u32 v5, s45, v15
    s_mov_b32 s8, s48
    s_mov_b32 s9, s49
    s_and_b32 s50, s40, 1
    s_lshr_b32 s51, s40, 1
    s_mul_i32 s54, s8, 5
    s_add_u32 s54, s54, 1
    s_lshr_b32 s54, s54, 1
    s_mul_i32 s54, s54, 34048
    s_add_u32 s44, s54, 68096
    s_sub_u32 s45, s54, 34040
    s_bitcmp1_b32 s8, 0
    s_cselect_b32 s55, s45, s44
    v_lshrrev_b32 v14, 5, v1
    s_lshl_b32 s44, s9, 12
    s_lshl_b32 s45, s50, 11
    s_add_u32 s44, s44, s45
    s_lshl_b32 s45, s51, 10
    s_add_u32 s56, s44, s45
    v_mul_u32_u24 v15, 34048, v14
    v_lshl_add_u32 v15, v13, 4, v15
    v_add_u32 v24, s54, v15
    s_mul_i32 s46, s56, 80
    s_add_u32 s46, s46, 8912896
    s_lshl_b32 s44, s8, 9
    s_add_u32 s44, s44, s46
    v_and_b32 v17, 15, v1
    v_bfe_u32 v15, v1, 4, 1
    v_mul_u32_u24 v15, 20480, v15
    v_lshl_add_u32 v15, v14, 8, v15
    v_lshl_add_u32 v15, v17, 4, v15
    v_add_u32 v32, s44, v15
    s_lshl_b32 s44, s8, 7
    s_add_u32 s44, s44, s46
    s_add_u32 s44, s44, 16384
    v_lshrrev_b32 v15, 4, v1
    v_mul_u32_u24 v15, 20480, v15
    v_lshl_add_u32 v15, v17, 3, v15
    v_add_u32 v33, s44, v15
    v_lshlrev_b32 v16, 4, v1
    v_add_u32 v25, s55, v16
    s_lshl_b32 s44, s51, 14
    s_add_u32 s44, s44, 2723840
    v_add_u32 v19, s44, v24
    s_add_u32 s44, s44, s55
    v_lshlrev_b32 v16, 4, v1
    v_add_u32 v20, s44, v16
    v_add_u32 v30, s58, v16
    s_xor_b32 s46, s40, 2
    s_mul_i32 s46, s46, 15360
    s_add_u32 s46, s46, 102400
    v_add_u32 v31, s46, v16
    s_mul_i32 s44, s8, 84736
    s_mul_i32 s45, s51, 40960
    s_add_u32 s44, s44, s45
    s_add_u32 s44, s44, 5767168
    v_and_b32 v15, 28, v13
    v_mov_b32 v16, 0x42130
    v_lshrrev_b32 v15, v15, v16
    v_and_b32 v15, 7, v15
    v_and_b32 v16, 3, v13
    v_lshl_add_u32 v15, v15, 2, v16
    v_lshlrev_b32 v15, 4, v15
    v_mul_u32_u24 v16, 320, v14
    v_add3_u32 v22, v15, v16, s44
    v_add_u32 v23, 2560, v22
    s_mov_b32 s62, 0xfffff
    s_mov_b32 s63, 0xfffff
    s_mov_b64 s[4:5], s[12:13]
    s_mov_b32 s6, 16777216
    s_mov_b64 s[32:33], s[12:13]
    s_mov_b32 s34, 16777216
    v_mov_b32 v18, 0xdddddddd
    v_lshrrev_b32 v15, 1, v1
    v_and_b32 v16, 1, v1
    v_lshlrev_b32 v16, 4, v16
    s_cmp_eq_u32 s42, 2
    s_cselect_b32 s26, 0, s26
    s_cselect_b32 s30, 0, s30
    s_cmp_eq_u32 s42, 0
    s_cselect_b32 s61, 0, 81920
    s_movk_i32 s44, 1280
    s_cselect_b32 s44, 3072, s44
    s_cselect_b32 s45, 64, 0
    s_cselect_b32 s46, 0, 40960
    s_cselect_b32 s54, 16, 64
    s_mul_i32 s54, s54, s44
    v_mad_u32_u24 v15, v14, s45, v15
    v_mul_u32_u24 v15, s44, v15
    s_mul_i32 s44, s40, 491520
    s_lshl_b32 s45, s43, 5
    s_add_u32 s44, s44, s45
    v_add3_u32 v28, v15, v16, s44
    v_add_u32 v29, s46, v28
    s_getreg_b32 s45, hwreg(HW_REG_XCC_ID, 0, 4)
    s_lshl_b32 s45, s45, 1
    s_or_b32 s10, s45, s41
    s_waitcnt vmcnt(6)
    s_barrier
    s_cmp_lg_u32 s40, 0
    s_cbranch_scc1 E_noflag_9
    v_mov_b32 v15, s10
    s_mov_b64 exec, 1
    buffer_store_dword v15, v2, s[12:15], s59 offen sc1
    s_mov_b64 exec, -1
E_noflag_9:
    v_cmp_eq_u32 vcc, 20, v13
    v_mov_b32 v16, 0x3f803f80
    s_nop 0
    v_cndmask_b32 v15, v2, v16, vcc
    v_accvgpr_write_b32 a24, v15
    v_accvgpr_write_b32 a25, v15
    v_accvgpr_write_b32 a26, v15
    v_accvgpr_write_b32 a27, v15
    v_accvgpr_write_b32 a28, v15
    v_accvgpr_write_b32 a29, v15
    v_accvgpr_write_b32 a30, v15
    v_accvgpr_write_b32 a31, v15
    v_accvgpr_write_b32 a32, v15
    v_accvgpr_write_b32 a33, v15
    v_accvgpr_write_b32 a34, v15
    v_accvgpr_write_b32 a35, v15
    v_accvgpr_write_b32 a36, v15
    v_accvgpr_write_b32 a37, v15
    v_accvgpr_write_b32 a38, v15
    v_accvgpr_write_b32 a39, v15
    v_accvgpr_write_b32 a40, v15
    v_accvgpr_write_b32 a41, v15
    v_accvgpr_write_b32 a42, v15
    v_accvgpr_write_b32 a43, v15
    v_accvgpr_write_b32 a44, v15
    v_accvgpr_write_b32 a45, v15
    v_accvgpr_write_b32 a46, v15
    v_accvgpr_write_b32 a47, v15
    v_accvgpr_write_b32 a48, v15
    v_accvgpr_write_b32 a49, v15
    v_accvgpr_write_b32 a50, v15
    v_accvgpr_write_b32 a51, v15
    v_accvgpr_write_b32 a52, v15
    v_accvgpr_write_b32 a53, v15
    v_accvgpr_write_b32 a54, v15
    v_accvgpr_write_b32 a55, v15
    v_accvgpr_write_b32 a56, v15
    v_accvgpr_write_b32 a57, v15
    v_accvgpr_write_b32 a58, v15
    v_accvgpr_write_b32 a59, v15
    v_accvgpr_write_b32 a60, v15
    v_accvgpr_write_b32 a61, v15
    v_accvgpr_write_b32 a62, v15
    v_accvgpr_write_b32 a63, v15
    v_accvgpr_write_b32 a64, v15
    v_accvgpr_write_b32 a65, v15
    v_accvgpr_write_b32 a66, v15
    v_accvgpr_write_b32 a67, v15
    v_accvgpr_write_b32 a68, v15
    v_accvgpr_write_b32 a69, v15
    v_accvgpr_write_b32 a70, v15
    v_accvgpr_write_b32 a71, v15
    v_mov_b32 v148, 0
    v_mov_b32 v149, 0
    v_mov_b32 v150, 0
    v_mov_b32 v151, 0
    v_mov_b32 v152, 0
    v_mov_b32 v153, 0
    v_mov_b32 v154, 0
    v_mov_b32 v155, 0
    v_mov_b32 v156, 0
    v_mov_b32 v157, 0
    v_mov_b32 v158, 0
    v_mov_b32 v159, 0
    v_mov_b32 v160, 0
    v_mov_b32 v161, 0
    v_mov_b32 v162, 0
    v_mov_b32 v163, 0
    v_mov_b32 v164, 0
    v_mov_b32 v165, 0
    v_mov_b32 v166, 0
    v_mov_b32 v167, 0
    v_mov_b32 v168, 0
    v_mov_b32 v169, 0
    v_mov_b32 v170, 0
    v_mov_b32 v171, 0
    v_mov_b32 v172, 0
    v_mov_b32 v173, 0
    v_mov_b32 v174, 0
    v_mov_b32 v175, 0
    v_mov_b32 v176, 0
    v_mov_b32 v177, 0
    v_mov_b32 v178, 0
    v_mov_b32 v179, 0
    v_mov_b32 v180, 0
    v_mov_b32 v181, 0
    v_mov_b32 v182, 0
    v_mov_b32 v183, 0
    v_mov_b32 v184, 0
    v_mov_b32 v185, 0
    v_mov_b32 v186, 0
    v_mov_b32 v187, 0
    v_mov_b32 v188, 0
    v_mov_b32 v189, 0
    v_mov_b32 v190, 0
    v_mov_b32 v191, 0
    v_mov_b32 v192, 0
    v_mov_b32 v193, 0
    v_mov_b32 v194, 0
    v_mov_b32 v195, 0
    v_mov_b32 v196, 0
    v_mov_b32 v197, 0
    v_mov_b32 v198, 0
    v_mov_b32 v199, 0
    v_mov_b32 v200, 0
    v_mov_b32 v201, 0
    v_mov_b32 v202, 0
    v_mov_b32 v203, 0
    v_mov_b32 v204, 0
    v_mov_b32 v205, 0
    v_mov_b32 v206, 0
    v_mov_b32 v207, 0
    v_mov_b32 v208, 0
    v_mov_b32 v209, 0
    v_mov_b32 v210, 0
    v_mov_b32 v211, 0
    v_lshrrev_b32 v15, 4, v1
    v_min_u32 v15, 2, v15
    v_mul_u32_u24 v16, 640, v15
    v_bfe_u32 v17, v1, 3, 1
    v_mad_u32_u24 v16, v17, 19, v16
    s_mul_i32 s44, s8, 20
    v_add_u32 v16, s44, v16
    v_lshrrev_b32 v16, 7, v16
    v_and_b32 v17, 7, v1
    s_lshl_b32 s44, s51, 3
    v_add_u32 v17, s44, v17
    s_lshl_b32 s44, s9, 1
    s_add_u32 s44, s44, s50
    v_cmp_eq_u32 vcc, 0, v15
    v_mov_b32 v15, s44
    s_lshl_b32 s44, s40, 13
    v_cndmask_b32 v17, v17, v15, vcc
    v_lshl_add_u32 v16, v16, 4, v17
    v_lshlrev_b32 v16, 7, v16
    v_add_u32 v16, 12091392, v16
    s_add_u32 s44, s44, 12091392
    v_lshl_add_u32 v27, v1, 7, s44
    s_and_b32 s44, s2, 4
    s_lshl_b32 s44, s44, 12
    s_and_b32 s45, s2, 3
    s_lshl_b32 s45, s45, 9
    s_add_u32 s44, s44, s45
    s_add_u32 s44, s44, 12091392
    v_lshrrev_b32 v15, 2, v13
    v_and_b32 v17, 3, v13
    v_lshl_add_u32 v15, v15, 4, v17
    v_lshl_add_u32 v26, v15, 7, s44
    s_xor_b32 s46, s56, 1024
    s_load_dwordx2 s[16:17], s[0:1], 40
    s_load_dwordx2 s[52:53], s[0:1], 48
    s_load_dwordx2 s[8:9], s[0:1], 56
    s_mov_b32 s18, 1966080
    s_lshl_b32 s44, s2, 2
    s_add_u32 s44, s44, s40
    s_mul_i32 s44, s44, 1920
    v_min_u32 v17, 7, v1
    v_lshl_add_u32 v17, v17, 7, s44
    s_waitcnt lgkmcnt(0)
    s_mov_b64 exec, 0
    s_cmp_eq_u32 s40, 0
    s_cbranch_scc1 PAD_5
    s_cmp_eq_u32 s40, 1
    s_cbranch_scc1 PAD_6
    s_cmp_eq_u32 s40, 2
    s_cbranch_scc1 PAD_7
    s_branch PAD_4
RET_E:
    s_mov_b64 exec, -1
    s_mov_b32 s47, 65536
E_fl_10:
    buffer_load_dword v15, v16, s[12:15], 0 offen sc1
    s_sub_u32 s47, s47, 1
    s_waitcnt vmcnt(0)
    s_cbranch_scc1 E_fl_ok_12
    v_and_b32 v15, 0xffffffe1, v15
    v_cmp_ne_u32 vcc, s41, v15
    s_cbranch_vccnz E_fl_10
E_fl_ok_12:
    buffer_load_dwordx2 v[56:57], v25, s[12:15], s46 offen sc1
    buffer_load_dwordx2 a[72:73], v20, s[4:7], 0 offen offset:0 sc1
    buffer_load_dwordx4 v[40:43], v24, s[12:15], s46 offen offset:0 sc1
    buffer_load_dwordx4 a[0:3], v19, s[4:7], 0 offen offset:0 sc1
    buffer_load_dwordx4 v[44:47], v24, s[12:15], s46 offen offset:512 sc1
    buffer_load_dwordx2 v[58:59], v25, s[12:15], s56 offen sc1
    s_mov_b64 exec, s[62:63]
    buffer_load_dwordx4 a[24:27], v22, s[32:35], 0 offen offset:0 sc1
    buffer_load_dwordx4 a[28:31], v22, s[32:35], 0 offen offset:640 sc1
    s_mov_b64 exec, -1
    buffer_load_dwordx4 v[48:51], v24, s[12:15], s56 offen offset:0 sc1
    buffer_load_dwordx4 v[52:55], v24, s[12:15], s56 offen offset:512 sc1
    buffer_load_dwordx4 a[4:7], v19, s[4:7], 0 offen offset:512 sc1
    s_mov_b64 exec, s[62:63]
    buffer_load_dwordx4 a[32:35], v22, s[32:35], 0 offen offset:1280 sc1
    buffer_load_dwordx4 a[36:39], v22, s[32:35], 0 offen offset:1920 sc1
    s_mov_b64 exec, -1
    buffer_load_dwordx4 a[8:11], v19, s[4:7], 0 offen offset:1024 sc1
    buffer_load_dwordx2 a[74:75], v20, s[4:7], 0 offen offset:1024 sc1
    buffer_load_dwordx4 a[12:15], v19, s[4:7], 0 offen offset:1536 sc1
    s_waitcnt vmcnt(14)
    v_mfma_f32_32x32x4_2b_bf16 v[60:91], a[72:73], v[56:57], 0 cbsz:1 abid:0
    s_nop 15
    s_waitcnt vmcnt(12)
    s_nop 0
    v_mfma_f32_32x32x16_bf16 v[60:75], a[0:3], v[40:43], v[60:75]
    s_waitcnt vmcnt(11)
    v_mfma_f32_32x32x16_bf16 v[76:91], a[0:3], v[44:47], v[76:91]
    s_nop 9
.p2align 3
    v_exp_f32 v60, v60
    v_exp_f32 v61, v61
    v_exp_f32 v62, v62
    v_exp_f32 v63, v63
    v_exp_f32 v64, v64
    v_exp_f32 v65, v65
    s_waitcnt vmcnt(10)
    v_mfma_f32_32x32x4_2b_bf16 v[92:123], a[72:73], v[58:59], 0 cbsz:1 abid:0
    v_exp_f32 v66, v66
    v_exp_f32 v67, v67
    v_exp_f32 v68, v68
    v_exp_f32 v69, v69
    v_exp_f32 v70, v70
    v_exp_f32 v71, v71
    v_exp_f32 v72, v72
    v_exp_f32 v73, v73
    v_exp_f32 v74, v74
    v_exp_f32 v75, v75
    s_waitcnt vmcnt(8)
    v_smfmac_f32_32x32x32_bf16 v[148:163], a[24:27], v[60:67], v18
    s_mov_b64 exec, s[62:63]
    buffer_load_dwordx4 a[40:43], v23, s[32:35], 0 offen offset:0 sc1
    buffer_load_dwordx4 a[44:47], v23, s[32:35], 0 offen offset:640 sc1
    buffer_load_dwordx4 a[48:51], v23, s[32:35], 0 offen offset:1280 sc1
    buffer_load_dwordx4 a[52:55], v23, s[32:35], 0 offen offset:1920 sc1
    s_mov_b64 exec, -1
    v_exp_f32 v76, v76
    v_exp_f32 v77, v77
    v_exp_f32 v78, v78
    v_smfmac_f32_32x32x32_bf16 v[148:163], a[28:31], v[68:75], v18
    v_exp_f32 v79, v79
    v_exp_f32 v80, v80
    v_exp_f32 v81, v81
    s_waitcnt vmcnt(10)
    v_mfma_f32_32x32x16_bf16 v[92:107], a[0:3], v[48:51], v[92:107]
    buffer_load_dwordx4 a[16:19], v19, s[4:7], 0 offen offset:2048 sc1
    buffer_load_dwordx2 a[76:77], v20, s[4:7], 0 offen offset:2048 sc1
    buffer_load_dwordx4 a[20:23], v19, s[4:7], 0 offen offset:2560 sc1
    v_exp_f32 v82, v82
    v_exp_f32 v83, v83
    v_exp_f32 v84, v84
    v_mfma_f32_32x32x16_bf16 v[108:123], a[0:3], v[52:55], v[108:123]
    v_exp_f32 v85, v85
    v_exp_f32 v86, v86
    v_exp_f32 v87, v87
    v_exp_f32 v88, v88
    v_exp_f32 v89, v89
    v_exp_f32 v90, v90
    v_exp_f32 v91, v91
    v_smfmac_f32_32x32x32_bf16 v[164:179], a[24:27], v[76:83], v18
    s_add_u32 s32, s32, 5120
    v_exp_f32 v92, v92
    v_exp_f32 v93, v93
    v_exp_f32 v94, v94
    v_smfmac_f32_32x32x32_bf16 v[164:179], a[28:31], v[84:91], v18
    s_addc_u32 s33, s33, 0
    v_exp_f32 v95, v95
    v_exp_f32 v96, v96
    v_exp_f32 v97, v97
    v_mfma_f32_32x32x4_2b_bf16 v[60:91], a[72:73], v[56:57], 0 cbsz:1 abid:1
    v_exp_f32 v98, v98
    v_exp_f32 v99, v99
    v_exp_f32 v100, v100
    v_exp_f32 v101, v101
    v_exp_f32 v102, v102
    v_exp_f32 v103, v103
    v_exp_f32 v104, v104
    v_exp_f32 v105, v105
    v_exp_f32 v106, v106
    v_exp_f32 v107, v107
    v_smfmac_f32_32x32x32_bf16 v[180:195], a[24:27], v[92:99], v18
    s_mov_b64 exec, s[62:63]
    buffer_load_dwordx4 a[56:59], v22, s[32:35], 0 offen offset:0 sc1
    buffer_load_dwordx4 a[60:63], v22, s[32:35], 0 offen offset:640 sc1
    buffer_load_dwordx4 a[64:67], v22, s[32:35], 0 offen offset:1280 sc1
    buffer_load_dwordx4 a[68:71], v22, s[32:35], 0 offen offset:1920 sc1
    s_mov_b64 exec, -1
    v_exp_f32 v108, v108
    v_exp_f32 v109, v109
    v_exp_f32 v110, v110
    v_smfmac_f32_32x32x32_bf16 v[180:195], a[28:31], v[100:107], v18
    v_exp_f32 v111, v111
    v_exp_f32 v112, v112
    v_exp_f32 v113, v113
    s_waitcnt vmcnt(16)
    v_mfma_f32_32x32x16_bf16 v[60:75], a[4:7], v[40:43], v[60:75]
    v_exp_f32 v114, v114
    v_exp_f32 v115, v115
    v_exp_f32 v116, v116
    v_mfma_f32_32x32x16_bf16 v[76:91], a[4:7], v[44:47], v[76:91]
    v_exp_f32 v117, v117
    v_exp_f32 v118, v118
    v_exp_f32 v119, v119
    v_exp_f32 v120, v120
    v_exp_f32 v121, v121
    v_exp_f32 v122, v122
    v_exp_f32 v123, v123
    v_smfmac_f32_32x32x32_bf16 v[196:211], a[24:27], v[108:115], v18
    v_exp_f32 v60, v60
    v_exp_f32 v61, v61
    v_exp_f32 v62, v62
    v_smfmac_f32_32x32x32_bf16 v[196:211], a[28:31], v[116:123], v18
    v_exp_f32 v63, v63
    v_exp_f32 v64, v64
    v_exp_f32 v65, v65
    v_mfma_f32_32x32x4_2b_bf16 v[92:123], a[72:73], v[58:59], 0 cbsz:1 abid:1
    v_exp_f32 v66, v66
    v_exp_f32 v67, v67
    v_exp_f32 v68, v68
    v_exp_f32 v69, v69
    v_exp_f32 v70, v70
    v_exp_f32 v71, v71
    v_exp_f32 v72, v72
    v_exp_f32 v73, v73
    v_exp_f32 v74, v74
    v_exp_f32 v75, v75
    s_waitcnt vmcnt(14)
    v_smfmac_f32_32x32x32_bf16 v[148:163], a[32:35], v[60:67], v18
    v_exp_f32 v76, v76
    v_exp_f32 v77, v77
    v_exp_f32 v78, v78
    v_smfmac_f32_32x32x32_bf16 v[148:163], a[36:39], v[68:75], v18
    v_exp_f32 v79, v79
    v_exp_f32 v80, v80
    v_exp_f32 v81, v81
    v_mfma_f32_32x32x16_bf16 v[92:107], a[4:7], v[48:51], v[92:107]
    v_exp_f32 v82, v82
    v_exp_f32 v83, v83
    v_exp_f32 v84, v84
    v_mfma_f32_32x32x16_bf16 v[108:123], a[4:7], v[52:55], v[108:123]
    v_exp_f32 v85, v85
    v_exp_f32 v86, v86
    v_exp_f32 v87, v87
    v_exp_f32 v88, v88
    v_exp_f32 v89, v89
    v_exp_f32 v90, v90
    v_exp_f32 v91, v91
    v_smfmac_f32_32x32x32_bf16 v[164:179], a[32:35], v[76:83], v18
    v_exp_f32 v92, v92
    v_exp_f32 v93, v93
    v_exp_f32 v94, v94
    v_smfmac_f32_32x32x32_bf16 v[164:179], a[36:39], v[84:91], v18
    s_waitcnt vmcnt(11)
    v_exp_f32 v95, v95
    v_exp_f32 v96, v96
    v_exp_f32 v97, v97
    v_mfma_f32_32x32x4_2b_bf16 v[60:91], a[74:75], v[56:57], 0 cbsz:1 abid:0
    v_exp_f32 v98, v98
    v_exp_f32 v99, v99
    v_exp_f32 v100, v100
    v_exp_f32 v101, v101
    v_exp_f32 v102, v102
    v_exp_f32 v103, v103
    v_exp_f32 v104, v104
    v_exp_f32 v105, v105
    v_exp_f32 v106, v106
    v_exp_f32 v107, v107
    v_smfmac_f32_32x32x32_bf16 v[180:195], a[32:35], v[92:99], v18
    v_exp_f32 v108, v108
    v_exp_f32 v109, v109
    v_exp_f32 v110, v110
    v_smfmac_f32_32x32x32_bf16 v[180:195], a[36:39], v[100:107], v18
    v_exp_f32 v111, v111
    v_exp_f32 v112, v112
    v_exp_f32 v113, v113
    v_mfma_f32_32x32x16_bf16 v[60:75], a[8:11], v[40:43], v[60:75]
    buffer_load_dwordx4 a[0:3], v19, s[4:7], 0 offen offset:3072 sc1
    buffer_load_dwordx2 a[72:73], v20, s[4:7], 0 offen offset:3072 sc1
    buffer_load_dwordx4 a[4:7], v19, s[4:7], 0 offen offset:3584 sc1
    v_exp_f32 v114, v114
    v_exp_f32 v115, v115
    v_exp_f32 v116, v116
    v_mfma_f32_32x32x16_bf16 v[76:91], a[8:11], v[44:47], v[76:91]
    buffer_load_dword v15, v17, s[16:19], 0 offen offset:0
    v_exp_f32 v117, v117
    v_exp_f32 v118, v118
    v_exp_f32 v119, v119
    v_exp_f32 v120, v120
    v_exp_f32 v121, v121
    v_exp_f32 v122, v122
    v_exp_f32 v123, v123
    v_smfmac_f32_32x32x32_bf16 v[196:211], a[32:35], v[108:115], v18
    s_add_u32 s4, s4, 4096
    v_exp_f32 v60, v60
    v_exp_f32 v61, v61
    v_exp_f32 v62, v62
    v_smfmac_f32_32x32x32_bf16 v[196:211], a[36:39], v[116:123], v18
    s_waitcnt vmcnt(11)
    v_exp_f32 v63, v63
    v_exp_f32 v64, v64
    v_exp_f32 v65, v65
    v_mfma_f32_32x32x4_2b_bf16 v[92:123], a[74:75], v[58:59], 0 cbsz:1 abid:0
    v_exp_f32 v66, v66
    v_exp_f32 v67, v67
    v_exp_f32 v68, v68
    v_exp_f32 v69, v69
    v_exp_f32 v70, v70
    v_exp_f32 v71, v71
    v_exp_f32 v72, v72
    v_exp_f32 v73, v73
    v_exp_f32 v74, v74
    v_exp_f32 v75, v75
    v_smfmac_f32_32x32x32_bf16 v[148:163], a[40:43], v[60:67], v18
    s_mov_b64 exec, s[62:63]
    buffer_load_dwordx4 a[24:27], v23, s[32:35], 0 offen offset:0 sc1
    buffer_load_dwordx4 a[28:31], v23, s[32:35], 0 offen offset:640 sc1
    buffer_load_dwordx4 a[32:35], v23, s[32:35], 0 offen offset:1280 sc1
    buffer_load_dwordx4 a[36:39], v23, s[32:35], 0 offen offset:1920 sc1
    s_mov_b64 exec, -1
    v_exp_f32 v76, v76
    v_exp_f32 v77, v77
    v_exp_f32 v78, v78
    v_smfmac_f32_32x32x32_bf16 v[148:163], a[44:47], v[68:75], v18
    s_addc_u32 s5, s5, 0
    v_exp_f32 v79, v79
    v_exp_f32 v80, v80
    v_exp_f32 v81, v81
    v_mfma_f32_32x32x16_bf16 v[92:107], a[8:11], v[48:51], v[92:107]
    v_exp_f32 v82, v82
    v_exp_f32 v83, v83
    v_exp_f32 v84, v84
    v_mfma_f32_32x32x16_bf16 v[108:123], a[8:11], v[52:55], v[108:123]
    v_exp_f32 v85, v85
    v_exp_f32 v86, v86
    v_exp_f32 v87, v87
    v_exp_f32 v88, v88
    v_exp_f32 v89, v89
    v_exp_f32 v90, v90
    v_exp_f32 v91, v91
    v_smfmac_f32_32x32x32_bf16 v[164:179], a[40:43], v[76:83], v18
    s_add_u32 s32, s32, 5120
    v_exp_f32 v92, v92
    v_exp_f32 v93, v93
    v_exp_f32 v94, v94
    v_smfmac_f32_32x32x32_bf16 v[164:179], a[44:47], v[84:91], v18
    s_addc_u32 s33, s33, 0
    v_exp_f32 v95, v95
    v_exp_f32 v96, v96
    v_exp_f32 v97, v97
    v_mfma_f32_32x32x4_2b_bf16 v[60:91], a[74:75], v[56:57], 0 cbsz:1 abid:1
    v_exp_f32 v98, v98
    v_exp_f32 v99, v99
    v_exp_f32 v100, v100
    v_exp_f32 v101, v101
    v_exp_f32 v102, v102
    v_exp_f32 v103, v103
    v_exp_f32 v104, v104
    v_exp_f32 v105, v105
    v_exp_f32 v106, v106
    v_exp_f32 v107, v107
    v_smfmac_f32_32x32x32_bf16 v[180:195], a[40:43], v[92:99], v18
    v_exp_f32 v108, v108
    v_exp_f32 v109, v109
    v_exp_f32 v110, v110
    v_smfmac_f32_32x32x32_bf16 v[180:195], a[44:47], v[100:107], v18
    v_exp_f32 v111, v111
    v_exp_f32 v112, v112
    v_exp_f32 v113, v113
    v_mfma_f32_32x32x16_bf16 v[60:75], a[12:15], v[40:43], v[60:75]
    v_exp_f32 v114, v114
    v_exp_f32 v115, v115
    v_exp_f32 v116, v116
    v_mfma_f32_32x32x16_bf16 v[76:91], a[12:15], v[44:47], v[76:91]
    v_exp_f32 v117, v117
    v_exp_f32 v118, v118
    v_exp_f32 v119, v119
    v_exp_f32 v120, v120
    v_exp_f32 v121, v121
    v_exp_f32 v122, v122
    v_exp_f32 v123, v123
    v_smfmac_f32_32x32x32_bf16 v[196:211], a[40:43], v[108:115], v18
    v_exp_f32 v60, v60
    v_exp_f32 v61, v61
    v_exp_f32 v62, v62
    v_smfmac_f32_32x32x32_bf16 v[196:211], a[44:47], v[116:123], v18
    v_exp_f32 v63, v63
    v_exp_f32 v64, v64
    v_exp_f32 v65, v65
    v_mfma_f32_32x32x4_2b_bf16 v[92:123], a[74:75], v[58:59], 0 cbsz:1 abid:1
    v_exp_f32 v66, v66
    v_exp_f32 v67, v67
    v_exp_f32 v68, v68
    v_exp_f32 v69, v69
    v_exp_f32 v70, v70
    v_exp_f32 v71, v71
    v_exp_f32 v72, v72
    v_exp_f32 v73, v73
    v_exp_f32 v74, v74
    v_exp_f32 v75, v75
    v_smfmac_f32_32x32x32_bf16 v[148:163], a[48:51], v[60:67], v18
    v_exp_f32 v76, v76
    v_exp_f32 v77, v77
    v_exp_f32 v78, v78
    v_smfmac_f32_32x32x32_bf16 v[148:163], a[52:55], v[68:75], v18
    v_exp_f32 v79, v79
    v_exp_f32 v80, v80
    v_exp_f32 v81, v81
    v_mfma_f32_32x32x16_bf16 v[92:107], a[12:15], v[48:51], v[92:107]
    v_exp_f32 v82, v82
    v_exp_f32 v83, v83
    v_exp_f32 v84, v84
    v_mfma_f32_32x32x16_bf16 v[108:123], a[12:15], v[52:55], v[108:123]
    v_exp_f32 v85, v85
    v_exp_f32 v86, v86
    v_exp_f32 v87, v87
    v_exp_f32 v88, v88
    v_exp_f32 v89, v89
PAD_1:
    s_cbranch_execz RET_E
    v_exp_f32 v90, v90
    v_exp_f32 v91, v91
    v_smfmac_f32_32x32x32_bf16 v[164:179], a[48:51], v[76:83], v18
    v_exp_f32 v92, v92
    v_exp_f32 v93, v93
    v_exp_f32 v94, v94
    v_smfmac_f32_32x32x32_bf16 v[164:179], a[52:55], v[84:91], v18
    s_waitcnt vmcnt(12)
    v_exp_f32 v95, v95
    v_exp_f32 v96, v96
    v_exp_f32 v97, v97
    v_mfma_f32_32x32x4_2b_bf16 v[60:91], a[76:77], v[56:57], 0 cbsz:1 abid:0
    v_exp_f32 v98, v98
    v_exp_f32 v99, v99
    v_exp_f32 v100, v100
    v_exp_f32 v101, v101
    v_exp_f32 v102, v102
    v_exp_f32 v103, v103
    v_exp_f32 v104, v104
    v_exp_f32 v105, v105
    v_exp_f32 v106, v106
    v_exp_f32 v107, v107
    v_smfmac_f32_32x32x32_bf16 v[180:195], a[48:51], v[92:99], v18
    v_exp_f32 v108, v108
    v_exp_f32 v109, v109
    v_exp_f32 v110, v110
    v_smfmac_f32_32x32x32_bf16 v[180:195], a[52:55], v[100:107], v18
    v_exp_f32 v111, v111
    v_exp_f32 v112, v112
    v_exp_f32 v113, v113
    v_mfma_f32_32x32x16_bf16 v[60:75], a[16:19], v[40:43], v[60:75]
    buffer_load_dwordx4 a[8:11], v19, s[4:7], 0 offen offset:0 sc1
    buffer_load_dwordx2 a[74:75], v20, s[4:7], 0 offen offset:0 sc1
    buffer_load_dwordx4 a[12:15], v19, s[4:7], 0 offen offset:512 sc1
    v_exp_f32 v114, v114
    v_exp_f32 v115, v115
    v_exp_f32 v116, v116
    v_mfma_f32_32x32x16_bf16 v[76:91], a[16:19], v[44:47], v[76:91]
    buffer_load_dword v15, v17, s[16:19], 0 offen offset:896
    v_exp_f32 v117, v117
    v_exp_f32 v118, v118
    v_exp_f32 v119, v119
    v_exp_f32 v120, v120
    v_exp_f32 v121, v121
    v_exp_f32 v122, v122
    v_exp_f32 v123, v123
    v_smfmac_f32_32x32x32_bf16 v[196:211], a[48:51], v[108:115], v18
    s_mov_b64 s[16:17], s[52:53]
    v_exp_f32 v60, v60
    v_exp_f32 v61, v61
    v_exp_f32 v62, v62
    v_smfmac_f32_32x32x32_bf16 v[196:211], a[52:55], v[116:123], v18
    s_waitcnt vmcnt(12)
    v_exp_f32 v63, v63
    v_exp_f32 v64, v64
    v_exp_f32 v65, v65
    v_mfma_f32_32x32x4_2b_bf16 v[92:123], a[76:77], v[58:59], 0 cbsz:1 abid:0
    v_exp_f32 v66, v66
    v_exp_f32 v67, v67
    v_exp_f32 v68, v68
    v_exp_f32 v69, v69
    v_exp_f32 v70, v70
    v_exp_f32 v71, v71
    v_exp_f32 v72, v72
    v_exp_f32 v73, v73
    v_exp_f32 v74, v74
    v_exp_f32 v75, v75
    v_smfmac_f32_32x32x32_bf16 v[148:163], a[56:59], v[60:67], v18
    s_mov_b64 exec, s[62:63]
    buffer_load_dwordx4 a[40:43], v22, s[32:35], 0 offen offset:0 sc1
    buffer_load_dwordx4 a[44:47], v22, s[32:35], 0 offen offset:640 sc1
    buffer_load_dwordx4 a[48:51], v22, s[32:35], 0 offen offset:1280 sc1
    buffer_load_dwordx4 a[52:55], v22, s[32:35], 0 offen offset:1920 sc1
    s_mov_b64 exec, -1
    v_exp_f32 v76, v76
    v_exp_f32 v77, v77
    v_exp_f32 v78, v78
    v_smfmac_f32_32x32x32_bf16 v[148:163], a[60:63], v[68:75], v18
    v_exp_f32 v79, v79
    v_exp_f32 v80, v80
    v_exp_f32 v81, v81
    v_mfma_f32_32x32x16_bf16 v[92:107], a[16:19], v[48:51], v[92:107]
    v_exp_f32 v82, v82
    v_exp_f32 v83, v83
    v_exp_f32 v84, v84
    v_mfma_f32_32x32x16_bf16 v[108:123], a[16:19], v[52:55], v[108:123]
    v_exp_f32 v85, v85
    v_exp_f32 v86, v86
    v_exp_f32 v87, v87
    v_exp_f32 v88, v88
    v_exp_f32 v89, v89
    v_exp_f32 v90, v90
    v_exp_f32 v91, v91
    v_smfmac_f32_32x32x32_bf16 v[164:179], a[56:59], v[76:83], v18
    v_exp_f32 v92, v92
    v_exp_f32 v93, v93
    v_exp_f32 v94, v94
    v_smfmac_f32_32x32x32_bf16 v[164:179], a[60:63], v[84:91], v18
    v_exp_f32 v95, v95
    v_exp_f32 v96, v96
    v_exp_f32 v97, v97
    v_mfma_f32_32x32x4_2b_bf16 v[60:91], a[76:77], v[56:57], 0 cbsz:1 abid:1
    v_exp_f32 v98, v98
    v_exp_f32 v99, v99
    v_exp_f32 v100, v100
    v_exp_f32 v101, v101
    v_exp_f32 v102, v102
    v_exp_f32 v103, v103
    v_exp_f32 v104, v104
    v_exp_f32 v105, v105
    v_exp_f32 v106, v106
    v_exp_f32 v107, v107
    v_smfmac_f32_32x32x32_bf16 v[180:195], a[56:59], v[92:99], v18
    v_exp_f32 v108, v108
    v_exp_f32 v109, v109
    v_exp_f32 v110, v110
    v_smfmac_f32_32x32x32_bf16 v[180:195], a[60:63], v[100:107], v18
    s_add_u32 m0, s100, 0
    v_exp_f32 v111, v111
    v_exp_f32 v112, v112
    v_exp_f32 v113, v113
    v_mfma_f32_32x32x16_bf16 v[60:75], a[20:23], v[40:43], v[60:75]
    buffer_load_dwordx4 v34, s[36:39], 0 offen offset:0 lds
    buffer_load_dwordx4 v35, s[36:39], 0 offen offset:1024 lds
    v_exp_f32 v114, v114
    v_exp_f32 v115, v115
    v_exp_f32 v116, v116
    v_mfma_f32_32x32x16_bf16 v[76:91], a[20:23], v[44:47], v[76:91]
    buffer_load_dwordx4 v36, s[36:39], 0 offen offset:2048 lds
    v_exp_f32 v117, v117
    v_exp_f32 v118, v118
    v_exp_f32 v119, v119
    v_exp_f32 v120, v120
    v_exp_f32 v121, v121
    v_exp_f32 v122, v122
    v_exp_f32 v123, v123
    v_smfmac_f32_32x32x32_bf16 v[196:211], a[56:59], v[108:115], v18
    v_exp_f32 v60, v60
    v_exp_f32 v61, v61
    v_exp_f32 v62, v62
    v_smfmac_f32_32x32x32_bf16 v[196:211], a[60:63], v[116:123], v18
    v_exp_f32 v63, v63
    v_exp_f32 v64, v64
    v_exp_f32 v65, v65
    v_mfma_f32_32x32x4_2b_bf16 v[92:123], a[76:77], v[58:59], 0 cbsz:1 abid:1
    v_exp_f32 v66, v66
    v_exp_f32 v67, v67
    v_exp_f32 v68, v68
    v_exp_f32 v69, v69
    v_exp_f32 v70, v70
    v_exp_f32 v71, v71
    v_exp_f32 v72, v72
    v_exp_f32 v73, v73
    v_exp_f32 v74, v74
    v_exp_f32 v75, v75
    v_smfmac_f32_32x32x32_bf16 v[148:163], a[64:67], v[60:67], v18
    v_exp_f32 v76, v76
    v_exp_f32 v77, v77
    v_exp_f32 v78, v78
    v_smfmac_f32_32x32x32_bf16 v[148:163], a[68:71], v[68:75], v18
    v_exp_f32 v79, v79
    v_exp_f32 v80, v80
    v_exp_f32 v81, v81
    v_mfma_f32_32x32x16_bf16 v[92:107], a[20:23], v[48:51], v[92:107]
    v_exp_f32 v82, v82
    v_exp_f32 v83, v83
    v_exp_f32 v84, v84
    v_mfma_f32_32x32x16_bf16 v[108:123], a[20:23], v[52:55], v[108:123]
    v_exp_f32 v85, v85
    v_exp_f32 v86, v86
    v_exp_f32 v87, v87
    v_exp_f32 v88, v88
    v_exp_f32 v89, v89
    v_exp_f32 v90, v90
    v_exp_f32 v91, v91
    v_smfmac_f32_32x32x32_bf16 v[164:179], a[64:67], v[76:83], v18
    v_exp_f32 v92, v92
    v_exp_f32 v93, v93
    v_exp_f32 v94, v94
    v_smfmac_f32_32x32x32_bf16 v[164:179], a[68:71], v[84:91], v18
    s_waitcnt vmcnt(16)
    v_exp_f32 v95, v95
    v_exp_f32 v96, v96
    v_exp_f32 v97, v97
    v_mfma_f32_32x32x4_2b_bf16 v[60:91], a[72:73], v[56:57], 0 cbsz:1 abid:0
    v_exp_f32 v98, v98
    v_exp_f32 v99, v99
    v_exp_f32 v100, v100
    v_exp_f32 v101, v101
    v_exp_f32 v102, v102
    v_exp_f32 v103, v103
    v_exp_f32 v104, v104
    v_exp_f32 v105, v105
    v_exp_f32 v106, v106
    v_exp_f32 v107, v107
    v_smfmac_f32_32x32x32_bf16 v[180:195], a[64:67], v[92:99], v18
    v_exp_f32 v108, v108
    v_exp_f32 v109, v109
    v_exp_f32 v110, v110
    v_smfmac_f32_32x32x32_bf16 v[180:195], a[68:71], v[100:107], v18
    v_exp_f32 v111, v111
    v_exp_f32 v112, v112
    v_exp_f32 v113, v113
    v_mfma_f32_32x32x16_bf16 v[60:75], a[0:3], v[40:43], v[60:75]
    buffer_load_dwordx4 a[16:19], v19, s[4:7], 0 offen offset:1024 sc1
    buffer_load_dwordx2 a[76:77], v20, s[4:7], 0 offen offset:1024 sc1
    buffer_load_dwordx4 a[20:23], v19, s[4:7], 0 offen offset:1536 sc1
    v_exp_f32 v114, v114
    v_exp_f32 v115, v115
    v_exp_f32 v116, v116
    v_mfma_f32_32x32x16_bf16 v[76:91], a[0:3], v[44:47], v[76:91]
    buffer_load_dword v15, v17, s[16:19], 0 offen offset:0
    v_exp_f32 v117, v117
    v_exp_f32 v118, v118
    v_exp_f32 v119, v119
    v_exp_f32 v120, v120
    v_exp_f32 v121, v121
    v_exp_f32 v122, v122
    v_exp_f32 v123, v123
    v_smfmac_f32_32x32x32_bf16 v[196:211], a[64:67], v[108:115], v18
    v_exp_f32 v60, v60
    v_exp_f32 v61, v61
    v_exp_f32 v62, v62
    v_smfmac_f32_32x32x32_bf16 v[196:211], a[68:71], v[116:123], v18
    s_waitcnt vmcnt(15)
    v_exp_f32 v63, v63
    v_exp_f32 v64, v64
    v_exp_f32 v65, v65
    v_mfma_f32_32x32x4_2b_bf16 v[92:123], a[72:73], v[58:59], 0 cbsz:1 abid:0
    v_exp_f32 v66, v66
    v_exp_f32 v67, v67
    v_exp_f32 v68, v68
    v_exp_f32 v69, v69
    v_exp_f32 v70, v70
    v_exp_f32 v71, v71
    v_exp_f32 v72, v72
    v_exp_f32 v73, v73
    v_exp_f32 v74, v74
    v_exp_f32 v75, v75
    v_smfmac_f32_32x32x32_bf16 v[148:163], a[24:27], v[60:67], v18
    s_mov_b64 exec, s[62:63]
    buffer_load_dwordx4 a[56:59], v23, s[32:35], 0 offen offset:0 sc1
    buffer_load_dwordx4 a[60:63], v23, s[32:35], 0 offen offset:640 sc1
    buffer_load_dwordx4 a[64:67], v23, s[32:35], 0 offen offset:1280 sc1
    buffer_load_dwordx4 a[68:71], v23, s[32:35], 0 offen offset:1920 sc1
    s_mov_b64 exec, -1
    v_exp_f32 v76, v76
    v_exp_f32 v77, v77
    v_exp_f32 v78, v78
    v_smfmac_f32_32x32x32_bf16 v[148:163], a[28:31], v[68:75], v18
    v_exp_f32 v79, v79
    v_exp_f32 v80, v80
    v_exp_f32 v81, v81
    v_mfma_f32_32x32x16_bf16 v[92:107], a[0:3], v[48:51], v[92:107]
    v_exp_f32 v82, v82
    v_exp_f32 v83, v83
    v_exp_f32 v84, v84
    v_mfma_f32_32x32x16_bf16 v[108:123], a[0:3], v[52:55], v[108:123]
    v_exp_f32 v85, v85
    v_exp_f32 v86, v86
    v_exp_f32 v87, v87
    v_exp_f32 v88, v88
    v_exp_f32 v89, v89
    v_exp_f32 v90, v90
    v_exp_f32 v91, v91
    v_smfmac_f32_32x32x32_bf16 v[164:179], a[24:27], v[76:83], v18
    s_add_u32 s32, s32, 5120
    v_exp_f32 v92, v92
    v_exp_f32 v93, v93
    v_exp_f32 v94, v94
    v_smfmac_f32_32x32x32_bf16 v[164:179], a[28:31], v[84:91], v18
    s_addc_u32 s33, s33, 0
    v_exp_f32 v95, v95
    v_exp_f32 v96, v96
    v_exp_f32 v97, v97
    v_mfma_f32_32x32x4_2b_bf16 v[60:91], a[72:73], v[56:57], 0 cbsz:1 abid:1
    v_exp_f32 v98, v98
    v_exp_f32 v99, v99
    v_exp_f32 v100, v100
    v_exp_f32 v101, v101
    v_exp_f32 v102, v102
    v_exp_f32 v103, v103
    v_exp_f32 v104, v104
    v_exp_f32 v105, v105
    v_exp_f32 v106, v106
    v_exp_f32 v107, v107
    v_smfmac_f32_32x32x32_bf16 v[180:195], a[24:27], v[92:99], v18
    v_exp_f32 v108, v108
    v_exp_f32 v109, v109
    v_exp_f32 v110, v110
    v_smfmac_f32_32x32x32_bf16 v[180:195], a[28:31], v[100:107], v18
    s_add_u32 m0, s100, 0
    v_exp_f32 v111, v111
    v_exp_f32 v112, v112
    v_exp_f32 v113, v113
    v_mfma_f32_32x32x16_bf16 v[60:75], a[4:7], v[40:43], v[60:75]
    buffer_load_dwordx4 v37, s[36:39], 0 offen offset:3072 lds
    v_exp_f32 v114, v114
    v_exp_f32 v115, v115
    v_exp_f32 v116, v116
    v_mfma_f32_32x32x16_bf16 v[76:91], a[4:7], v[44:47], v[76:91]
    v_exp_f32 v117, v117
    v_exp_f32 v118, v118
    v_exp_f32 v119, v119
    v_exp_f32 v120, v120
    v_exp_f32 v121, v121
    v_exp_f32 v122, v122
    v_exp_f32 v123, v123
    v_smfmac_f32_32x32x32_bf16 v[196:211], a[24:27], v[108:115], v18
    v_exp_f32 v60, v60
    v_exp_f32 v61, v61
    v_exp_f32 v62, v62
    v_smfmac_f32_32x32x32_bf16 v[196:211], a[28:31], v[116:123], v18
    v_exp_f32 v63, v63
    v_exp_f32 v64, v64
    v_exp_f32 v65, v65
    v_mfma_f32_32x32x4_2b_bf16 v[92:123], a[72:73], v[58:59], 0 cbsz:1 abid:1
    v_exp_f32 v66, v66
    v_exp_f32 v67, v67
    v_exp_f32 v68, v68
    v_exp_f32 v69, v69
    v_exp_f32 v70, v70
    v_exp_f32 v71, v71
    v_exp_f32 v72, v72
    v_exp_f32 v73, v73
    v_exp_f32 v74, v74
    v_exp_f32 v75, v75
    v_smfmac_f32_32x32x32_bf16 v[148:163], a[32:35], v[60:67], v18
    v_exp_f32 v76, v76
    v_exp_f32 v77, v77
    v_exp_f32 v78, v78
    v_smfmac_f32_32x32x32_bf16 v[148:163], a[36:39], v[68:75], v18
    s_add_u32 m0, s100, 4096
    v_exp_f32 v79, v79
    v_exp_f32 v80, v80
    v_exp_f32 v81, v81
    v_mfma_f32_32x32x16_bf16 v[92:107], a[4:7], v[48:51], v[92:107]
    buffer_load_dwordx4 v38, s[36:39], 0 offen offset:0 lds
    v_exp_f32 v82, v82
    v_exp_f32 v83, v83
    v_exp_f32 v84, v84
    v_mfma_f32_32x32x16_bf16 v[108:123], a[4:7], v[52:55], v[108:123]
    v_exp_f32 v85, v85
    v_exp_f32 v86, v86
    v_exp_f32 v87, v87
    v_exp_f32 v88, v88
    v_exp_f32 v89, v89
    v_exp_f32 v90, v90
    v_exp_f32 v91, v91
    v_smfmac_f32_32x32x32_bf16 v[164:179], a[32:35], v[76:83], v18
    s_add_u32 s36, s36, 40960
    v_exp_f32 v92, v92
    v_exp_f32 v93, v93
    v_exp_f32 v94, v94
    v_smfmac_f32_32x32x32_bf16 v[164:179], a[36:39], v[84:91], v18
    s_waitcnt vmcnt(18)
    v_exp_f32 v95, v95
    v_exp_f32 v96, v96
    v_exp_f32 v97, v97
    v_mfma_f32_32x32x4_2b_bf16 v[60:91], a[74:75], v[56:57], 0 cbsz:1 abid:0
    v_exp_f32 v98, v98
    v_exp_f32 v99, v99
    v_exp_f32 v100, v100
    v_exp_f32 v101, v101
    v_exp_f32 v102, v102
    v_exp_f32 v103, v103
    v_exp_f32 v104, v104
    v_exp_f32 v105, v105
    v_exp_f32 v106, v106
    v_exp_f32 v107, v107
    v_smfmac_f32_32x32x32_bf16 v[180:195], a[32:35], v[92:99], v18
    s_addc_u32 s37, s37, 0
    v_exp_f32 v108, v108
    v_exp_f32 v109, v109
    v_exp_f32 v110, v110
    v_smfmac_f32_32x32x32_bf16 v[180:195], a[36:39], v[100:107], v18
    v_exp_f32 v111, v111
    v_exp_f32 v112, v112
    v_exp_f32 v113, v113
    v_mfma_f32_32x32x16_bf16 v[60:75], a[8:11], v[40:43], v[60:75]
    buffer_load_dwordx4 a[0:3], v19, s[4:7], 0 offen offset:2048 sc1
    buffer_load_dwordx2 a[72:73], v20, s[4:7], 0 offen offset:2048 sc1
    buffer_load_dwordx4 a[4:7], v19, s[4:7], 0 offen offset:2560 sc1
    v_exp_f32 v114, v114
    v_exp_f32 v115, v115
    v_exp_f32 v116, v116
    v_mfma_f32_32x32x16_bf16 v[76:91], a[8:11], v[44:47], v[76:91]
    buffer_load_dword v15, v17, s[16:19], 0 offen offset:896
    v_exp_f32 v117, v117
    v_exp_f32 v118, v118
    v_exp_f32 v119, v119
    v_exp_f32 v120, v120
    v_exp_f32 v121, v121
    v_exp_f32 v122, v122
    v_exp_f32 v123, v123
    v_smfmac_f32_32x32x32_bf16 v[196:211], a[32:35], v[108:115], v18
    s_mov_b64 s[16:17], s[8:9]
    v_exp_f32 v60, v60
    v_exp_f32 v61, v61
    v_exp_f32 v62, v62
    v_smfmac_f32_32x32x32_bf16 v[196:211], a[36:39], v[116:123], v18
    s_waitcnt vmcnt(17)
    v_exp_f32 v63, v63
    v_exp_f32 v64, v64
    v_exp_f32 v65, v65
    v_mfma_f32_32x32x4_2b_bf16 v[92:123], a[74:75], v[58:59], 0 cbsz:1 abid:0
    v_exp_f32 v66, v66
    v_exp_f32 v67, v67
    v_exp_f32 v68, v68
    v_exp_f32 v69, v69
    v_exp_f32 v70, v70
    v_exp_f32 v71, v71
    v_exp_f32 v72, v72
    v_exp_f32 v73, v73
    v_exp_f32 v74, v74
    v_exp_f32 v75, v75
    v_smfmac_f32_32x32x32_bf16 v[148:163], a[40:43], v[60:67], v18
    s_mov_b64 exec, s[62:63]
    buffer_load_dwordx4 a[24:27], v22, s[32:35], 0 offen offset:0 sc1
    buffer_load_dwordx4 a[28:31], v22, s[32:35], 0 offen offset:640 sc1
    buffer_load_dwordx4 a[32:35], v22, s[32:35], 0 offen offset:1280 sc1
    buffer_load_dwordx4 a[36:39], v22, s[32:35], 0 offen offset:1920 sc1
    s_mov_b64 exec, -1
    v_exp_f32 v76, v76
    v_exp_f32 v77, v77
    v_exp_f32 v78, v78
    v_smfmac_f32_32x32x32_bf16 v[148:163], a[44:47], v[68:75], v18
    v_exp_f32 v79, v79
    v_exp_f32 v80, v80
    v_exp_f32 v81, v81
    v_mfma_f32_32x32x16_bf16 v[92:107], a[8:11], v[48:51], v[92:107]
    v_exp_f32 v82, v82
    v_exp_f32 v83, v83
    v_exp_f32 v84, v84
    v_mfma_f32_32x32x16_bf16 v[108:123], a[8:11], v[52:55], v[108:123]
    v_exp_f32 v85, v85
    v_exp_f32 v86, v86
    v_exp_f32 v87, v87
    v_exp_f32 v88, v88
    v_exp_f32 v89, v89
    v_exp_f32 v90, v90
    v_exp_f32 v91, v91
    v_smfmac_f32_32x32x32_bf16 v[164:179], a[40:43], v[76:83], v18
    v_exp_f32 v92, v92
    v_exp_f32 v93, v93
    v_exp_f32 v94, v94
    v_smfmac_f32_32x32x32_bf16 v[164:179], a[44:47], v[84:91], v18
    v_exp_f32 v95, v95
    v_exp_f32 v96, v96
    v_exp_f32 v97, v97
    v_mfma_f32_32x32x4_2b_bf16 v[60:91], a[74:75], v[56:57], 0 cbsz:1 abid:1
    v_exp_f32 v98, v98
    v_exp_f32 v99, v99
    v_exp_f32 v100, v100
    v_exp_f32 v101, v101
    v_exp_f32 v102, v102
    v_exp_f32 v103, v103
    v_exp_f32 v104, v104
    v_exp_f32 v105, v105
    v_exp_f32 v106, v106
    v_exp_f32 v107, v107
    v_smfmac_f32_32x32x32_bf16 v[180:195], a[40:43], v[92:99], v18
    v_exp_f32 v108, v108
    v_exp_f32 v109, v109
    v_exp_f32 v110, v110
    v_smfmac_f32_32x32x32_bf16 v[180:195], a[44:47], v[100:107], v18
    s_add_u32 m0, s100, 5120
    v_exp_f32 v111, v111
    v_exp_f32 v112, v112
    v_exp_f32 v113, v113
    v_mfma_f32_32x32x16_bf16 v[60:75], a[12:15], v[40:43], v[60:75]
    buffer_load_dwordx4 v34, s[36:39], 0 offen offset:0 lds
    buffer_load_dwordx4 v35, s[36:39], 0 offen offset:1024 lds
    v_exp_f32 v114, v114
    v_exp_f32 v115, v115
    v_exp_f32 v116, v116
    v_mfma_f32_32x32x16_bf16 v[76:91], a[12:15], v[44:47], v[76:91]
    buffer_load_dwordx4 v36, s[36:39], 0 offen offset:2048 lds
    v_exp_f32 v117, v117
    v_exp_f32 v118, v118
    v_exp_f32 v119, v119
    v_exp_f32 v120, v120
    v_exp_f32 v121, v121
    v_exp_f32 v122, v122
    v_exp_f32 v123, v123
    v_smfmac_f32_32x32x32_bf16 v[196:211], a[40:43], v[108:115], v18
    v_exp_f32 v60, v60
    v_exp_f32 v61, v61
    v_exp_f32 v62, v62
    v_smfmac_f32_32x32x32_bf16 v[196:211], a[44:47], v[116:123], v18
    v_exp_f32 v63, v63
    v_exp_f32 v64, v64
    v_exp_f32 v65, v65
    v_mfma_f32_32x32x4_2b_bf16 v[92:123], a[74:75], v[58:59], 0 cbsz:1 abid:1
    v_exp_f32 v66, v66
    v_exp_f32 v67, v67
    v_exp_f32 v68, v68
    v_exp_f32 v69, v69
    v_exp_f32 v70, v70
    v_exp_f32 v71, v71
    v_exp_f32 v72, v72
    v_exp_f32 v73, v73
    v_exp_f32 v74, v74
    v_exp_f32 v75, v75
    v_smfmac_f32_32x32x32_bf16 v[148:163], a[48:51], v[60:67], v18
    v_exp_f32 v76, v76
    v_exp_f32 v77, v77
    v_exp_f32 v78, v78
    v_smfmac_f32_32x32x32_bf16 v[148:163], a[52:55], v[68:75], v18
    v_exp_f32 v79, v79
    v_exp_f32 v80, v80
    v_exp_f32 v81, v81
    v_mfma_f32_32x32x16_bf16 v[92:107], a[12:15], v[48:51], v[92:107]
    v_exp_f32 v82, v82
    v_exp_f32 v83, v83
    v_exp_f32 v84, v84
    v_mfma_f32_32x32x16_bf16 v[108:123], a[12:15], v[52:55], v[108:123]
    v_exp_f32 v85, v85
    v_exp_f32 v86, v86
    v_exp_f32 v87, v87
    v_exp_f32 v88, v88
    v_exp_f32 v89, v89
    v_exp_f32 v90, v90
    v_exp_f32 v91, v91
    v_smfmac_f32_32x32x32_bf16 v[164:179], a[48:51], v[76:83], v18
    v_exp_f32 v92, v92
    v_exp_f32 v93, v93
    v_exp_f32 v94, v94
    v_smfmac_f32_32x32x32_bf16 v[164:179], a[52:55], v[84:91], v18
    s_waitcnt vmcnt(18)
    v_exp_f32 v95, v95
    v_exp_f32 v96, v96
    v_exp_f32 v97, v97
    v_mfma_f32_32x32x4_2b_bf16 v[60:91], a[76:77], v[56:57], 0 cbsz:1 abid:0
    v_exp_f32 v98, v98
    v_exp_f32 v99, v99
    v_exp_f32 v100, v100
    v_exp_f32 v101, v101
    v_exp_f32 v102, v102
    v_exp_f32 v103, v103
    v_exp_f32 v104, v104
    v_exp_f32 v105, v105
    v_exp_f32 v106, v106
    v_exp_f32 v107, v107
    v_smfmac_f32_32x32x32_bf16 v[180:195], a[48:51], v[92:99], v18
    v_exp_f32 v108, v108
    v_exp_f32 v109, v109
    v_exp_f32 v110, v110
    v_smfmac_f32_32x32x32_bf16 v[180:195], a[52:55], v[100:107], v18
    v_exp_f32 v111, v111
    v_exp_f32 v112, v112
    v_exp_f32 v113, v113
    v_mfma_f32_32x32x16_bf16 v[60:75], a[16:19], v[40:43], v[60:75]
    buffer_load_dwordx4 a[8:11], v19, s[4:7], 0 offen offset:3072 sc1
    buffer_load_dwordx2 a[74:75], v20, s[4:7], 0 offen offset:3072 sc1
    buffer_load_dwordx4 a[12:15], v19, s[4:7], 0 offen offset:3584 sc1
    v_exp_f32 v114, v114
    v_exp_f32 v115, v115
    v_exp_f32 v116, v116
    v_mfma_f32_32x32x16_bf16 v[76:91], a[16:19], v[44:47], v[76:91]
    buffer_load_dword v15, v17, s[16:19], 0 offen offset:0
    v_exp_f32 v117, v117
    v_exp_f32 v118, v118
    v_exp_f32 v119, v119
    v_exp_f32 v120, v120
    v_exp_f32 v121, v121
    v_exp_f32 v122, v122
    v_exp_f32 v123, v123
    v_smfmac_f32_32x32x32_bf16 v[196:211], a[48:51], v[108:115], v18
    s_add_u32 s4, s4, 4096
    v_exp_f32 v60, v60
    v_exp_f32 v61, v61
    v_exp_f32 v62, v62
    v_smfmac_f32_32x32x32_bf16 v[196:211], a[52:55], v[116:123], v18
    s_waitcnt vmcnt(17)
    v_exp_f32 v63, v63
    v_exp_f32 v64, v64
    v_exp_f32 v65, v65
    v_mfma_f32_32x32x4_2b_bf16 v[92:123], a[76:77], v[58:59], 0 cbsz:1 abid:0
    v_exp_f32 v66, v66
    v_exp_f32 v67, v67
    v_exp_f32 v68, v68
    v_exp_f32 v69, v69
    v_exp_f32 v70, v70
    v_exp_f32 v71, v71
    v_exp_f32 v72, v72
    v_exp_f32 v73, v73
    v_exp_f32 v74, v74
    v_exp_f32 v75, v75
    v_smfmac_f32_32x32x32_bf16 v[148:163], a[56:59], v[60:67], v18
    s_mov_b64 exec, s[62:63]
    buffer_load_dwordx4 a[40:43], v23, s[32:35], 0 offen offset:0 sc1
    buffer_load_dwordx4 a[44:47], v23, s[32:35], 0 offen offset:640 sc1
    buffer_load_dwordx4 a[48:51], v23, s[32:35], 0 offen offset:1280 sc1
    buffer_load_dwordx4 a[52:55], v23, s[32:35], 0 offen offset:1920 sc1
    s_mov_b64 exec, -1
    v_exp_f32 v76, v76
    v_exp_f32 v77, v77
    v_exp_f32 v78, v78
    v_smfmac_f32_32x32x32_bf16 v[148:163], a[60:63], v[68:75], v18
    s_addc_u32 s5, s5, 0
    v_exp_f32 v79, v79
    v_exp_f32 v80, v80
    v_exp_f32 v81, v81
    v_mfma_f32_32x32x16_bf16 v[92:107], a[16:19], v[48:51], v[92:107]
    v_exp_f32 v82, v82
    v_exp_f32 v83, v83
    v_exp_f32 v84, v84
    v_mfma_f32_32x32x16_bf16 v[108:123], a[16:19], v[52:55], v[108:123]
    v_exp_f32 v85, v85
    v_exp_f32 v86, v86
    v_exp_f32 v87, v87
    v_exp_f32 v88, v88
    v_exp_f32 v89, v89
    v_exp_f32 v90, v90
    v_exp_f32 v91, v91
    v_smfmac_f32_32x32x32_bf16 v[164:179], a[56:59], v[76:83], v18
    s_add_u32 s32, s32, 5120
    v_exp_f32 v92, v92
    v_exp_f32 v93, v93
    v_exp_f32 v94, v94
    v_smfmac_f32_32x32x32_bf16 v[164:179], a[60:63], v[84:91], v18
    s_addc_u32 s33, s33, 0
    v_exp_f32 v95, v95
    v_exp_f32 v96, v96
    v_exp_f32 v97, v97
    v_mfma_f32_32x32x4_2b_bf16 v[60:91], a[76:77], v[56:57], 0 cbsz:1 abid:1
    v_exp_f32 v98, v98
    v_exp_f32 v99, v99
    v_exp_f32 v100, v100
    v_exp_f32 v101, v101
    v_exp_f32 v102, v102
    v_exp_f32 v103, v103
    v_exp_f32 v104, v104
    v_exp_f32 v105, v105
    v_exp_f32 v106, v106
    v_exp_f32 v107, v107
    v_smfmac_f32_32x32x32_bf16 v[180:195], a[56:59], v[92:99], v18
    v_exp_f32 v108, v108
    v_exp_f32 v109, v109
    v_exp_f32 v110, v110
    v_smfmac_f32_32x32x32_bf16 v[180:195], a[60:63], v[100:107], v18
    s_add_u32 m0, s100, 5120
    v_exp_f32 v111, v111
    v_exp_f32 v112, v112
    v_exp_f32 v113, v113
    v_mfma_f32_32x32x16_bf16 v[60:75], a[20:23], v[40:43], v[60:75]
    buffer_load_dwordx4 v37, s[36:39], 0 offen offset:3072 lds
    v_exp_f32 v114, v114
    v_exp_f32 v115, v115
    v_exp_f32 v116, v116
    v_mfma_f32_32x32x16_bf16 v[76:91], a[20:23], v[44:47], v[76:91]
    v_exp_f32 v117, v117
    v_exp_f32 v118, v118
    v_exp_f32 v119, v119
    v_exp_f32 v120, v120
    v_exp_f32 v121, v121
    v_exp_f32 v122, v122
    v_exp_f32 v123, v123
    v_smfmac_f32_32x32x32_bf16 v[196:211], a[56:59], v[108:115], v18
    v_exp_f32 v60, v60
    v_exp_f32 v61, v61
    v_exp_f32 v62, v62
    v_smfmac_f32_32x32x32_bf16 v[196:211], a[60:63], v[116:123], v18
    v_exp_f32 v63, v63
    v_exp_f32 v64, v64
    v_exp_f32 v65, v65
    v_mfma_f32_32x32x4_2b_bf16 v[92:123], a[76:77], v[58:59], 0 cbsz:1 abid:1
    v_exp_f32 v66, v66
    v_exp_f32 v67, v67
    v_exp_f32 v68, v68
    v_exp_f32 v69, v69
    v_exp_f32 v70, v70
    v_exp_f32 v71, v71
    v_exp_f32 v72, v72
    v_exp_f32 v73, v73
    v_exp_f32 v74, v74
    v_exp_f32 v75, v75
    v_smfmac_f32_32x32x32_bf16 v[148:163], a[64:67], v[60:67], v18
    v_exp_f32 v76, v76
    v_exp_f32 v77, v77
    v_exp_f32 v78, v78
    v_smfmac_f32_32x32x32_bf16 v[148:163], a[68:71], v[68:75], v18
    s_add_u32 m0, s100, 9216
    v_exp_f32 v79, v79
    v_exp_f32 v80, v80
    v_exp_f32 v81, v81
    v_mfma_f32_32x32x16_bf16 v[92:107], a[20:23], v[48:51], v[92:107]
    buffer_load_dwordx4 v38, s[36:39], 0 offen offset:0 lds
    v_exp_f32 v82, v82
    v_exp_f32 v83, v83
    v_exp_f32 v84, v84
    v_mfma_f32_32x32x16_bf16 v[108:123], a[20:23], v[52:55], v[108:123]
    v_exp_f32 v85, v85
    v_exp_f32 v86, v86
    v_exp_f32 v87, v87
    v_exp_f32 v88, v88
    v_exp_f32 v89, v89
    v_exp_f32 v90, v90
    v_exp_f32 v91, v91
    v_smfmac_f32_32x32x32_bf16 v[164:179], a[64:67], v[76:83], v18
    s_add_u32 s36, s36, 40960
    v_exp_f32 v92, v92
    v_exp_f32 v93, v93
    v_exp_f32 v94, v94
    v_smfmac_f32_32x32x32_bf16 v[164:179], a[68:71], v[84:91], v18
    s_waitcnt vmcnt(18)
    v_exp_f32 v95, v95
    v_exp_f32 v96, v96
    v_exp_f32 v97, v97
    v_mfma_f32_32x32x4_2b_bf16 v[60:91], a[72:73], v[56:57], 0 cbsz:1 abid:0
    v_exp_f32 v98, v98
    v_exp_f32 v99, v99
    v_exp_f32 v100, v100
    v_exp_f32 v101, v101
    v_exp_f32 v102, v102
    v_exp_f32 v103, v103
    v_exp_f32 v104, v104
    v_exp_f32 v105, v105
    v_exp_f32 v106, v106
    v_exp_f32 v107, v107
    v_smfmac_f32_32x32x32_bf16 v[180:195], a[64:67], v[92:99], v18
    s_addc_u32 s37, s37, 0
    v_exp_f32 v108, v108
    v_exp_f32 v109, v109
    v_exp_f32 v110, v110
    v_smfmac_f32_32x32x32_bf16 v[180:195], a[68:71], v[100:107], v18
    v_exp_f32 v111, v111
    v_exp_f32 v112, v112
    v_exp_f32 v113, v113
    v_mfma_f32_32x32x16_bf16 v[60:75], a[0:3], v[40:43], v[60:75]
    buffer_load_dwordx4 a[16:19], v19, s[4:7], 0 offen offset:0 sc1
    buffer_load_dwordx2 a[76:77], v20, s[4:7], 0 offen offset:0 sc1
    buffer_load_dwordx4 a[20:23], v19, s[4:7], 0 offen offset:512 sc1
    v_exp_f32 v114, v114
    v_exp_f32 v115, v115
    v_exp_f32 v116, v116
    v_mfma_f32_32x32x16_bf16 v[76:91], a[0:3], v[44:47], v[76:91]
    buffer_load_dword v15, v17, s[16:19], 0 offen offset:896
    v_exp_f32 v117, v117
    v_exp_f32 v118, v118
    v_exp_f32 v119, v119
    v_exp_f32 v120, v120
    v_exp_f32 v121, v121
    v_exp_f32 v122, v122
    v_exp_f32 v123, v123
    v_smfmac_f32_32x32x32_bf16 v[196:211], a[64:67], v[108:115], v18
    v_exp_f32 v60, v60
    v_exp_f32 v61, v61
    v_exp_f32 v62, v62
    v_smfmac_f32_32x32x32_bf16 v[196:211], a[68:71], v[116:123], v18
    s_waitcnt vmcnt(17)
    v_exp_f32 v63, v63
    v_exp_f32 v64, v64
    v_exp_f32 v65, v65
    v_mfma_f32_32x32x4_2b_bf16 v[92:123], a[72:73], v[58:59], 0 cbsz:1 abid:0
    v_exp_f32 v66, v66
    v_exp_f32 v67, v67
    v_exp_f32 v68, v68
    v_exp_f32 v69, v69
    v_exp_f32 v70, v70
    v_exp_f32 v71, v71
    v_exp_f32 v72, v72
    v_exp_f32 v73, v73
    v_exp_f32 v74, v74
    v_exp_f32 v75, v75
    v_smfmac_f32_32x32x32_bf16 v[148:163], a[24:27], v[60:67], v18
    s_mov_b64 exec, s[62:63]
    buffer_load_dwordx4 a[56:59], v22, s[32:35], 0 offen offset:0 sc1
    buffer_load_dwordx4 a[60:63], v22, s[32:35], 0 offen offset:640 sc1
    buffer_load_dwordx4 a[64:67], v22, s[32:35], 0 offen offset:1280 sc1
    buffer_load_dwordx4 a[68:71], v22, s[32:35], 0 offen offset:1920 sc1
    s_mov_b64 exec, -1
    v_exp_f32 v76, v76
    v_exp_f32 v77, v77
    v_exp_f32 v78, v78
    v_smfmac_f32_32x32x32_bf16 v[148:163], a[28:31], v[68:75], v18
    v_exp_f32 v79, v79
    v_exp_f32 v80, v80
    v_exp_f32 v81, v81
    v_mfma_f32_32x32x16_bf16 v[92:107], a[0:3], v[48:51], v[92:107]
    v_exp_f32 v82, v82
    v_exp_f32 v83, v83
    v_exp_f32 v84, v84
    v_mfma_f32_32x32x16_bf16 v[108:123], a[0:3], v[52:55], v[108:123]
    v_exp_f32 v85, v85
    v_exp_f32 v86, v86
    v_exp_f32 v87, v87
    v_exp_f32 v88, v88
    v_exp_f32 v89, v89
    v_exp_f32 v90, v90
    v_exp_f32 v91, v91
    v_smfmac_f32_32x32x32_bf16 v[164:179], a[24:27], v[76:83], v18
    v_exp_f32 v92, v92
    v_exp_f32 v93, v93
    v_exp_f32 v94, v94
    v_smfmac_f32_32x32x32_bf16 v[164:179], a[28:31], v[84:91], v18
    v_exp_f32 v95, v95
    v_exp_f32 v96, v96
    v_exp_f32 v97, v97
    v_mfma_f32_32x32x4_2b_bf16 v[60:91], a[72:73], v[56:57], 0 cbsz:1 abid:1
    v_exp_f32 v98, v98
    v_exp_f32 v99, v99
    v_exp_f32 v100, v100
    v_exp_f32 v101, v101
    v_exp_f32 v102, v102
    v_exp_f32 v103, v103
    v_exp_f32 v104, v104
    v_exp_f32 v105, v105
    v_exp_f32 v106, v106
    v_exp_f32 v107, v107
    v_smfmac_f32_32x32x32_bf16 v[180:195], a[24:27], v[92:99], v18
    v_exp_f32 v108, v108
    v_exp_f32 v109, v109
    v_exp_f32 v110, v110
    v_smfmac_f32_32x32x32_bf16 v[180:195], a[28:31], v[100:107], v18
    s_add_u32 m0, s100, 10240
    v_exp_f32 v111, v111
    v_exp_f32 v112, v112
    v_exp_f32 v113, v113
    v_mfma_f32_32x32x16_bf16 v[60:75], a[4:7], v[40:43], v[60:75]
    buffer_load_dwordx4 v34, s[36:39], 0 offen offset:0 lds
    buffer_load_dwordx4 v35, s[36:39], 0 offen offset:1024 lds
    v_exp_f32 v114, v114
    v_exp_f32 v115, v115
    v_exp_f32 v116, v116
    v_mfma_f32_32x32x16_bf16 v[76:91], a[4:7], v[44:47], v[76:91]
    buffer_load_dwordx4 v36, s[36:39], 0 offen offset:2048 lds
PAD_2:
    s_cbranch_execz RET_E
    v_exp_f32 v117, v117
    v_exp_f32 v118, v118
    v_exp_f32 v119, v119
    v_exp_f32 v120, v120
    v_exp_f32 v121, v121
    v_exp_f32 v122, v122
    v_exp_f32 v123, v123
    v_smfmac_f32_32x32x32_bf16 v[196:211], a[24:27], v[108:115], v18
    v_exp_f32 v60, v60
    v_exp_f32 v61, v61
    v_exp_f32 v62, v62
    v_smfmac_f32_32x32x32_bf16 v[196:211], a[28:31], v[116:123], v18
    v_exp_f32 v63, v63
    v_exp_f32 v64, v64
    v_exp_f32 v65, v65
    v_mfma_f32_32x32x4_2b_bf16 v[92:123], a[72:73], v[58:59], 0 cbsz:1 abid:1
    v_exp_f32 v66, v66
    v_exp_f32 v67, v67
    v_exp_f32 v68, v68
    v_exp_f32 v69, v69
    v_exp_f32 v70, v70
    v_exp_f32 v71, v71
    v_exp_f32 v72, v72
    v_exp_f32 v73, v73
    v_exp_f32 v74, v74
    v_exp_f32 v75, v75
    v_smfmac_f32_32x32x32_bf16 v[148:163], a[32:35], v[60:67], v18
    v_exp_f32 v76, v76
    v_exp_f32 v77, v77
    v_exp_f32 v78, v78
    v_smfmac_f32_32x32x32_bf16 v[148:163], a[36:39], v[68:75], v18
    v_exp_f32 v79, v79
    v_exp_f32 v80, v80
    v_exp_f32 v81, v81
    v_mfma_f32_32x32x16_bf16 v[92:107], a[4:7], v[48:51], v[92:107]
    v_exp_f32 v82, v82
    v_exp_f32 v83, v83
    v_exp_f32 v84, v84
    v_mfma_f32_32x32x16_bf16 v[108:123], a[4:7], v[52:55], v[108:123]
    v_exp_f32 v85, v85
    v_exp_f32 v86, v86
    v_exp_f32 v87, v87
    v_exp_f32 v88, v88
    v_exp_f32 v89, v89
    v_exp_f32 v90, v90
    v_exp_f32 v91, v91
    v_smfmac_f32_32x32x32_bf16 v[164:179], a[32:35], v[76:83], v18
    v_exp_f32 v92, v92
    v_exp_f32 v93, v93
    v_exp_f32 v94, v94
    v_smfmac_f32_32x32x32_bf16 v[164:179], a[36:39], v[84:91], v18
    s_waitcnt vmcnt(18)
    v_exp_f32 v95, v95
    v_exp_f32 v96, v96
    v_exp_f32 v97, v97
    v_mfma_f32_32x32x4_2b_bf16 v[60:91], a[74:75], v[56:57], 0 cbsz:1 abid:0
    v_exp_f32 v98, v98
    v_exp_f32 v99, v99
    v_exp_f32 v100, v100
    v_exp_f32 v101, v101
    v_exp_f32 v102, v102
    v_exp_f32 v103, v103
    v_exp_f32 v104, v104
    v_exp_f32 v105, v105
    v_exp_f32 v106, v106
    v_exp_f32 v107, v107
    v_smfmac_f32_32x32x32_bf16 v[180:195], a[32:35], v[92:99], v18
    v_exp_f32 v108, v108
    v_exp_f32 v109, v109
    v_exp_f32 v110, v110
    v_smfmac_f32_32x32x32_bf16 v[180:195], a[36:39], v[100:107], v18
    v_exp_f32 v111, v111
    v_exp_f32 v112, v112
    v_exp_f32 v113, v113
    v_mfma_f32_32x32x16_bf16 v[60:75], a[8:11], v[40:43], v[60:75]
    buffer_load_dwordx4 a[0:3], v19, s[4:7], 0 offen offset:1024 sc1
    buffer_load_dwordx2 a[72:73], v20, s[4:7], 0 offen offset:1024 sc1
    buffer_load_dwordx4 a[4:7], v19, s[4:7], 0 offen offset:1536 sc1
    v_exp_f32 v114, v114
    v_exp_f32 v115, v115
    v_exp_f32 v116, v116
    v_mfma_f32_32x32x16_bf16 v[76:91], a[8:11], v[44:47], v[76:91]
    v_exp_f32 v117, v117
    v_exp_f32 v118, v118
    v_exp_f32 v119, v119
    v_exp_f32 v120, v120
    v_exp_f32 v121, v121
    v_exp_f32 v122, v122
    v_exp_f32 v123, v123
    v_smfmac_f32_32x32x32_bf16 v[196:211], a[32:35], v[108:115], v18
    v_exp_f32 v60, v60
    v_exp_f32 v61, v61
    v_exp_f32 v62, v62
    v_smfmac_f32_32x32x32_bf16 v[196:211], a[36:39], v[116:123], v18
    s_waitcnt vmcnt(16)
    v_exp_f32 v63, v63
    v_exp_f32 v64, v64
    v_exp_f32 v65, v65
    v_mfma_f32_32x32x4_2b_bf16 v[92:123], a[74:75], v[58:59], 0 cbsz:1 abid:0
    v_exp_f32 v66, v66
    v_exp_f32 v67, v67
    v_exp_f32 v68, v68
    v_exp_f32 v69, v69
    v_exp_f32 v70, v70
    v_exp_f32 v71, v71
    v_exp_f32 v72, v72
    v_exp_f32 v73, v73
    v_exp_f32 v74, v74
    v_exp_f32 v75, v75
    v_smfmac_f32_32x32x32_bf16 v[148:163], a[40:43], v[60:67], v18
    s_mov_b64 exec, s[62:63]
    buffer_load_dwordx4 a[24:27], v23, s[32:35], 0 offen offset:0 sc1
    buffer_load_dwordx4 a[28:31], v23, s[32:35], 0 offen offset:640 sc1
    buffer_load_dwordx4 a[32:35], v23, s[32:35], 0 offen offset:1280 sc1
    buffer_load_dwordx4 a[36:39], v23, s[32:35], 0 offen offset:1920 sc1
    s_mov_b64 exec, -1
    v_exp_f32 v76, v76
    v_exp_f32 v77, v77
    v_exp_f32 v78, v78
    v_smfmac_f32_32x32x32_bf16 v[148:163], a[44:47], v[68:75], v18
    s_add_u32 m0, s58, 0
    v_exp_f32 v79, v79
    v_exp_f32 v80, v80
    v_exp_f32 v81, v81
    v_mfma_f32_32x32x16_bf16 v[92:107], a[8:11], v[48:51], v[92:107]
    v_exp_f32 v82, v82
    v_exp_f32 v83, v83
    v_exp_f32 v84, v84
    v_mfma_f32_32x32x16_bf16 v[108:123], a[8:11], v[52:55], v[108:123]
    buffer_load_dwordx4 v28, s[24:27], 0 offen lds
    v_exp_f32 v85, v85
    v_exp_f32 v86, v86
    v_exp_f32 v87, v87
    v_exp_f32 v88, v88
    v_exp_f32 v89, v89
    v_exp_f32 v90, v90
    v_exp_f32 v91, v91
    v_smfmac_f32_32x32x32_bf16 v[164:179], a[40:43], v[76:83], v18
    s_add_u32 s32, s32, 5120
    v_exp_f32 v92, v92
    v_exp_f32 v93, v93
    v_exp_f32 v94, v94
    v_smfmac_f32_32x32x32_bf16 v[164:179], a[44:47], v[84:91], v18
    s_addc_u32 s33, s33, 0
    v_exp_f32 v95, v95
    v_exp_f32 v96, v96
    v_exp_f32 v97, v97
    v_mfma_f32_32x32x4_2b_bf16 v[60:91], a[74:75], v[56:57], 0 cbsz:1 abid:1
    v_exp_f32 v98, v98
    v_exp_f32 v99, v99
    v_exp_f32 v100, v100
    v_exp_f32 v101, v101
    v_exp_f32 v102, v102
    v_exp_f32 v103, v103
    v_exp_f32 v104, v104
    v_exp_f32 v105, v105
    v_exp_f32 v106, v106
    v_exp_f32 v107, v107
    v_smfmac_f32_32x32x32_bf16 v[180:195], a[40:43], v[92:99], v18
    v_exp_f32 v108, v108
    v_exp_f32 v109, v109
    v_exp_f32 v110, v110
    v_smfmac_f32_32x32x32_bf16 v[180:195], a[44:47], v[100:107], v18
    s_add_u32 m0, s100, 10240
    v_exp_f32 v111, v111
    v_exp_f32 v112, v112
    v_exp_f32 v113, v113
    v_mfma_f32_32x32x16_bf16 v[60:75], a[12:15], v[40:43], v[60:75]
    buffer_load_dwordx4 v37, s[36:39], 0 offen offset:3072 lds
    v_exp_f32 v114, v114
    v_exp_f32 v115, v115
    v_exp_f32 v116, v116
    v_mfma_f32_32x32x16_bf16 v[76:91], a[12:15], v[44:47], v[76:91]
    v_exp_f32 v117, v117
    v_exp_f32 v118, v118
    v_exp_f32 v119, v119
    v_exp_f32 v120, v120
    v_exp_f32 v121, v121
    v_exp_f32 v122, v122
    v_exp_f32 v123, v123
    v_smfmac_f32_32x32x32_bf16 v[196:211], a[40:43], v[108:115], v18
    s_add_u32 s24, s24, s54
    v_exp_f32 v60, v60
    v_exp_f32 v61, v61
    v_exp_f32 v62, v62
    v_smfmac_f32_32x32x32_bf16 v[196:211], a[44:47], v[116:123], v18
    s_addc_u32 s25, s25, 0
    v_exp_f32 v63, v63
    v_exp_f32 v64, v64
    v_exp_f32 v65, v65
    v_mfma_f32_32x32x4_2b_bf16 v[92:123], a[74:75], v[58:59], 0 cbsz:1 abid:1
    v_exp_f32 v66, v66
    v_exp_f32 v67, v67
    v_exp_f32 v68, v68
    v_exp_f32 v69, v69
    v_exp_f32 v70, v70
    v_exp_f32 v71, v71
    v_exp_f32 v72, v72
    v_exp_f32 v73, v73
    v_exp_f32 v74, v74
    v_exp_f32 v75, v75
    v_smfmac_f32_32x32x32_bf16 v[148:163], a[48:51], v[60:67], v18
    v_exp_f32 v76, v76
    v_exp_f32 v77, v77
    v_exp_f32 v78, v78
    v_smfmac_f32_32x32x32_bf16 v[148:163], a[52:55], v[68:75], v18
    s_add_u32 m0, s100, 14336
    v_exp_f32 v79, v79
    v_exp_f32 v80, v80
    v_exp_f32 v81, v81
    v_mfma_f32_32x32x16_bf16 v[92:107], a[12:15], v[48:51], v[92:107]
    buffer_load_dwordx4 v38, s[36:39], 0 offen offset:0 lds
    v_exp_f32 v82, v82
    v_exp_f32 v83, v83
    v_exp_f32 v84, v84
    v_mfma_f32_32x32x16_bf16 v[108:123], a[12:15], v[52:55], v[108:123]
    v_exp_f32 v85, v85
    v_exp_f32 v86, v86
    v_exp_f32 v87, v87
    v_exp_f32 v88, v88
    v_exp_f32 v89, v89
    v_exp_f32 v90, v90
    v_exp_f32 v91, v91
    v_smfmac_f32_32x32x32_bf16 v[164:179], a[48:51], v[76:83], v18
    s_add_u32 s36, s36, 40960
    v_exp_f32 v92, v92
    v_exp_f32 v93, v93
    v_exp_f32 v94, v94
    v_smfmac_f32_32x32x32_bf16 v[164:179], a[52:55], v[84:91], v18
    s_waitcnt vmcnt(18)
    v_exp_f32 v95, v95
    v_exp_f32 v96, v96
    v_exp_f32 v97, v97
    v_mfma_f32_32x32x4_2b_bf16 v[60:91], a[76:77], v[56:57], 0 cbsz:1 abid:0
    v_exp_f32 v98, v98
    v_exp_f32 v99, v99
    v_exp_f32 v100, v100
    v_exp_f32 v101, v101
    v_exp_f32 v102, v102
    v_exp_f32 v103, v103
    v_exp_f32 v104, v104
    v_exp_f32 v105, v105
    v_exp_f32 v106, v106
    v_exp_f32 v107, v107
    v_smfmac_f32_32x32x32_bf16 v[180:195], a[48:51], v[92:99], v18
    s_addc_u32 s37, s37, 0
    v_exp_f32 v108, v108
    v_exp_f32 v109, v109
    v_exp_f32 v110, v110
    v_smfmac_f32_32x32x32_bf16 v[180:195], a[52:55], v[100:107], v18
    s_add_u32 m0, s58, 1024
    v_exp_f32 v111, v111
    v_exp_f32 v112, v112
    v_exp_f32 v113, v113
    v_mfma_f32_32x32x16_bf16 v[60:75], a[16:19], v[40:43], v[60:75]
    buffer_load_dwordx4 a[8:11], v19, s[4:7], 0 offen offset:2048 sc1
    buffer_load_dwordx2 a[74:75], v20, s[4:7], 0 offen offset:2048 sc1
    buffer_load_dwordx4 a[12:15], v19, s[4:7], 0 offen offset:2560 sc1
    v_exp_f32 v114, v114
    v_exp_f32 v115, v115
    v_exp_f32 v116, v116
    v_mfma_f32_32x32x16_bf16 v[76:91], a[16:19], v[44:47], v[76:91]
    buffer_load_dwordx4 v29, s[28:31], 0 offen lds
    v_exp_f32 v117, v117
    v_exp_f32 v118, v118
    v_exp_f32 v119, v119
    v_exp_f32 v120, v120
    v_exp_f32 v121, v121
    v_exp_f32 v122, v122
    v_exp_f32 v123, v123
    v_smfmac_f32_32x32x32_bf16 v[196:211], a[48:51], v[108:115], v18
    v_exp_f32 v60, v60
    v_exp_f32 v61, v61
    v_exp_f32 v62, v62
    v_smfmac_f32_32x32x32_bf16 v[196:211], a[52:55], v[116:123], v18
    s_waitcnt vmcnt(17)
    v_exp_f32 v63, v63
    v_exp_f32 v64, v64
    v_exp_f32 v65, v65
    v_mfma_f32_32x32x4_2b_bf16 v[92:123], a[76:77], v[58:59], 0 cbsz:1 abid:0
    v_exp_f32 v66, v66
    v_exp_f32 v67, v67
    v_exp_f32 v68, v68
    v_exp_f32 v69, v69
    v_exp_f32 v70, v70
    v_exp_f32 v71, v71
    v_exp_f32 v72, v72
    v_exp_f32 v73, v73
    v_exp_f32 v74, v74
    v_exp_f32 v75, v75
    v_smfmac_f32_32x32x32_bf16 v[148:163], a[56:59], v[60:67], v18
    s_mov_b64 exec, s[62:63]
    buffer_load_dwordx4 a[40:43], v22, s[32:35], 0 offen offset:0 sc1
    buffer_load_dwordx4 a[44:47], v22, s[32:35], 0 offen offset:640 sc1
    buffer_load_dwordx4 a[48:51], v22, s[32:35], 0 offen offset:1280 sc1
    buffer_load_dwordx4 a[52:55], v22, s[32:35], 0 offen offset:1920 sc1
    s_mov_b64 exec, -1
    v_exp_f32 v76, v76
    v_exp_f32 v77, v77
    v_exp_f32 v78, v78
    v_smfmac_f32_32x32x32_bf16 v[148:163], a[60:63], v[68:75], v18
    s_add_u32 m0, s58, 2048
    v_exp_f32 v79, v79
    v_exp_f32 v80, v80
    v_exp_f32 v81, v81
    v_mfma_f32_32x32x16_bf16 v[92:107], a[16:19], v[48:51], v[92:107]
    v_exp_f32 v82, v82
    v_exp_f32 v83, v83
    v_exp_f32 v84, v84
    v_mfma_f32_32x32x16_bf16 v[108:123], a[16:19], v[52:55], v[108:123]
    buffer_load_dwordx4 v28, s[24:27], 0 offen lds
    v_exp_f32 v85, v85
    v_exp_f32 v86, v86
    v_exp_f32 v87, v87
    v_exp_f32 v88, v88
    v_exp_f32 v89, v89
    v_exp_f32 v90, v90
    v_exp_f32 v91, v91
    v_smfmac_f32_32x32x32_bf16 v[164:179], a[56:59], v[76:83], v18
    s_add_u32 s28, s28, s54
    v_exp_f32 v92, v92
    v_exp_f32 v93, v93
    v_exp_f32 v94, v94
    v_smfmac_f32_32x32x32_bf16 v[164:179], a[60:63], v[84:91], v18
    s_addc_u32 s29, s29, 0
    v_exp_f32 v95, v95
    v_exp_f32 v96, v96
    v_exp_f32 v97, v97
    v_mfma_f32_32x32x4_2b_bf16 v[60:91], a[76:77], v[56:57], 0 cbsz:1 abid:1
    v_exp_f32 v98, v98
    v_exp_f32 v99, v99
    v_exp_f32 v100, v100
    v_exp_f32 v101, v101
    v_exp_f32 v102, v102
    v_exp_f32 v103, v103
    v_exp_f32 v104, v104
    v_exp_f32 v105, v105
    v_exp_f32 v106, v106
    v_exp_f32 v107, v107
    v_smfmac_f32_32x32x32_bf16 v[180:195], a[56:59], v[92:99], v18
    v_exp_f32 v108, v108
    v_exp_f32 v109, v109
    v_exp_f32 v110, v110
    v_smfmac_f32_32x32x32_bf16 v[180:195], a[60:63], v[100:107], v18
    s_add_u32 m0, s100, 15360
    v_exp_f32 v111, v111
    v_exp_f32 v112, v112
    v_exp_f32 v113, v113
    v_mfma_f32_32x32x16_bf16 v[60:75], a[20:23], v[40:43], v[60:75]
    buffer_load_dwordx4 v34, s[36:39], 0 offen offset:0 lds
    buffer_load_dwordx4 v35, s[36:39], 0 offen offset:1024 lds
    v_exp_f32 v114, v114
    v_exp_f32 v115, v115
    v_exp_f32 v116, v116
    v_mfma_f32_32x32x16_bf16 v[76:91], a[20:23], v[44:47], v[76:91]
    buffer_load_dwordx4 v36, s[36:39], 0 offen offset:2048 lds
    v_exp_f32 v117, v117
    v_exp_f32 v118, v118
    v_exp_f32 v119, v119
    v_exp_f32 v120, v120
    v_exp_f32 v121, v121
    v_exp_f32 v122, v122
    v_exp_f32 v123, v123
    v_smfmac_f32_32x32x32_bf16 v[196:211], a[56:59], v[108:115], v18
    s_add_u32 s24, s24, s54
    v_exp_f32 v60, v60
    v_exp_f32 v61, v61
    v_exp_f32 v62, v62
    v_smfmac_f32_32x32x32_bf16 v[196:211], a[60:63], v[116:123], v18
    s_addc_u32 s25, s25, 0
    v_exp_f32 v63, v63
    v_exp_f32 v64, v64
    v_exp_f32 v65, v65
    v_mfma_f32_32x32x4_2b_bf16 v[92:123], a[76:77], v[58:59], 0 cbsz:1 abid:1
    v_exp_f32 v66, v66
    v_exp_f32 v67, v67
    v_exp_f32 v68, v68
    v_exp_f32 v69, v69
    v_exp_f32 v70, v70
    v_exp_f32 v71, v71
    v_exp_f32 v72, v72
    v_exp_f32 v73, v73
    v_exp_f32 v74, v74
    v_exp_f32 v75, v75
    v_smfmac_f32_32x32x32_bf16 v[148:163], a[64:67], v[60:67], v18
    v_exp_f32 v76, v76
    v_exp_f32 v77, v77
    v_exp_f32 v78, v78
    v_smfmac_f32_32x32x32_bf16 v[148:163], a[68:71], v[68:75], v18
    v_exp_f32 v79, v79
    v_exp_f32 v80, v80
    v_exp_f32 v81, v81
    v_mfma_f32_32x32x16_bf16 v[92:107], a[20:23], v[48:51], v[92:107]
    v_exp_f32 v82, v82
    v_exp_f32 v83, v83
    v_exp_f32 v84, v84
    v_mfma_f32_32x32x16_bf16 v[108:123], a[20:23], v[52:55], v[108:123]
    v_exp_f32 v85, v85
    v_exp_f32 v86, v86
    v_exp_f32 v87, v87
    v_exp_f32 v88, v88
    v_exp_f32 v89, v89
    v_exp_f32 v90, v90
    v_exp_f32 v91, v91
    v_smfmac_f32_32x32x32_bf16 v[164:179], a[64:67], v[76:83], v18
    v_exp_f32 v92, v92
    v_exp_f32 v93, v93
    v_exp_f32 v94, v94
    v_smfmac_f32_32x32x32_bf16 v[164:179], a[68:71], v[84:91], v18
    s_waitcnt vmcnt(19)
    v_exp_f32 v95, v95
    v_exp_f32 v96, v96
    v_exp_f32 v97, v97
    v_mfma_f32_32x32x4_2b_bf16 v[60:91], a[72:73], v[56:57], 0 cbsz:1 abid:0
    v_exp_f32 v98, v98
    v_exp_f32 v99, v99
    v_exp_f32 v100, v100
    v_exp_f32 v101, v101
    v_exp_f32 v102, v102
    v_exp_f32 v103, v103
    v_exp_f32 v104, v104
    v_exp_f32 v105, v105
    v_exp_f32 v106, v106
    v_exp_f32 v107, v107
    v_smfmac_f32_32x32x32_bf16 v[180:195], a[64:67], v[92:99], v18
    v_exp_f32 v108, v108
    v_exp_f32 v109, v109
    v_exp_f32 v110, v110
    v_smfmac_f32_32x32x32_bf16 v[180:195], a[68:71], v[100:107], v18
    s_add_u32 m0, s58, 3072
    v_exp_f32 v111, v111
    v_exp_f32 v112, v112
    v_exp_f32 v113, v113
    v_mfma_f32_32x32x16_bf16 v[60:75], a[0:3], v[40:43], v[60:75]
    buffer_load_dwordx4 a[16:19], v19, s[4:7], 0 offen offset:3072 sc1
    buffer_load_dwordx2 a[76:77], v20, s[4:7], 0 offen offset:3072 sc1
    buffer_load_dwordx4 a[20:23], v19, s[4:7], 0 offen offset:3584 sc1
    v_exp_f32 v114, v114
    v_exp_f32 v115, v115
    v_exp_f32 v116, v116
    v_mfma_f32_32x32x16_bf16 v[76:91], a[0:3], v[44:47], v[76:91]
    buffer_load_dwordx4 v29, s[28:31], 0 offen lds
    v_exp_f32 v117, v117
    v_exp_f32 v118, v118
    v_exp_f32 v119, v119
    v_exp_f32 v120, v120
    v_exp_f32 v121, v121
    v_exp_f32 v122, v122
    v_exp_f32 v123, v123
    v_smfmac_f32_32x32x32_bf16 v[196:211], a[64:67], v[108:115], v18
    s_add_u32 s28, s28, s54
    s_addc_u32 s29, s29, 0
    v_exp_f32 v60, v60
    v_exp_f32 v61, v61
    v_exp_f32 v62, v62
    v_smfmac_f32_32x32x32_bf16 v[196:211], a[68:71], v[116:123], v18
    s_waitcnt vmcnt(19)
    v_exp_f32 v63, v63
    v_exp_f32 v64, v64
    v_exp_f32 v65, v65
    v_mfma_f32_32x32x4_2b_bf16 v[92:123], a[72:73], v[58:59], 0 cbsz:1 abid:0
    v_exp_f32 v66, v66
    v_exp_f32 v67, v67
    v_exp_f32 v68, v68
    v_exp_f32 v69, v69
    v_exp_f32 v70, v70
    v_exp_f32 v71, v71
    v_exp_f32 v72, v72
    v_exp_f32 v73, v73
    v_exp_f32 v74, v74
    v_exp_f32 v75, v75
    v_smfmac_f32_32x32x32_bf16 v[148:163], a[24:27], v[60:67], v18
    s_mov_b64 exec, s[62:63]
    buffer_load_dwordx4 a[56:59], v23, s[32:35], 0 offen offset:0 sc1
    buffer_load_dwordx4 a[60:63], v23, s[32:35], 0 offen offset:640 sc1
    buffer_load_dwordx4 a[64:67], v23, s[32:35], 0 offen offset:1280 sc1
    buffer_load_dwordx4 a[68:71], v23, s[32:35], 0 offen offset:1920 sc1
    s_mov_b64 exec, -1
    v_exp_f32 v76, v76
    v_exp_f32 v77, v77
    v_exp_f32 v78, v78
    v_smfmac_f32_32x32x32_bf16 v[148:163], a[28:31], v[68:75], v18
    s_add_u32 m0, s58, 4096
    v_exp_f32 v79, v79
    v_exp_f32 v80, v80
    v_exp_f32 v81, v81
    v_mfma_f32_32x32x16_bf16 v[92:107], a[0:3], v[48:51], v[92:107]
    v_exp_f32 v82, v82
    v_exp_f32 v83, v83
    v_exp_f32 v84, v84
    v_mfma_f32_32x32x16_bf16 v[108:123], a[0:3], v[52:55], v[108:123]
    buffer_load_dwordx4 v28, s[24:27], 0 offen lds
    v_exp_f32 v85, v85
    v_exp_f32 v86, v86
    v_exp_f32 v87, v87
    v_exp_f32 v88, v88
    v_exp_f32 v89, v89
    v_exp_f32 v90, v90
    v_exp_f32 v91, v91
    v_smfmac_f32_32x32x32_bf16 v[164:179], a[24:27], v[76:83], v18
    s_add_u32 s32, s32, 5120
    v_exp_f32 v92, v92
    v_exp_f32 v93, v93
    v_exp_f32 v94, v94
    v_smfmac_f32_32x32x32_bf16 v[164:179], a[28:31], v[84:91], v18
    s_addc_u32 s33, s33, 0
    v_exp_f32 v95, v95
    v_exp_f32 v96, v96
    v_exp_f32 v97, v97
    v_mfma_f32_32x32x4_2b_bf16 v[60:91], a[72:73], v[56:57], 0 cbsz:1 abid:1
    v_exp_f32 v98, v98
    v_exp_f32 v99, v99
    v_exp_f32 v100, v100
    v_exp_f32 v101, v101
    v_exp_f32 v102, v102
    v_exp_f32 v103, v103
    v_exp_f32 v104, v104
    v_exp_f32 v105, v105
    v_exp_f32 v106, v106
    v_exp_f32 v107, v107
    v_smfmac_f32_32x32x32_bf16 v[180:195], a[24:27], v[92:99], v18
    s_add_u32 s24, s24, s54
    s_addc_u32 s25, s25, 0
    v_exp_f32 v108, v108
    v_exp_f32 v109, v109
    v_exp_f32 v110, v110
    v_smfmac_f32_32x32x32_bf16 v[180:195], a[28:31], v[100:107], v18
    s_add_u32 m0, s100, 15360
    v_exp_f32 v111, v111
    v_exp_f32 v112, v112
    v_exp_f32 v113, v113
    v_mfma_f32_32x32x16_bf16 v[60:75], a[4:7], v[40:43], v[60:75]
    buffer_load_dwordx4 v37, s[36:39], 0 offen offset:3072 lds
    v_exp_f32 v114, v114
    v_exp_f32 v115, v115
    v_exp_f32 v116, v116
    v_mfma_f32_32x32x16_bf16 v[76:91], a[4:7], v[44:47], v[76:91]
    v_exp_f32 v117, v117
    v_exp_f32 v118, v118
    v_exp_f32 v119, v119
    v_exp_f32 v120, v120
    v_exp_f32 v121, v121
    v_exp_f32 v122, v122
    v_exp_f32 v123, v123
    v_smfmac_f32_32x32x32_bf16 v[196:211], a[24:27], v[108:115], v18
    s_add_u32 s4, s4, 4096
    v_exp_f32 v60, v60
    v_exp_f32 v61, v61
    v_exp_f32 v62, v62
    v_smfmac_f32_32x32x32_bf16 v[196:211], a[28:31], v[116:123], v18
    s_addc_u32 s5, s5, 0
    v_exp_f32 v63, v63
    v_exp_f32 v64, v64
    v_exp_f32 v65, v65
    v_mfma_f32_32x32x4_2b_bf16 v[92:123], a[72:73], v[58:59], 0 cbsz:1 abid:1
    v_exp_f32 v66, v66
    v_exp_f32 v67, v67
    v_exp_f32 v68, v68
    v_exp_f32 v69, v69
    v_exp_f32 v70, v70
    v_exp_f32 v71, v71
    v_exp_f32 v72, v72
    v_exp_f32 v73, v73
    v_exp_f32 v74, v74
    v_exp_f32 v75, v75
    v_smfmac_f32_32x32x32_bf16 v[148:163], a[32:35], v[60:67], v18
    v_exp_f32 v76, v76
    v_exp_f32 v77, v77
    v_exp_f32 v78, v78
    v_smfmac_f32_32x32x32_bf16 v[148:163], a[36:39], v[68:75], v18
    s_add_u32 m0, s100, 19456
    v_exp_f32 v79, v79
    v_exp_f32 v80, v80
    v_exp_f32 v81, v81
    v_mfma_f32_32x32x16_bf16 v[92:107], a[4:7], v[48:51], v[92:107]
    buffer_load_dwordx4 v38, s[36:39], 0 offen offset:0 lds
    v_exp_f32 v82, v82
    v_exp_f32 v83, v83
    v_exp_f32 v84, v84
    v_mfma_f32_32x32x16_bf16 v[108:123], a[4:7], v[52:55], v[108:123]
    v_exp_f32 v85, v85
    v_exp_f32 v86, v86
    v_exp_f32 v87, v87
    v_exp_f32 v88, v88
    v_exp_f32 v89, v89
    v_exp_f32 v90, v90
    v_exp_f32 v91, v91
    v_smfmac_f32_32x32x32_bf16 v[164:179], a[32:35], v[76:83], v18
    s_add_u32 s36, s36, 40960
    v_exp_f32 v92, v92
    v_exp_f32 v93, v93
    v_exp_f32 v94, v94
    v_smfmac_f32_32x32x32_bf16 v[164:179], a[36:39], v[84:91], v18
    s_waitcnt vmcnt(20)
    v_exp_f32 v95, v95
    v_exp_f32 v96, v96
    v_exp_f32 v97, v97
    v_mfma_f32_32x32x4_2b_bf16 v[60:91], a[74:75], v[56:57], 0 cbsz:1 abid:0
    v_exp_f32 v98, v98
    v_exp_f32 v99, v99
    v_exp_f32 v100, v100
    v_exp_f32 v101, v101
    v_exp_f32 v102, v102
    v_exp_f32 v103, v103
    v_exp_f32 v104, v104
    v_exp_f32 v105, v105
    v_exp_f32 v106, v106
    v_exp_f32 v107, v107
    v_smfmac_f32_32x32x32_bf16 v[180:195], a[32:35], v[92:99], v18
    s_addc_u32 s37, s37, 0
    v_exp_f32 v108, v108
    v_exp_f32 v109, v109
    v_exp_f32 v110, v110
    v_smfmac_f32_32x32x32_bf16 v[180:195], a[36:39], v[100:107], v18
    s_add_u32 m0, s58, 5120
    v_exp_f32 v111, v111
    v_exp_f32 v112, v112
    v_exp_f32 v113, v113
    v_mfma_f32_32x32x16_bf16 v[60:75], a[8:11], v[40:43], v[60:75]
    buffer_load_dwordx4 a[0:3], v19, s[4:7], 0 offen offset:0 sc1
    buffer_load_dwordx2 a[72:73], v20, s[4:7], 0 offen offset:0 sc1
    buffer_load_dwordx4 a[4:7], v19, s[4:7], 0 offen offset:512 sc1
    v_exp_f32 v114, v114
    v_exp_f32 v115, v115
    v_exp_f32 v116, v116
    v_mfma_f32_32x32x16_bf16 v[76:91], a[8:11], v[44:47], v[76:91]
    buffer_load_dwordx4 v29, s[28:31], 0 offen lds
    v_exp_f32 v117, v117
    v_exp_f32 v118, v118
    v_exp_f32 v119, v119
    v_exp_f32 v120, v120
    v_exp_f32 v121, v121
    v_exp_f32 v122, v122
    v_exp_f32 v123, v123
    v_smfmac_f32_32x32x32_bf16 v[196:211], a[32:35], v[108:115], v18
    v_exp_f32 v60, v60
    v_exp_f32 v61, v61
    v_exp_f32 v62, v62
    v_smfmac_f32_32x32x32_bf16 v[196:211], a[36:39], v[116:123], v18
    s_waitcnt vmcnt(19)
    v_exp_f32 v63, v63
    v_exp_f32 v64, v64
    v_exp_f32 v65, v65
    v_mfma_f32_32x32x4_2b_bf16 v[92:123], a[74:75], v[58:59], 0 cbsz:1 abid:0
    v_exp_f32 v66, v66
    v_exp_f32 v67, v67
    v_exp_f32 v68, v68
    v_exp_f32 v69, v69
    v_exp_f32 v70, v70
    v_exp_f32 v71, v71
    v_exp_f32 v72, v72
    v_exp_f32 v73, v73
    v_exp_f32 v74, v74
    v_exp_f32 v75, v75
    v_smfmac_f32_32x32x32_bf16 v[148:163], a[40:43], v[60:67], v18
    s_mov_b64 exec, s[62:63]
    buffer_load_dwordx4 a[24:27], v22, s[32:35], 0 offen offset:0 sc1
    buffer_load_dwordx4 a[28:31], v22, s[32:35], 0 offen offset:640 sc1
    buffer_load_dwordx4 a[32:35], v22, s[32:35], 0 offen offset:1280 sc1
    buffer_load_dwordx4 a[36:39], v22, s[32:35], 0 offen offset:1920 sc1
    s_mov_b64 exec, -1
    v_exp_f32 v76, v76
    v_exp_f32 v77, v77
    v_exp_f32 v78, v78
    v_smfmac_f32_32x32x32_bf16 v[148:163], a[44:47], v[68:75], v18
    s_add_u32 m0, s58, 6144
    v_exp_f32 v79, v79
    v_exp_f32 v80, v80
    v_exp_f32 v81, v81
    v_mfma_f32_32x32x16_bf16 v[92:107], a[8:11], v[48:51], v[92:107]
    v_exp_f32 v82, v82
    v_exp_f32 v83, v83
    v_exp_f32 v84, v84
    v_mfma_f32_32x32x16_bf16 v[108:123], a[8:11], v[52:55], v[108:123]
    buffer_load_dwordx4 v28, s[24:27], 0 offen lds
    v_exp_f32 v85, v85
    v_exp_f32 v86, v86
    v_exp_f32 v87, v87
    v_exp_f32 v88, v88
    v_exp_f32 v89, v89
    v_exp_f32 v90, v90
    v_exp_f32 v91, v91
    v_smfmac_f32_32x32x32_bf16 v[164:179], a[40:43], v[76:83], v18
    s_add_u32 s28, s28, s54
    v_exp_f32 v92, v92
    v_exp_f32 v93, v93
    v_exp_f32 v94, v94
    v_smfmac_f32_32x32x32_bf16 v[164:179], a[44:47], v[84:91], v18
    s_addc_u32 s29, s29, 0
    v_exp_f32 v95, v95
    v_exp_f32 v96, v96
    v_exp_f32 v97, v97
    v_mfma_f32_32x32x4_2b_bf16 v[60:91], a[74:75], v[56:57], 0 cbsz:1 abid:1
    v_exp_f32 v98, v98
    v_exp_f32 v99, v99
    v_exp_f32 v100, v100
    v_exp_f32 v101, v101
    v_exp_f32 v102, v102
    v_exp_f32 v103, v103
    v_exp_f32 v104, v104
    v_exp_f32 v105, v105
    v_exp_f32 v106, v106
    v_exp_f32 v107, v107
    v_smfmac_f32_32x32x32_bf16 v[180:195], a[40:43], v[92:99], v18
    v_exp_f32 v108, v108
    v_exp_f32 v109, v109
    v_exp_f32 v110, v110
    v_smfmac_f32_32x32x32_bf16 v[180:195], a[44:47], v[100:107], v18
    s_add_u32 m0, s100, 20480
    v_exp_f32 v111, v111
    v_exp_f32 v112, v112
    v_exp_f32 v113, v113
    v_mfma_f32_32x32x16_bf16 v[60:75], a[12:15], v[40:43], v[60:75]
    buffer_load_dwordx4 v34, s[36:39], 0 offen offset:0 lds
    buffer_load_dwordx4 v35, s[36:39], 0 offen offset:1024 lds
    v_exp_f32 v114, v114
    v_exp_f32 v115, v115
    v_exp_f32 v116, v116
    v_mfma_f32_32x32x16_bf16 v[76:91], a[12:15], v[44:47], v[76:91]
    buffer_load_dwordx4 v36, s[36:39], 0 offen offset:2048 lds
    v_exp_f32 v117, v117
    v_exp_f32 v118, v118
    v_exp_f32 v119, v119
    v_exp_f32 v120, v120
    v_exp_f32 v121, v121
    v_exp_f32 v122, v122
    v_exp_f32 v123, v123
    v_smfmac_f32_32x32x32_bf16 v[196:211], a[40:43], v[108:115], v18
    s_add_u32 s24, s24, s54
    v_exp_f32 v60, v60
    v_exp_f32 v61, v61
    v_exp_f32 v62, v62
    v_smfmac_f32_32x32x32_bf16 v[196:211], a[44:47], v[116:123], v18
    s_addc_u32 s25, s25, 0
    v_exp_f32 v63, v63
    v_exp_f32 v64, v64
    v_exp_f32 v65, v65
    v_mfma_f32_32x32x4_2b_bf16 v[92:123], a[74:75], v[58:59], 0 cbsz:1 abid:1
    v_exp_f32 v66, v66
    v_exp_f32 v67, v67
    v_exp_f32 v68, v68
    v_exp_f32 v69, v69
    v_exp_f32 v70, v70
    v_exp_f32 v71, v71
    v_exp_f32 v72, v72
    v_exp_f32 v73, v73
    v_exp_f32 v74, v74
    v_exp_f32 v75, v75
    v_smfmac_f32_32x32x32_bf16 v[148:163], a[48:51], v[60:67], v18
    v_exp_f32 v76, v76
    v_exp_f32 v77, v77
    v_exp_f32 v78, v78
    v_smfmac_f32_32x32x32_bf16 v[148:163], a[52:55], v[68:75], v18
    v_exp_f32 v79, v79
    v_exp_f32 v80, v80
    v_exp_f32 v81, v81
    v_mfma_f32_32x32x16_bf16 v[92:107], a[12:15], v[48:51], v[92:107]
    v_exp_f32 v82, v82
    v_exp_f32 v83, v83
    v_exp_f32 v84, v84
    v_mfma_f32_32x32x16_bf16 v[108:123], a[12:15], v[52:55], v[108:123]
    v_exp_f32 v85, v85
    v_exp_f32 v86, v86
    v_exp_f32 v87, v87
    v_exp_f32 v88, v88
    v_exp_f32 v89, v89
    v_exp_f32 v90, v90
    v_exp_f32 v91, v91
    v_smfmac_f32_32x32x32_bf16 v[164:179], a[48:51], v[76:83], v18
    v_exp_f32 v92, v92
    v_exp_f32 v93, v93
    v_exp_f32 v94, v94
    v_smfmac_f32_32x32x32_bf16 v[164:179], a[52:55], v[84:91], v18
    s_waitcnt vmcnt(20)
    v_exp_f32 v95, v95
    v_exp_f32 v96, v96
    v_exp_f32 v97, v97
    v_mfma_f32_32x32x4_2b_bf16 v[60:91], a[76:77], v[56:57], 0 cbsz:1 abid:0
    v_exp_f32 v98, v98
    v_exp_f32 v99, v99
    v_exp_f32 v100, v100
    v_exp_f32 v101, v101
    v_exp_f32 v102, v102
    v_exp_f32 v103, v103
    v_exp_f32 v104, v104
    v_exp_f32 v105, v105
    v_exp_f32 v106, v106
    v_exp_f32 v107, v107
    v_smfmac_f32_32x32x32_bf16 v[180:195], a[48:51], v[92:99], v18
    v_exp_f32 v108, v108
    v_exp_f32 v109, v109
    v_exp_f32 v110, v110
    v_smfmac_f32_32x32x32_bf16 v[180:195], a[52:55], v[100:107], v18
    s_add_u32 m0, s58, 7168
    v_exp_f32 v111, v111
    v_exp_f32 v112, v112
    v_exp_f32 v113, v113
    v_mfma_f32_32x32x16_bf16 v[60:75], a[16:19], v[40:43], v[60:75]
    buffer_load_dwordx4 a[8:11], v19, s[4:7], 0 offen offset:1024 sc1
    buffer_load_dwordx2 a[74:75], v20, s[4:7], 0 offen offset:1024 sc1
    buffer_load_dwordx4 a[12:15], v19, s[4:7], 0 offen offset:1536 sc1
    v_exp_f32 v114, v114
    v_exp_f32 v115, v115
    v_exp_f32 v116, v116
    v_mfma_f32_32x32x16_bf16 v[76:91], a[16:19], v[44:47], v[76:91]
    buffer_load_dwordx4 v29, s[28:31], 0 offen lds
    v_exp_f32 v117, v117
    v_exp_f32 v118, v118
    v_exp_f32 v119, v119
    v_exp_f32 v120, v120
    v_exp_f32 v121, v121
    v_exp_f32 v122, v122
    v_exp_f32 v123, v123
    v_smfmac_f32_32x32x32_bf16 v[196:211], a[48:51], v[108:115], v18
    v_exp_f32 v60, v60
    v_exp_f32 v61, v61
    v_exp_f32 v62, v62
    v_smfmac_f32_32x32x32_bf16 v[196:211], a[52:55], v[116:123], v18
    s_waitcnt vmcnt(19)
    v_exp_f32 v63, v63
    v_exp_f32 v64, v64
    v_exp_f32 v65, v65
    v_mfma_f32_32x32x4_2b_bf16 v[92:123], a[76:77], v[58:59], 0 cbsz:1 abid:0
    v_exp_f32 v66, v66
    v_exp_f32 v67, v67
    v_exp_f32 v68, v68
PAD_3:
    s_cbranch_execz RET_E
    v_exp_f32 v69, v69
    v_exp_f32 v70, v70
    v_exp_f32 v71, v71
    v_exp_f32 v72, v72
    v_exp_f32 v73, v73
    v_exp_f32 v74, v74
    v_exp_f32 v75, v75
    v_smfmac_f32_32x32x32_bf16 v[148:163], a[56:59], v[60:67], v18
    s_mov_b64 exec, s[62:63]
    buffer_load_dwordx4 a[40:43], v23, s[32:35], 0 offen offset:0 sc1
    buffer_load_dwordx4 a[44:47], v23, s[32:35], 0 offen offset:640 sc1
    buffer_load_dwordx4 a[48:51], v23, s[32:35], 0 offen offset:1280 sc1
    buffer_load_dwordx4 a[52:55], v23, s[32:35], 0 offen offset:1920 sc1
    s_mov_b64 exec, -1
    v_exp_f32 v76, v76
    v_exp_f32 v77, v77
    v_exp_f32 v78, v78
    v_smfmac_f32_32x32x32_bf16 v[148:163], a[60:63], v[68:75], v18
    s_add_u32 m0, s58, 8192
    v_exp_f32 v79, v79
    v_exp_f32 v80, v80
    v_exp_f32 v81, v81
    v_mfma_f32_32x32x16_bf16 v[92:107], a[16:19], v[48:51], v[92:107]
    v_exp_f32 v82, v82
    v_exp_f32 v83, v83
    v_exp_f32 v84, v84
    v_mfma_f32_32x32x16_bf16 v[108:123], a[16:19], v[52:55], v[108:123]
    buffer_load_dwordx4 v28, s[24:27], 0 offen lds
    v_exp_f32 v85, v85
    v_exp_f32 v86, v86
    v_exp_f32 v87, v87
    v_exp_f32 v88, v88
    v_exp_f32 v89, v89
    v_exp_f32 v90, v90
    v_exp_f32 v91, v91
    v_smfmac_f32_32x32x32_bf16 v[164:179], a[56:59], v[76:83], v18
    s_add_u32 s32, s32, 5120
    v_exp_f32 v92, v92
    v_exp_f32 v93, v93
    v_exp_f32 v94, v94
    v_smfmac_f32_32x32x32_bf16 v[164:179], a[60:63], v[84:91], v18
    s_addc_u32 s33, s33, 0
    v_exp_f32 v95, v95
    v_exp_f32 v96, v96
    v_exp_f32 v97, v97
    v_mfma_f32_32x32x4_2b_bf16 v[60:91], a[76:77], v[56:57], 0 cbsz:1 abid:1
    v_exp_f32 v98, v98
    v_exp_f32 v99, v99
    v_exp_f32 v100, v100
    v_exp_f32 v101, v101
    v_exp_f32 v102, v102
    v_exp_f32 v103, v103
    v_exp_f32 v104, v104
    v_exp_f32 v105, v105
    v_exp_f32 v106, v106
    v_exp_f32 v107, v107
    v_smfmac_f32_32x32x32_bf16 v[180:195], a[56:59], v[92:99], v18
    v_exp_f32 v108, v108
    v_exp_f32 v109, v109
    v_exp_f32 v110, v110
    v_smfmac_f32_32x32x32_bf16 v[180:195], a[60:63], v[100:107], v18
    s_add_u32 m0, s100, 20480
    v_exp_f32 v111, v111
    v_exp_f32 v112, v112
    v_exp_f32 v113, v113
    v_mfma_f32_32x32x16_bf16 v[60:75], a[20:23], v[40:43], v[60:75]
    buffer_load_dwordx4 v37, s[36:39], 0 offen offset:3072 lds
    v_exp_f32 v114, v114
    v_exp_f32 v115, v115
    v_exp_f32 v116, v116
    v_mfma_f32_32x32x16_bf16 v[76:91], a[20:23], v[44:47], v[76:91]
    v_exp_f32 v117, v117
    v_exp_f32 v118, v118
    v_exp_f32 v119, v119
    v_exp_f32 v120, v120
    v_exp_f32 v121, v121
    v_exp_f32 v122, v122
    v_exp_f32 v123, v123
    v_smfmac_f32_32x32x32_bf16 v[196:211], a[56:59], v[108:115], v18
    s_add_u32 s28, s28, s54
    v_exp_f32 v60, v60
    v_exp_f32 v61, v61
    v_exp_f32 v62, v62
    v_smfmac_f32_32x32x32_bf16 v[196:211], a[60:63], v[116:123], v18
    s_addc_u32 s29, s29, 0
    v_exp_f32 v63, v63
    v_exp_f32 v64, v64
    v_exp_f32 v65, v65
    v_mfma_f32_32x32x4_2b_bf16 v[92:123], a[76:77], v[58:59], 0 cbsz:1 abid:1
    v_exp_f32 v66, v66
    v_exp_f32 v67, v67
    v_exp_f32 v68, v68
    v_exp_f32 v69, v69
    v_exp_f32 v70, v70
    v_exp_f32 v71, v71
    v_exp_f32 v72, v72
    v_exp_f32 v73, v73
    v_exp_f32 v74, v74
    v_exp_f32 v75, v75
    v_smfmac_f32_32x32x32_bf16 v[148:163], a[64:67], v[60:67], v18
    v_exp_f32 v76, v76
    v_exp_f32 v77, v77
    v_exp_f32 v78, v78
    v_smfmac_f32_32x32x32_bf16 v[148:163], a[68:71], v[68:75], v18
    s_add_u32 m0, s100, 24576
    v_exp_f32 v79, v79
    v_exp_f32 v80, v80
    v_exp_f32 v81, v81
    v_mfma_f32_32x32x16_bf16 v[92:107], a[20:23], v[48:51], v[92:107]
    buffer_load_dwordx4 v38, s[36:39], 0 offen offset:0 lds
    v_exp_f32 v82, v82
    v_exp_f32 v83, v83
    v_exp_f32 v84, v84
    v_mfma_f32_32x32x16_bf16 v[108:123], a[20:23], v[52:55], v[108:123]
    v_exp_f32 v85, v85
    v_exp_f32 v86, v86
    v_exp_f32 v87, v87
    v_exp_f32 v88, v88
    v_exp_f32 v89, v89
    v_exp_f32 v90, v90
    v_exp_f32 v91, v91
    v_smfmac_f32_32x32x32_bf16 v[164:179], a[64:67], v[76:83], v18
    s_add_u32 s24, s24, s61
    v_exp_f32 v92, v92
    v_exp_f32 v93, v93
    v_exp_f32 v94, v94
    v_smfmac_f32_32x32x32_bf16 v[164:179], a[68:71], v[84:91], v18
    s_waitcnt vmcnt(20)
    v_exp_f32 v95, v95
    v_exp_f32 v96, v96
    v_exp_f32 v97, v97
    v_mfma_f32_32x32x4_2b_bf16 v[60:91], a[72:73], v[56:57], 0 cbsz:1 abid:0
    v_exp_f32 v98, v98
    v_exp_f32 v99, v99
    v_exp_f32 v100, v100
    v_exp_f32 v101, v101
    v_exp_f32 v102, v102
    v_exp_f32 v103, v103
    v_exp_f32 v104, v104
    v_exp_f32 v105, v105
    v_exp_f32 v106, v106
    v_exp_f32 v107, v107
    v_smfmac_f32_32x32x32_bf16 v[180:195], a[64:67], v[92:99], v18
    s_addc_u32 s25, s25, 0
    v_exp_f32 v108, v108
    v_exp_f32 v109, v109
    v_exp_f32 v110, v110
    v_smfmac_f32_32x32x32_bf16 v[180:195], a[68:71], v[100:107], v18
    s_add_u32 m0, s58, 9216
    v_exp_f32 v111, v111
    v_exp_f32 v112, v112
    v_exp_f32 v113, v113
    v_mfma_f32_32x32x16_bf16 v[60:75], a[0:3], v[40:43], v[60:75]
    buffer_load_dwordx4 a[16:19], v19, s[4:7], 0 offen offset:2048 sc1
    buffer_load_dwordx2 a[76:77], v20, s[4:7], 0 offen offset:2048 sc1
    buffer_load_dwordx4 a[20:23], v19, s[4:7], 0 offen offset:2560 sc1
    v_exp_f32 v114, v114
    v_exp_f32 v115, v115
    v_exp_f32 v116, v116
    v_mfma_f32_32x32x16_bf16 v[76:91], a[0:3], v[44:47], v[76:91]
    buffer_load_dwordx4 v29, s[28:31], 0 offen lds
    v_exp_f32 v117, v117
    v_exp_f32 v118, v118
    v_exp_f32 v119, v119
    v_exp_f32 v120, v120
    v_exp_f32 v121, v121
    v_exp_f32 v122, v122
    v_exp_f32 v123, v123
    v_smfmac_f32_32x32x32_bf16 v[196:211], a[64:67], v[108:115], v18
    v_exp_f32 v60, v60
    v_exp_f32 v61, v61
    v_exp_f32 v62, v62
    v_smfmac_f32_32x32x32_bf16 v[196:211], a[68:71], v[116:123], v18
    s_waitcnt vmcnt(19)
    v_exp_f32 v63, v63
    v_exp_f32 v64, v64
    v_exp_f32 v65, v65
    v_mfma_f32_32x32x4_2b_bf16 v[92:123], a[72:73], v[58:59], 0 cbsz:1 abid:0
    v_exp_f32 v66, v66
    v_exp_f32 v67, v67
    v_exp_f32 v68, v68
    v_exp_f32 v69, v69
    v_exp_f32 v70, v70
    v_exp_f32 v71, v71
    v_exp_f32 v72, v72
    v_exp_f32 v73, v73
    v_exp_f32 v74, v74
    v_exp_f32 v75, v75
    v_smfmac_f32_32x32x32_bf16 v[148:163], a[24:27], v[60:67], v18
    s_mov_b64 exec, s[62:63]
    buffer_load_dwordx4 a[56:59], v22, s[32:35], 0 offen offset:0 sc1
    buffer_load_dwordx4 a[60:63], v22, s[32:35], 0 offen offset:640 sc1
    buffer_load_dwordx4 a[64:67], v22, s[32:35], 0 offen offset:1280 sc1
    buffer_load_dwordx4 a[68:71], v22, s[32:35], 0 offen offset:1920 sc1
    s_mov_b64 exec, -1
    v_exp_f32 v76, v76
    v_exp_f32 v77, v77
    v_exp_f32 v78, v78
    v_smfmac_f32_32x32x32_bf16 v[148:163], a[28:31], v[68:75], v18
    s_add_u32 m0, s58, 10240
    v_exp_f32 v79, v79
    v_exp_f32 v80, v80
    v_exp_f32 v81, v81
    v_mfma_f32_32x32x16_bf16 v[92:107], a[0:3], v[48:51], v[92:107]
    v_exp_f32 v82, v82
    v_exp_f32 v83, v83
    v_exp_f32 v84, v84
    v_mfma_f32_32x32x16_bf16 v[108:123], a[0:3], v[52:55], v[108:123]
    buffer_load_dwordx4 v28, s[24:27], 0 offen lds
    v_exp_f32 v85, v85
    v_exp_f32 v86, v86
    v_exp_f32 v87, v87
    v_exp_f32 v88, v88
    v_exp_f32 v89, v89
    v_exp_f32 v90, v90
    v_exp_f32 v91, v91
    v_smfmac_f32_32x32x32_bf16 v[164:179], a[24:27], v[76:83], v18
    s_add_u32 s28, s28, s61
    v_exp_f32 v92, v92
    v_exp_f32 v93, v93
    v_exp_f32 v94, v94
    v_smfmac_f32_32x32x32_bf16 v[164:179], a[28:31], v[84:91], v18
    s_addc_u32 s29, s29, 0
    v_exp_f32 v95, v95
    v_exp_f32 v96, v96
    v_exp_f32 v97, v97
    v_mfma_f32_32x32x4_2b_bf16 v[60:91], a[72:73], v[56:57], 0 cbsz:1 abid:1
    v_exp_f32 v98, v98
    v_exp_f32 v99, v99
    v_exp_f32 v100, v100
    v_exp_f32 v101, v101
    v_exp_f32 v102, v102
    v_exp_f32 v103, v103
    v_exp_f32 v104, v104
    v_exp_f32 v105, v105
    v_exp_f32 v106, v106
    v_exp_f32 v107, v107
    v_smfmac_f32_32x32x32_bf16 v[180:195], a[24:27], v[92:99], v18
    v_exp_f32 v108, v108
    v_exp_f32 v109, v109
    v_exp_f32 v110, v110
    v_smfmac_f32_32x32x32_bf16 v[180:195], a[28:31], v[100:107], v18
    v_exp_f32 v111, v111
    v_exp_f32 v112, v112
    v_exp_f32 v113, v113
    v_mfma_f32_32x32x16_bf16 v[60:75], a[4:7], v[40:43], v[60:75]
    v_exp_f32 v114, v114
    v_exp_f32 v115, v115
    v_exp_f32 v116, v116
    v_mfma_f32_32x32x16_bf16 v[76:91], a[4:7], v[44:47], v[76:91]
    v_exp_f32 v117, v117
    v_exp_f32 v118, v118
    v_exp_f32 v119, v119
    v_exp_f32 v120, v120
    v_exp_f32 v121, v121
    v_exp_f32 v122, v122
    v_exp_f32 v123, v123
    v_smfmac_f32_32x32x32_bf16 v[196:211], a[24:27], v[108:115], v18
    v_exp_f32 v60, v60
    v_exp_f32 v61, v61
    v_exp_f32 v62, v62
    v_smfmac_f32_32x32x32_bf16 v[196:211], a[28:31], v[116:123], v18
    v_exp_f32 v63, v63
    v_exp_f32 v64, v64
    v_exp_f32 v65, v65
    v_mfma_f32_32x32x4_2b_bf16 v[92:123], a[72:73], v[58:59], 0 cbsz:1 abid:1
    v_exp_f32 v66, v66
    v_exp_f32 v67, v67
    v_exp_f32 v68, v68
    v_exp_f32 v69, v69
    v_exp_f32 v70, v70
    v_exp_f32 v71, v71
    v_exp_f32 v72, v72
    v_exp_f32 v73, v73
    v_exp_f32 v74, v74
    v_exp_f32 v75, v75
    v_smfmac_f32_32x32x32_bf16 v[148:163], a[32:35], v[60:67], v18
    v_exp_f32 v76, v76
    v_exp_f32 v77, v77
    v_exp_f32 v78, v78
    v_smfmac_f32_32x32x32_bf16 v[148:163], a[36:39], v[68:75], v18
    v_exp_f32 v79, v79
    v_exp_f32 v80, v80
    v_exp_f32 v81, v81
    v_mfma_f32_32x32x16_bf16 v[92:107], a[4:7], v[48:51], v[92:107]
    v_exp_f32 v82, v82
    v_exp_f32 v83, v83
    v_exp_f32 v84, v84
    v_mfma_f32_32x32x16_bf16 v[108:123], a[4:7], v[52:55], v[108:123]
    v_exp_f32 v85, v85
    v_exp_f32 v86, v86
    v_exp_f32 v87, v87
    v_exp_f32 v88, v88
    v_exp_f32 v89, v89
    v_exp_f32 v90, v90
    v_exp_f32 v91, v91
    v_smfmac_f32_32x32x32_bf16 v[164:179], a[32:35], v[76:83], v18
    v_exp_f32 v92, v92
    v_exp_f32 v93, v93
    v_exp_f32 v94, v94
    v_smfmac_f32_32x32x32_bf16 v[164:179], a[36:39], v[84:91], v18
    s_waitcnt vmcnt(17)
    v_exp_f32 v95, v95
    v_exp_f32 v96, v96
    v_exp_f32 v97, v97
    v_mfma_f32_32x32x4_2b_bf16 v[60:91], a[74:75], v[56:57], 0 cbsz:1 abid:0
    v_exp_f32 v98, v98
    v_exp_f32 v99, v99
    v_exp_f32 v100, v100
    v_exp_f32 v101, v101
    v_exp_f32 v102, v102
    v_exp_f32 v103, v103
    v_exp_f32 v104, v104
    v_exp_f32 v105, v105
    v_exp_f32 v106, v106
    v_exp_f32 v107, v107
    v_smfmac_f32_32x32x32_bf16 v[180:195], a[32:35], v[92:99], v18
    v_exp_f32 v108, v108
    v_exp_f32 v109, v109
    v_exp_f32 v110, v110
    v_smfmac_f32_32x32x32_bf16 v[180:195], a[36:39], v[100:107], v18
    s_add_u32 m0, s58, 11264
    v_exp_f32 v111, v111
    v_exp_f32 v112, v112
    v_exp_f32 v113, v113
    v_mfma_f32_32x32x16_bf16 v[60:75], a[8:11], v[40:43], v[60:75]
    buffer_load_dwordx4 a[0:3], v19, s[4:7], 0 offen offset:3072 sc1
    buffer_load_dwordx2 a[72:73], v20, s[4:7], 0 offen offset:3072 sc1
    buffer_load_dwordx4 a[4:7], v19, s[4:7], 0 offen offset:3584 sc1
    v_exp_f32 v114, v114
    v_exp_f32 v115, v115
    v_exp_f32 v116, v116
    v_mfma_f32_32x32x16_bf16 v[76:91], a[8:11], v[44:47], v[76:91]
    buffer_load_dwordx4 v29, s[28:31], 0 offen lds
    v_exp_f32 v117, v117
    v_exp_f32 v118, v118
    v_exp_f32 v119, v119
    v_exp_f32 v120, v120
    v_exp_f32 v121, v121
    v_exp_f32 v122, v122
    v_exp_f32 v123, v123
    v_smfmac_f32_32x32x32_bf16 v[196:211], a[32:35], v[108:115], v18
    v_exp_f32 v60, v60
    v_exp_f32 v61, v61
    v_exp_f32 v62, v62
    v_smfmac_f32_32x32x32_bf16 v[196:211], a[36:39], v[116:123], v18
    s_waitcnt vmcnt(16)
    v_exp_f32 v63, v63
    v_exp_f32 v64, v64
    v_exp_f32 v65, v65
    v_mfma_f32_32x32x4_2b_bf16 v[92:123], a[74:75], v[58:59], 0 cbsz:1 abid:0
    v_exp_f32 v66, v66
    v_exp_f32 v67, v67
    v_exp_f32 v68, v68
    v_exp_f32 v69, v69
    v_exp_f32 v70, v70
    v_exp_f32 v71, v71
    v_exp_f32 v72, v72
    v_exp_f32 v73, v73
    v_exp_f32 v74, v74
    v_exp_f32 v75, v75
    v_smfmac_f32_32x32x32_bf16 v[148:163], a[40:43], v[60:67], v18
    s_mov_b64 exec, s[62:63]
    buffer_load_dwordx4 a[24:27], v23, s[32:35], 0 offen offset:0 sc1
    buffer_load_dwordx4 a[28:31], v23, s[32:35], 0 offen offset:640 sc1
    buffer_load_dwordx4 a[32:35], v23, s[32:35], 0 offen offset:1280 sc1
    buffer_load_dwordx4 a[36:39], v23, s[32:35], 0 offen offset:1920 sc1
    s_mov_b64 exec, -1
    v_exp_f32 v76, v76
    v_exp_f32 v77, v77
    v_exp_f32 v78, v78
    v_smfmac_f32_32x32x32_bf16 v[148:163], a[44:47], v[68:75], v18
    v_exp_f32 v79, v79
    v_exp_f32 v80, v80
    v_exp_f32 v81, v81
    v_mfma_f32_32x32x16_bf16 v[92:107], a[8:11], v[48:51], v[92:107]
    v_exp_f32 v82, v82
    v_exp_f32 v83, v83
    v_exp_f32 v84, v84
    v_mfma_f32_32x32x16_bf16 v[108:123], a[8:11], v[52:55], v[108:123]
    buffer_load_dword v34, v27, s[12:15], 0 offen sc1
    v_exp_f32 v85, v85
    v_exp_f32 v86, v86
    v_exp_f32 v87, v87
    v_exp_f32 v88, v88
    v_exp_f32 v89, v89
    v_exp_f32 v90, v90
    v_exp_f32 v91, v91
    v_smfmac_f32_32x32x32_bf16 v[164:179], a[40:43], v[76:83], v18
    v_exp_f32 v92, v92
    v_exp_f32 v93, v93
    v_exp_f32 v94, v94
    v_smfmac_f32_32x32x32_bf16 v[164:179], a[44:47], v[84:91], v18
    v_exp_f32 v95, v95
    v_exp_f32 v96, v96
    v_exp_f32 v97, v97
    v_mfma_f32_32x32x4_2b_bf16 v[60:91], a[74:75], v[56:57], 0 cbsz:1 abid:1
    v_exp_f32 v98, v98
    v_exp_f32 v99, v99
    v_exp_f32 v100, v100
    v_exp_f32 v101, v101
    v_exp_f32 v102, v102
    v_exp_f32 v103, v103
    v_exp_f32 v104, v104
    v_exp_f32 v105, v105
    v_exp_f32 v106, v106
    v_exp_f32 v107, v107
    v_smfmac_f32_32x32x32_bf16 v[180:195], a[40:43], v[92:99], v18
    v_exp_f32 v108, v108
    v_exp_f32 v109, v109
    v_exp_f32 v110, v110
    v_smfmac_f32_32x32x32_bf16 v[180:195], a[44:47], v[100:107], v18
    v_exp_f32 v111, v111
    v_exp_f32 v112, v112
    v_exp_f32 v113, v113
    v_mfma_f32_32x32x16_bf16 v[60:75], a[12:15], v[40:43], v[60:75]
    buffer_load_dword v35, v26, s[12:15], 0 offen sc1
    v_exp_f32 v114, v114
    v_exp_f32 v115, v115
    v_exp_f32 v116, v116
    v_mfma_f32_32x32x16_bf16 v[76:91], a[12:15], v[44:47], v[76:91]
    v_exp_f32 v117, v117
    v_exp_f32 v118, v118
    v_exp_f32 v119, v119
    v_exp_f32 v120, v120
    v_exp_f32 v121, v121
    v_exp_f32 v122, v122
    v_exp_f32 v123, v123
    v_smfmac_f32_32x32x32_bf16 v[196:211], a[40:43], v[108:115], v18
    v_exp_f32 v60, v60
    v_exp_f32 v61, v61
    v_exp_f32 v62, v62
    v_smfmac_f32_32x32x32_bf16 v[196:211], a[44:47], v[116:123], v18
    v_exp_f32 v63, v63
    v_exp_f32 v64, v64
    v_exp_f32 v65, v65
    v_mfma_f32_32x32x4_2b_bf16 v[92:123], a[74:75], v[58:59], 0 cbsz:1 abid:1
    v_exp_f32 v66, v66
    v_exp_f32 v67, v67
    v_exp_f32 v68, v68
    v_exp_f32 v69, v69
    v_exp_f32 v70, v70
    v_exp_f32 v71, v71
    v_exp_f32 v72, v72
    v_exp_f32 v73, v73
    v_exp_f32 v74, v74
    v_exp_f32 v75, v75
    v_smfmac_f32_32x32x32_bf16 v[148:163], a[48:51], v[60:67], v18
    v_exp_f32 v76, v76
    v_exp_f32 v77, v77
    v_exp_f32 v78, v78
    v_smfmac_f32_32x32x32_bf16 v[148:163], a[52:55], v[68:75], v18
    v_exp_f32 v79, v79
    v_exp_f32 v80, v80
    v_exp_f32 v81, v81
    v_mfma_f32_32x32x16_bf16 v[92:107], a[12:15], v[48:51], v[92:107]
    v_exp_f32 v82, v82
    v_exp_f32 v83, v83
    v_exp_f32 v84, v84
    v_mfma_f32_32x32x16_bf16 v[108:123], a[12:15], v[52:55], v[108:123]
    v_exp_f32 v85, v85
    v_exp_f32 v86, v86
    v_exp_f32 v87, v87
    v_exp_f32 v88, v88
    v_exp_f32 v89, v89
    v_exp_f32 v90, v90
    v_exp_f32 v91, v91
    v_smfmac_f32_32x32x32_bf16 v[164:179], a[48:51], v[76:83], v18
    v_exp_f32 v92, v92
    v_exp_f32 v93, v93
    v_exp_f32 v94, v94
    v_smfmac_f32_32x32x32_bf16 v[164:179], a[52:55], v[84:91], v18
    s_waitcnt vmcnt(16)
    v_exp_f32 v95, v95
    v_exp_f32 v96, v96
    v_exp_f32 v97, v97
    v_mfma_f32_32x32x4_2b_bf16 v[60:91], a[76:77], v[56:57], 0 cbsz:1 abid:0
    v_exp_f32 v98, v98
    v_exp_f32 v99, v99
    v_exp_f32 v100, v100
    v_exp_f32 v101, v101
    v_exp_f32 v102, v102
    v_exp_f32 v103, v103
    v_exp_f32 v104, v104
    v_exp_f32 v105, v105
    v_exp_f32 v106, v106
    v_exp_f32 v107, v107
    v_smfmac_f32_32x32x32_bf16 v[180:195], a[48:51], v[92:99], v18
    v_exp_f32 v108, v108
    v_exp_f32 v109, v109
    v_exp_f32 v110, v110
    v_smfmac_f32_32x32x32_bf16 v[180:195], a[52:55], v[100:107], v18
    v_exp_f32 v111, v111
    v_exp_f32 v112, v112
    v_exp_f32 v113, v113
    v_mfma_f32_32x32x16_bf16 v[60:75], a[16:19], v[40:43], v[60:75]
    v_exp_f32 v114, v114
    v_exp_f32 v115, v115
    v_exp_f32 v116, v116
    v_mfma_f32_32x32x16_bf16 v[76:91], a[16:19], v[44:47], v[76:91]
    v_exp_f32 v117, v117
    v_exp_f32 v118, v118
    v_exp_f32 v119, v119
    v_exp_f32 v120, v120
    v_exp_f32 v121, v121
    v_exp_f32 v122, v122
    v_exp_f32 v123, v123
    v_smfmac_f32_32x32x32_bf16 v[196:211], a[48:51], v[108:115], v18
    v_exp_f32 v60, v60
    v_exp_f32 v61, v61
    v_exp_f32 v62, v62
    v_smfmac_f32_32x32x32_bf16 v[196:211], a[52:55], v[116:123], v18
    s_waitcnt vmcnt(11)
    v_exp_f32 v63, v63
    v_exp_f32 v64, v64
    v_exp_f32 v65, v65
    v_mfma_f32_32x32x4_2b_bf16 v[92:123], a[76:77], v[58:59], 0 cbsz:1 abid:0
    v_exp_f32 v66, v66
    v_exp_f32 v67, v67
    v_exp_f32 v68, v68
    v_exp_f32 v69, v69
    v_exp_f32 v70, v70
    v_exp_f32 v71, v71
    v_exp_f32 v72, v72
    v_exp_f32 v73, v73
    v_exp_f32 v74, v74
    v_exp_f32 v75, v75
    v_smfmac_f32_32x32x32_bf16 v[148:163], a[56:59], v[60:67], v18
    v_exp_f32 v76, v76
    v_exp_f32 v77, v77
    v_exp_f32 v78, v78
    v_smfmac_f32_32x32x32_bf16 v[148:163], a[60:63], v[68:75], v18
    v_exp_f32 v79, v79
    v_exp_f32 v80, v80
    v_exp_f32 v81, v81
    v_mfma_f32_32x32x16_bf16 v[92:107], a[16:19], v[48:51], v[92:107]
    v_exp_f32 v82, v82
    v_exp_f32 v83, v83
    v_exp_f32 v84, v84
    v_mfma_f32_32x32x16_bf16 v[108:123], a[16:19], v[52:55], v[108:123]
    v_exp_f32 v85, v85
    v_exp_f32 v86, v86
    v_exp_f32 v87, v87
    v_exp_f32 v88, v88
    v_exp_f32 v89, v89
    v_exp_f32 v90, v90
    v_exp_f32 v91, v91
    v_smfmac_f32_32x32x32_bf16 v[164:179], a[56:59], v[76:83], v18
    v_exp_f32 v92, v92
    v_exp_f32 v93, v93
    v_exp_f32 v94, v94
    v_smfmac_f32_32x32x32_bf16 v[164:179], a[60:63], v[84:91], v18
    v_exp_f32 v95, v95
    v_exp_f32 v96, v96
    v_exp_f32 v97, v97
    v_mfma_f32_32x32x4_2b_bf16 v[60:91], a[76:77], v[56:57], 0 cbsz:1 abid:1
    v_exp_f32 v98, v98
    v_exp_f32 v99, v99
    v_exp_f32 v100, v100
    v_exp_f32 v101, v101
    v_exp_f32 v102, v102
    v_exp_f32 v103, v103
    v_exp_f32 v104, v104
    v_exp_f32 v105, v105
    v_exp_f32 v106, v106
    v_exp_f32 v107, v107
    v_smfmac_f32_32x32x32_bf16 v[180:195], a[56:59], v[92:99], v18
    v_exp_f32 v108, v108
    v_exp_f32 v109, v109
    v_exp_f32 v110, v110
    v_smfmac_f32_32x32x32_bf16 v[180:195], a[60:63], v[100:107], v18
    v_exp_f32 v111, v111
    v_exp_f32 v112, v112
    v_exp_f32 v113, v113
    v_mfma_f32_32x32x16_bf16 v[60:75], a[20:23], v[40:43], v[60:75]
    v_exp_f32 v114, v114
    v_exp_f32 v115, v115
    v_exp_f32 v116, v116
    v_mfma_f32_32x32x16_bf16 v[76:91], a[20:23], v[44:47], v[76:91]
    v_exp_f32 v117, v117
    v_exp_f32 v118, v118
    v_exp_f32 v119, v119
    v_exp_f32 v120, v120
    v_exp_f32 v121, v121
    v_exp_f32 v122, v122
    v_exp_f32 v123, v123
    v_smfmac_f32_32x32x32_bf16 v[196:211], a[56:59], v[108:115], v18
    v_exp_f32 v60, v60
    v_exp_f32 v61, v61
    v_exp_f32 v62, v62
    v_smfmac_f32_32x32x32_bf16 v[196:211], a[60:63], v[116:123], v18
    v_exp_f32 v63, v63
    v_exp_f32 v64, v64
    v_exp_f32 v65, v65
    v_mfma_f32_32x32x4_2b_bf16 v[92:123], a[76:77], v[58:59], 0 cbsz:1 abid:1
    v_exp_f32 v66, v66
    v_exp_f32 v67, v67
    v_exp_f32 v68, v68
    v_exp_f32 v69, v69
    v_exp_f32 v70, v70
    v_exp_f32 v71, v71
    v_exp_f32 v72, v72
    v_exp_f32 v73, v73
    v_exp_f32 v74, v74
    v_exp_f32 v75, v75
    v_smfmac_f32_32x32x32_bf16 v[148:163], a[64:67], v[60:67], v18
    v_exp_f32 v76, v76
    v_exp_f32 v77, v77
    v_exp_f32 v78, v78
    v_smfmac_f32_32x32x32_bf16 v[148:163], a[68:71], v[68:75], v18
    v_exp_f32 v79, v79
    v_exp_f32 v80, v80
    v_exp_f32 v81, v81
    v_mfma_f32_32x32x16_bf16 v[92:107], a[20:23], v[48:51], v[92:107]
    v_exp_f32 v82, v82
    v_exp_f32 v83, v83
    v_exp_f32 v84, v84
    v_mfma_f32_32x32x16_bf16 v[108:123], a[20:23], v[52:55], v[108:123]
    v_exp_f32 v85, v85
    v_exp_f32 v86, v86
    v_exp_f32 v87, v87
    v_exp_f32 v88, v88
    v_exp_f32 v89, v89
    v_exp_f32 v90, v90
    v_exp_f32 v91, v91
    v_smfmac_f32_32x32x32_bf16 v[164:179], a[64:67], v[76:83], v18
    v_exp_f32 v92, v92
    v_exp_f32 v93, v93
    v_exp_f32 v94, v94
    v_smfmac_f32_32x32x32_bf16 v[164:179], a[68:71], v[84:91], v18
    s_waitcnt vmcnt(7)
    v_exp_f32 v95, v95
    v_exp_f32 v96, v96
    v_exp_f32 v97, v97
    v_mfma_f32_32x32x4_2b_bf16 v[60:91], a[72:73], v[56:57], 0 cbsz:1 abid:0
    v_exp_f32 v98, v98
    v_exp_f32 v99, v99
    v_exp_f32 v100, v100
    v_exp_f32 v101, v101
    v_exp_f32 v102, v102
    v_exp_f32 v103, v103
    v_exp_f32 v104, v104
    v_exp_f32 v105, v105
    v_exp_f32 v106, v106
    v_exp_f32 v107, v107
    v_smfmac_f32_32x32x32_bf16 v[180:195], a[64:67], v[92:99], v18
    v_exp_f32 v108, v108
    v_exp_f32 v109, v109
    v_exp_f32 v110, v110
    v_smfmac_f32_32x32x32_bf16 v[180:195], a[68:71], v[100:107], v18
    v_exp_f32 v111, v111
    v_exp_f32 v112, v112
    v_exp_f32 v113, v113
    v_mfma_f32_32x32x16_bf16 v[60:75], a[0:3], v[40:43], v[60:75]
    v_exp_f32 v114, v114
    v_exp_f32 v115, v115
    v_exp_f32 v116, v116
    v_mfma_f32_32x32x16_bf16 v[76:91], a[0:3], v[44:47], v[76:91]
    v_exp_f32 v117, v117
    v_exp_f32 v118, v118
    v_exp_f32 v119, v119
    v_exp_f32 v120, v120
    v_exp_f32 v121, v121
    v_exp_f32 v122, v122
    v_exp_f32 v123, v123
    v_smfmac_f32_32x32x32_bf16 v[196:211], a[64:67], v[108:115], v18
    v_exp_f32 v60, v60
    v_exp_f32 v61, v61
    v_exp_f32 v62, v62
    v_smfmac_f32_32x32x32_bf16 v[196:211], a[68:71], v[116:123], v18
    s_waitcnt vmcnt(2)
    v_exp_f32 v63, v63
    v_exp_f32 v64, v64
    v_exp_f32 v65, v65
    v_mfma_f32_32x32x4_2b_bf16 v[92:123], a[72:73], v[56:57], 0 cbsz:1 abid:1
    v_exp_f32 v66, v66
    v_exp_f32 v67, v67
    v_exp_f32 v68, v68
    v_exp_f32 v69, v69
    v_exp_f32 v70, v70
    v_exp_f32 v71, v71
    v_exp_f32 v72, v72
    v_exp_f32 v73, v73
    v_exp_f32 v74, v74
    v_exp_f32 v75, v75
    v_smfmac_f32_32x32x32_bf16 v[148:163], a[24:27], v[60:67], v18
    s_waitcnt vmcnt(0)
    ds_read_b64_tr_b16 a[224:225], v4 offset:9216
    ds_read_b64_tr_b16 a[226:227], v4 offset:9344
    ds_read_b64_tr_b16 a[228:229], v4 offset:10240
    ds_read_b64_tr_b16 a[230:231], v4 offset:10368
    ds_read_b64_tr_b16 a[232:233], v4 offset:11264
    ds_read_b64_tr_b16 a[234:235], v4 offset:11392
    v_xor_b32 v34, s10, v34
    v_xor_b32 v35, s10, v35
    v_or_b32 v15, v34, v35
    v_and_b32 v15, 0xffffffe1, v15
    v_cmp_ne_u32 vcc, 0, v15
    s_cbranch_vccnz B_flre_14
B_flok_13:
    v_cmp_ne_u32 vcc, 0, v35
    v_exp_f32 v76, v76
    v_exp_f32 v77, v77
    v_exp_f32 v78, v78
    v_smfmac_f32_32x32x32_bf16 v[148:163], a[28:31], v[68:75], v18
    v_exp_f32 v79, v79
    v_exp_f32 v80, v80
    v_exp_f32 v81, v81
    v_mfma_f32_32x32x16_bf16 v[92:107], a[4:7], v[40:43], v[92:107]
    v_exp_f32 v82, v82
    v_exp_f32 v83, v83
    v_exp_f32 v84, v84
    v_mfma_f32_32x32x16_bf16 v[108:123], a[4:7], v[44:47], v[108:123]
    v_exp_f32 v85, v85
    v_exp_f32 v86, v86
    v_exp_f32 v87, v87
    v_exp_f32 v88, v88
    v_exp_f32 v89, v89
    v_exp_f32 v90, v90
    v_exp_f32 v91, v91
    v_smfmac_f32_32x32x32_bf16 v[164:179], a[24:27], v[76:83], v18
    s_cmp_eq_u64 vcc, 0
    v_exp_f32 v92, v92
    v_exp_f32 v93, v93
    v_exp_f32 v94, v94
    v_smfmac_f32_32x32x32_bf16 v[164:179], a[28:31], v[84:91], v18
    s_cselect_b32 s10, 1, 0
    v_exp_f32 v95, v95
    v_exp_f32 v96, v96
    v_exp_f32 v97, v97
    v_mfma_f32_32x32x4_2b_bf16 v[60:91], a[72:73], v[58:59], 0 cbsz:1 abid:0
    v_exp_f32 v98, v98
    v_exp_f32 v99, v99
    v_exp_f32 v100, v100
    v_exp_f32 v101, v101
    v_exp_f32 v102, v102
    v_exp_f32 v103, v103
    v_exp_f32 v104, v104
    v_exp_f32 v105, v105
    v_exp_f32 v106, v106
    v_exp_f32 v107, v107
    v_smfmac_f32_32x32x32_bf16 v[148:163], a[32:35], v[92:99], v18
    v_exp_f32 v108, v108
    v_exp_f32 v109, v109
    v_exp_f32 v110, v110
    v_smfmac_f32_32x32x32_bf16 v[148:163], a[36:39], v[100:107], v18
    v_exp_f32 v111, v111
    v_exp_f32 v112, v112
    v_exp_f32 v113, v113
    v_mfma_f32_32x32x16_bf16 v[60:75], a[0:3], v[48:51], v[60:75]
    v_exp_f32 v114, v114
    v_exp_f32 v115, v115
    v_exp_f32 v116, v116
    v_mfma_f32_32x32x16_bf16 v[76:91], a[0:3], v[52:55], v[76:91]
    v_exp_f32 v117, v117
    v_exp_f32 v118, v118
    v_exp_f32 v119, v119
    v_exp_f32 v120, v120
    v_exp_f32 v121, v121
    v_exp_f32 v122, v122
    v_exp_f32 v123, v123
    v_smfmac_f32_32x32x32_bf16 v[164:179], a[32:35], v[108:115], v18
    v_exp_f32 v60, v60
    v_exp_f32 v61, v61
    v_exp_f32 v62, v62
    v_smfmac_f32_32x32x32_bf16 v[164:179], a[36:39], v[116:123], v18
    ds_write_b128 v30, v[148:151] offset:9216
    ds_write_b128 v30, v[152:155] offset:10240
    ds_write_b128 v30, v[156:159] offset:11264
    v_exp_f32 v63, v63
    v_exp_f32 v64, v64
    v_exp_f32 v65, v65
    v_mfma_f32_32x32x4_2b_bf16 v[92:123], a[72:73], v[58:59], 0 cbsz:1 abid:1
    v_exp_f32 v66, v66
    v_exp_f32 v67, v67
    v_exp_f32 v68, v68
    v_exp_f32 v69, v69
    v_exp_f32 v70, v70
    v_exp_f32 v71, v71
    v_exp_f32 v72, v72
    v_exp_f32 v73, v73
    v_exp_f32 v74, v74
    v_exp_f32 v75, v75
    v_smfmac_f32_32x32x32_bf16 v[180:195], a[24:27], v[60:67], v18
    v_exp_f32 v76, v76
    v_exp_f32 v77, v77
    v_exp_f32 v78, v78
    v_smfmac_f32_32x32x32_bf16 v[180:195], a[28:31], v[68:75], v18
    ds_write_b128 v30, v[164:167] offset:12288
    ds_write_b128 v30, v[168:171] offset:13312
    ds_write_b128 v30, v[172:175] offset:14336
    v_exp_f32 v79, v79
    v_exp_f32 v80, v80
    v_exp_f32 v81, v81
    v_mfma_f32_32x32x16_bf16 v[92:107], a[4:7], v[48:51], v[92:107]
    v_exp_f32 v82, v82
    v_exp_f32 v83, v83
    v_exp_f32 v84, v84
    v_mfma_f32_32x32x16_bf16 v[108:123], a[4:7], v[52:55], v[108:123]
    v_exp_f32 v85, v85
    v_exp_f32 v86, v86
    v_exp_f32 v87, v87
    v_exp_f32 v88, v88
    v_exp_f32 v89, v89
    v_exp_f32 v90, v90
    v_exp_f32 v91, v91
    v_smfmac_f32_32x32x32_bf16 v[196:211], a[24:27], v[76:83], v18
    s_waitcnt lgkmcnt(0)
    v_exp_f32 v92, v92
    v_exp_f32 v93, v93
    v_exp_f32 v94, v94
    v_smfmac_f32_32x32x32_bf16 v[196:211], a[28:31], v[84:91], v18
    s_barrier
    ds_read_b128 v[124:127], v31 offset:9216
    ds_read_b128 v[128:131], v31 offset:10240
    ds_read_b128 v[132:135], v31 offset:11264
    ds_read_b128 v[136:139], v31 offset:12288
    ds_read_b128 v[140:143], v31 offset:13312
    ds_read_b128 v[144:147], v31 offset:14336
    v_exp_f32 v95, v95
    v_exp_f32 v96, v96
    v_exp_f32 v97, v97
    v_exp_f32 v98, v98
    v_exp_f32 v99, v99
    v_exp_f32 v100, v100
    v_exp_f32 v101, v101
    v_exp_f32 v102, v102
    v_exp_f32 v103, v103
    v_exp_f32 v104, v104
    v_exp_f32 v105, v105
    v_exp_f32 v106, v106
    v_exp_f32 v107, v107
    v_smfmac_f32_32x32x32_bf16 v[180:195], a[32:35], v[92:99], v18
    s_mov_b32 s44, 40960
    v_exp_f32 v108, v108
    v_exp_f32 v109, v109
    v_exp_f32 v110, v110
    v_smfmac_f32_32x32x32_bf16 v[180:195], a[36:39], v[100:107], v18
PAD_4:
    s_cbranch_execz RET_E
    s_waitcnt lgkmcnt(0)
    v_exp_f32 v111, v111
    v_exp_f32 v112, v112
    v_exp_f32 v113, v113
    v_exp_f32 v114, v114
    v_exp_f32 v115, v115
    v_exp_f32 v116, v116
    v_exp_f32 v117, v117
    v_exp_f32 v118, v118
    v_exp_f32 v119, v119
    v_exp_f32 v120, v120
    v_exp_f32 v121, v121
    v_exp_f32 v122, v122
    v_exp_f32 v123, v123
    v_smfmac_f32_32x32x32_bf16 v[196:211], a[32:35], v[108:115], v18
    v_add_f32 v180, v180, v124
    v_add_f32 v181, v181, v125
    v_add_f32 v182, v182, v126
    v_add_f32 v183, v183, v127
    v_add_f32 v184, v184, v128
    v_smfmac_f32_32x32x32_bf16 v[196:211], a[36:39], v[116:123], v18
    v_add_f32 v185, v185, v129
    v_add_f32 v186, v186, v130
    v_add_f32 v187, v187, v131
    v_add_f32 v188, v188, v132
    v_add_f32 v189, v189, v133
    v_add_f32 v190, v190, v134
    v_add_f32 v191, v191, v135
    v_mov_b32 v60, v188
    v_mov_b32 v61, v188
    s_nop 1
    v_permlane32_swap_b32 v61, v60
    v_rcp_f32 v61, v60
    v_subrev_u32 v15, 0x1f800000, v60
    v_cmp_lt_u32 vcc, 0x40000000, v15
    s_cbranch_vccnz sequential_preLN__mha_block__moe_arch_mod__prompt_kernel_slow
    v_pk_mul_f32 v[180:181], v[180:181], v[60:61] op_sel:[0,1] op_sel_hi:[1,1]
    v_pk_mul_f32 v[182:183], v[182:183], v[60:61] op_sel:[0,1] op_sel_hi:[1,1]
    v_pk_mul_f32 v[184:185], v[184:185], v[60:61] op_sel:[0,1] op_sel_hi:[1,1]
    v_pk_mul_f32 v[186:187], v[186:187], v[60:61] op_sel:[0,1] op_sel_hi:[1,1]
    v_pk_mul_f32 v[188:189], v[188:189], v[60:61] op_sel:[0,1] op_sel_hi:[1,1]
    v_pk_mul_f32 v[190:191], v[190:191], v[60:61] op_sel:[0,1] op_sel_hi:[1,1]
    v_cvt_pk_bf16_f32 v180, v180, v181
    v_cvt_pk_bf16_f32 v181, v182, v183
    v_cvt_pk_bf16_f32 v182, v184, v185
    v_cvt_pk_bf16_f32 v183, v186, v187
    v_cvt_pk_bf16_f32 v184, v188, v189
    v_cvt_pk_bf16_f32 v185, v190, v191
    buffer_store_dwordx4 v[180:183], v32, s[12:15], 0 offen sc1
    v_pk_add_f32 v[196:197], v[196:197], v[136:137]
    v_pk_add_f32 v[198:199], v[198:199], v[138:139]
    v_pk_add_f32 v[200:201], v[200:201], v[140:141]
    v_pk_add_f32 v[202:203], v[202:203], v[142:143]
    v_pk_add_f32 v[204:205], v[204:205], v[144:145]
    v_pk_add_f32 v[206:207], v[206:207], v[146:147]
    v_mov_b32 v62, v204
    v_mov_b32 v63, v204
    s_nop 1
    v_permlane32_swap_b32 v63, v62
    v_rcp_f32 v63, v62
    v_subrev_u32 v15, 0x1f800000, v62
    v_cmp_lt_u32 vcc, 0x40000000, v15
    s_cbranch_vccnz sequential_preLN__mha_block__moe_arch_mod__prompt_kernel_slow
    v_pk_mul_f32 v[196:197], v[196:197], v[62:63] op_sel:[0,1] op_sel_hi:[1,1]
    v_pk_mul_f32 v[198:199], v[198:199], v[62:63] op_sel:[0,1] op_sel_hi:[1,1]
    v_pk_mul_f32 v[200:201], v[200:201], v[62:63] op_sel:[0,1] op_sel_hi:[1,1]
    v_pk_mul_f32 v[202:203], v[202:203], v[62:63] op_sel:[0,1] op_sel_hi:[1,1]
    v_pk_mul_f32 v[204:205], v[204:205], v[62:63] op_sel:[0,1] op_sel_hi:[1,1]
    v_pk_mul_f32 v[206:207], v[206:207], v[62:63] op_sel:[0,1] op_sel_hi:[1,1]
    v_cvt_pk_bf16_f32 v196, v196, v197
    v_cvt_pk_bf16_f32 v197, v198, v199
    v_cvt_pk_bf16_f32 v198, v200, v201
    v_cvt_pk_bf16_f32 v199, v202, v203
    v_cvt_pk_bf16_f32 v200, v204, v205
    v_cvt_pk_bf16_f32 v201, v206, v207
    buffer_store_dwordx4 v[196:199], v32, s[12:15], s44 offen sc1
sequential_preLN__mha_block__moe_arch_mod__prompt_kernel_norm:
    s_nop 0
    v_permlane32_swap_b32 v184, v200
    v_permlane32_swap_b32 v185, v201
    buffer_store_dwordx2 v[184:185], v33, s[12:15], 0 offen sc1
    s_movk_i32 s51, 4096
    s_movk_i32 s16, 4096
    s_movk_i32 s17, 8192
    s_movk_i32 s18, 12288
C_again_16:
    ds_read_b64_tr_b16 a[0:1], v8 offset:0
    ds_read_b64_tr_b16 a[2:3], v9 offset:0
    ds_read_b64_tr_b16 a[4:5], v8 offset:8
    ds_read_b64_tr_b16 a[6:7], v9 offset:8
    ds_read_b64_tr_b16 a[8:9], v8 offset:16
    ds_read_b64_tr_b16 a[10:11], v9 offset:16
    ds_read_b64_tr_b16 a[12:13], v8 offset:24
    ds_read_b64_tr_b16 a[14:15], v9 offset:24
    ds_read_b64_tr_b16 a[16:17], v8 offset:32
    ds_read_b64_tr_b16 a[18:19], v9 offset:32
    ds_read_b64_tr_b16 a[20:21], v8 offset:6400
    ds_read_b64_tr_b16 a[22:23], v9 offset:6400
    ds_read_b64_tr_b16 a[24:25], v8 offset:6408
    ds_read_b64_tr_b16 a[26:27], v9 offset:6408
    v_accvgpr_read_b32 v15, a236
    v_lshlrev_b32 v56, 16, v15
    v_and_b32 v57, 0xffff0000, v15
    v_accvgpr_read_b32 v15, a237
    v_lshlrev_b32 v58, 16, v15
    v_and_b32 v59, 0xffff0000, v15
    v_accvgpr_read_b32 v15, a238
    v_lshlrev_b32 v60, 16, v15
    v_and_b32 v61, 0xffff0000, v15
    v_accvgpr_read_b32 v15, a239
    v_lshlrev_b32 v62, 16, v15
    v_and_b32 v63, 0xffff0000, v15
    v_accvgpr_read_b32 v15, a240
    v_lshlrev_b32 v64, 16, v15
    ds_read_b64_tr_b16 a[28:29], v8 offset:6416
    ds_read_b64_tr_b16 a[30:31], v9 offset:6416
    ds_read_b64_tr_b16 a[32:33], v8 offset:6424
    ds_read_b64_tr_b16 a[34:35], v9 offset:6424
    ds_read_b64_tr_b16 a[36:37], v8 offset:6432
    ds_read_b64_tr_b16 a[38:39], v9 offset:6432
    ds_read_b64_tr_b16 a[40:41], v8 offset:12800
    ds_read_b64_tr_b16 a[42:43], v9 offset:12800
    ds_read_b64_tr_b16 a[44:45], v8 offset:12808
    ds_read_b64_tr_b16 a[46:47], v9 offset:12808
    ds_read_b64_tr_b16 a[48:49], v8 offset:12816
    ds_read_b64_tr_b16 a[50:51], v9 offset:12816
    ds_read_b64_tr_b16 a[52:53], v8 offset:12824
    ds_read_b64_tr_b16 a[54:55], v9 offset:12824
    v_and_b32 v65, 0xffff0000, v15
    v_accvgpr_read_b32 v15, a241
    v_lshlrev_b32 v66, 16, v15
    v_and_b32 v67, 0xffff0000, v15
    v_accvgpr_read_b32 v15, a242
    v_lshlrev_b32 v68, 16, v15
    v_and_b32 v69, 0xffff0000, v15
    v_accvgpr_read_b32 v15, a243
    v_lshlrev_b32 v70, 16, v15
    v_and_b32 v71, 0xffff0000, v15
    v_accvgpr_read_b32 v15, a244
    v_lshlrev_b32 v72, 16, v15
    v_and_b32 v73, 0xffff0000, v15
    v_accvgpr_read_b32 v15, a245
    ds_read_b64_tr_b16 a[56:57], v8 offset:12832
    ds_read_b64_tr_b16 a[58:59], v9 offset:12832
    ds_read_b64_tr_b16 a[60:61], v8 offset:19200
    ds_read_b64_tr_b16 a[62:63], v9 offset:19200
    ds_read_b64_tr_b16 a[64:65], v8 offset:19208
    ds_read_b64_tr_b16 a[66:67], v9 offset:19208
    ds_read_b64_tr_b16 a[68:69], v8 offset:19216
    ds_read_b64_tr_b16 a[70:71], v9 offset:19216
    ds_read_b64_tr_b16 a[72:73], v8 offset:19224
    ds_read_b64_tr_b16 a[74:75], v9 offset:19224
    ds_read_b64_tr_b16 a[76:77], v8 offset:19232
    ds_read_b64_tr_b16 a[78:79], v9 offset:19232
    ds_read_b64_tr_b16 a[80:81], v8 offset:25600
    ds_read_b64_tr_b16 a[82:83], v9 offset:25600
    v_lshlrev_b32 v74, 16, v15
    v_and_b32 v75, 0xffff0000, v15
    v_accvgpr_read_b32 v15, a246
    v_lshlrev_b32 v34, 16, v15
    v_and_b32 v35, 0xffff0000, v15
    v_accvgpr_read_b32 v15, a247
    v_lshlrev_b32 v36, 16, v15
    v_and_b32 v37, 0xffff0000, v15
    v_accvgpr_read_b32 v15, a248
    v_lshlrev_b32 v38, 16, v15
    v_and_b32 v39, 0xffff0000, v15
    v_accvgpr_read_b32 v15, a249
    v_lshlrev_b32 v40, 16, v15
    v_and_b32 v41, 0xffff0000, v15
    ds_read_b64_tr_b16 a[84:85], v8 offset:25608
    ds_read_b64_tr_b16 a[86:87], v9 offset:25608
    ds_read_b64_tr_b16 a[88:89], v8 offset:25616
    ds_read_b64_tr_b16 a[90:91], v9 offset:25616
    ds_read_b64_tr_b16 a[92:93], v8 offset:25624
    ds_read_b64_tr_b16 a[94:95], v9 offset:25624
    ds_read_b64_tr_b16 a[96:97], v8 offset:25632
    ds_read_b64_tr_b16 a[98:99], v9 offset:25632
    ds_read_b64_tr_b16 a[100:101], v8 offset:32000
    ds_read_b64_tr_b16 a[102:103], v9 offset:32000
    ds_read_b64_tr_b16 a[104:105], v8 offset:32008
    ds_read_b64_tr_b16 a[106:107], v9 offset:32008
    ds_read_b64_tr_b16 a[108:109], v8 offset:32016
    ds_read_b64_tr_b16 a[110:111], v9 offset:32016
    v_accvgpr_read_b32 v15, a250
    v_lshlrev_b32 v42, 16, v15
    v_and_b32 v43, 0xffff0000, v15
    v_accvgpr_read_b32 v15, a251
    v_lshlrev_b32 v44, 16, v15
    v_and_b32 v45, 0xffff0000, v15
    v_accvgpr_read_b32 v15, a252
    v_lshlrev_b32 v46, 16, v15
    v_and_b32 v47, 0xffff0000, v15
    v_accvgpr_read_b32 v15, a253
    v_lshlrev_b32 v48, 16, v15
    v_and_b32 v49, 0xffff0000, v15
    v_accvgpr_read_b32 v15, a254
    v_lshlrev_b32 v50, 16, v15
    ds_read_b64_tr_b16 a[112:113], v8 offset:32024
    ds_read_b64_tr_b16 a[114:115], v9 offset:32024
    ds_read_b64_tr_b16 a[116:117], v8 offset:32032
    ds_read_b64_tr_b16 a[118:119], v9 offset:32032
    buffer_load_dword v19, v5, s[12:15], 0 offen sc1
    ds_read_b64_tr_b16 a[120:121], v8 offset:38400
    ds_read_b64_tr_b16 a[122:123], v9 offset:38400
    ds_read_b64_tr_b16 a[124:125], v8 offset:38408
    ds_read_b64_tr_b16 a[126:127], v9 offset:38408
    ds_read_b64_tr_b16 a[128:129], v8 offset:38416
    ds_read_b64_tr_b16 a[130:131], v9 offset:38416
    ds_read_b64_tr_b16 a[132:133], v8 offset:38424
    ds_read_b64_tr_b16 a[134:135], v9 offset:38424
    ds_read_b64_tr_b16 a[136:137], v8 offset:38432
    ds_read_b64_tr_b16 a[138:139], v9 offset:38432
    v_and_b32 v51, 0xffff0000, v15
    v_accvgpr_read_b32 v15, a255
    v_lshlrev_b32 v52, 16, v15
    v_and_b32 v53, 0xffff0000, v15
    v_add_f32 v79, v34, v35
    v_add_f32 v79, v79, v36
    v_add_f32 v79, v79, v37
    v_add_f32 v79, v79, v38
    v_add_f32 v79, v79, v39
    v_add_f32 v79, v79, v40
    v_add_f32 v79, v79, v41
    v_add_f32 v79, v79, v42
    v_add_f32 v79, v79, v43
    v_add_f32 v79, v79, v44
    ds_read_b64_tr_b16 a[140:141], v8 offset:44800
    ds_read_b64_tr_b16 a[142:143], v9 offset:44800
    ds_read_b64_tr_b16 a[144:145], v8 offset:44808
    ds_read_b64_tr_b16 a[146:147], v9 offset:44808
    ds_read_b64_tr_b16 a[148:149], v8 offset:44816
    ds_read_b64_tr_b16 a[150:151], v9 offset:44816
    ds_read_b64_tr_b16 a[152:153], v8 offset:44824
    ds_read_b64_tr_b16 a[154:155], v9 offset:44824
    ds_read_b64_tr_b16 a[156:157], v8 offset:44832
    ds_read_b64_tr_b16 a[158:159], v9 offset:44832
    v_add_u32 v8, 51200, v8
    v_add_u32 v9, 51200, v9
    ds_read_b64_tr_b16 a[160:161], v8 offset:0
    ds_read_b64_tr_b16 a[162:163], v9 offset:0
    ds_read_b64_tr_b16 a[164:165], v8 offset:8
    ds_read_b64_tr_b16 a[166:167], v9 offset:8
    v_add_f32 v79, v79, v45
    v_add_f32 v79, v79, v46
    v_add_f32 v79, v79, v47
    v_add_f32 v79, v79, v48
    v_add_f32 v79, v79, v49
    v_add_f32 v79, v79, v50
    v_add_f32 v79, v79, v51
    v_add_f32 v79, v79, v52
    v_add_f32 v79, v79, v53
    v_and_b32 v13, 15, v1
    v_lshrrev_b32 v14, 4, v1
    s_lshl_b32 s44, s48, 13
    s_lshl_b32 s45, s40, 8
    s_add_u32 s44, s44, s45
    ds_read_b64_tr_b16 a[168:169], v8 offset:16
    ds_read_b64_tr_b16 a[170:171], v9 offset:16
    ds_read_b64_tr_b16 a[172:173], v8 offset:24
    ds_read_b64_tr_b16 a[174:175], v9 offset:24
    ds_read_b64_tr_b16 a[176:177], v8 offset:32
    ds_read_b64_tr_b16 a[178:179], v9 offset:32
    ds_read_b64_tr_b16 a[180:181], v8 offset:6400
    ds_read_b64_tr_b16 a[182:183], v9 offset:6400
    ds_read_b64_tr_b16 a[184:185], v8 offset:6408
    ds_read_b64_tr_b16 a[186:187], v9 offset:6408
    ds_read_b64_tr_b16 a[188:189], v8 offset:6416
    ds_read_b64_tr_b16 a[190:191], v9 offset:6416
    ds_read_b64_tr_b16 a[192:193], v8 offset:6424
    ds_read_b64_tr_b16 a[194:195], v9 offset:6424
    s_add_u32 s44, s44, 11534336
    s_lshl_b32 s45, s49, 10
    s_add_u32 s45, s45, s44
    v_lshlrev_b32 v15, 4, v13
    v_lshl_add_u32 v16, v14, 10, v15
    v_add_u32 v17, 4096, v16
    v_lshl_add_u32 v15, v14, 24, v15
    v_mov_b32 v18, 0
    ds_read_b64_tr_b16 a[196:197], v8 offset:6432
    ds_read_b64_tr_b16 a[198:199], v9 offset:6432
    ds_read_b64_tr_b16 a[200:201], v8 offset:12800
    ds_read_b64_tr_b16 a[202:203], v9 offset:12800
    ds_read_b64_tr_b16 a[204:205], v8 offset:12808
    ds_read_b64_tr_b16 a[206:207], v9 offset:12808
    ds_read_b64_tr_b16 a[208:209], v8 offset:12816
    ds_read_b64_tr_b16 a[210:211], v9 offset:12816
    ds_read_b64_tr_b16 a[212:213], v8 offset:12824
    ds_read_b64_tr_b16 a[214:215], v9 offset:12824
    ds_read_b64_tr_b16 a[216:217], v8 offset:12832
    ds_read_b64_tr_b16 a[218:219], v9 offset:12832
    s_mov_b32 s47, 65536
    s_branch C_pr_ck_19
C_pr_18:
    buffer_load_dword v19, v5, s[12:15], 0 offen sc1
C_pr_ck_19:
    s_sub_u32 s47, s47, 1
    s_waitcnt vmcnt(0)
    s_cbranch_scc1 C_pr_ok_20
    v_cmp_eq_u32 vcc, -1, v19
    s_cbranch_vccnz C_pr_18
C_pr_ok_20:
    buffer_load_dwordx4 v[108:111], v6, s[12:15], 0 offen offset:0 sc1
    buffer_load_dwordx4 v[112:115], v6, s[12:15], 0 offen offset:1024 sc1
    buffer_load_dwordx4 v[116:119], v6, s[12:15], 0 offen offset:2048 sc1
    buffer_load_dwordx4 v[120:123], v6, s[12:15], 0 offen offset:3072 sc1
    buffer_load_dwordx4 v[124:127], v6, s[12:15], s16 offen offset:0 sc1
    buffer_load_dwordx4 v[128:131], v6, s[12:15], s16 offen offset:1024 sc1
    ds_read_b64_tr_b16 a[220:221], v8 offset:19200
    ds_read_b64_tr_b16 a[222:223], v9 offset:19200
    s_waitcnt vmcnt(5) lgkmcnt(0)
    v_mfma_f32_16x16x32_bf16 v[56:59], a[0:3], v[108:111], v[56:59]
    buffer_load_dwordx4 v[132:135], v6, s[12:15], s16 offen offset:2048 sc1
    v_max3_u32 v18, v18, v108, v109
    v_mfma_f32_16x16x32_bf16 v[60:63], a[4:7], v[108:111], v[60:63]
    ds_read_b64_tr_b16 a[0:1], v8 offset:19208
    ds_read_b64_tr_b16 a[2:3], v9 offset:19208
    v_mfma_f32_16x16x32_bf16 v[64:67], a[8:11], v[108:111], v[64:67]
    ds_read_b64_tr_b16 a[4:5], v8 offset:19216
    ds_read_b64_tr_b16 a[6:7], v9 offset:19216
    v_mfma_f32_16x16x32_bf16 v[68:71], a[12:15], v[108:111], v[68:71]
    ds_read_b64_tr_b16 a[8:9], v8 offset:19224
    ds_read_b64_tr_b16 a[10:11], v9 offset:19224
    v_mfma_f32_16x16x32_bf16 v[72:75], a[16:19], v[108:111], v[72:75]
    v_max3_u32 v18, v18, v110, v111
    s_waitcnt vmcnt(5)
    v_mfma_f32_16x16x32_bf16 v[56:59], a[20:23], v[112:115], v[56:59]
    buffer_load_dwordx4 v[136:139], v6, s[12:15], s16 offen offset:3072 sc1
    v_max3_u32 v18, v18, v112, v113
    v_mfma_f32_16x16x32_bf16 v[60:63], a[24:27], v[112:115], v[60:63]
    ds_read_b64_tr_b16 a[12:13], v8 offset:19232
    ds_read_b64_tr_b16 a[14:15], v9 offset:19232
    v_mfma_f32_16x16x32_bf16 v[64:67], a[28:31], v[112:115], v[64:67]
    ds_read_b64_tr_b16 a[16:17], v8 offset:25600
    ds_read_b64_tr_b16 a[18:19], v9 offset:25600
    v_mfma_f32_16x16x32_bf16 v[68:71], a[32:35], v[112:115], v[68:71]
    ds_read_b64_tr_b16 a[20:21], v8 offset:25608
    ds_read_b64_tr_b16 a[22:23], v9 offset:25608
    v_mfma_f32_16x16x32_bf16 v[72:75], a[36:39], v[112:115], v[72:75]
    v_max3_u32 v18, v18, v114, v115
    s_waitcnt vmcnt(5)
    v_mfma_f32_16x16x32_bf16 v[56:59], a[40:43], v[116:119], v[56:59]
    buffer_load_dwordx4 v[140:143], v6, s[12:15], s17 offen offset:0 sc1
    v_max3_u32 v18, v18, v116, v117
    v_mfma_f32_16x16x32_bf16 v[60:63], a[44:47], v[116:119], v[60:63]
    ds_read_b64_tr_b16 a[24:25], v8 offset:25616
    ds_read_b64_tr_b16 a[26:27], v9 offset:25616
    v_mfma_f32_16x16x32_bf16 v[64:67], a[48:51], v[116:119], v[64:67]
    ds_read_b64_tr_b16 a[28:29], v8 offset:25624
    ds_read_b64_tr_b16 a[30:31], v9 offset:25624
    v_mfma_f32_16x16x32_bf16 v[68:71], a[52:55], v[116:119], v[68:71]
    ds_read_b64_tr_b16 a[32:33], v8 offset:25632
    ds_read_b64_tr_b16 a[34:35], v9 offset:25632
    v_mfma_f32_16x16x32_bf16 v[72:75], a[56:59], v[116:119], v[72:75]
    v_max3_u32 v18, v18, v118, v119
    s_waitcnt vmcnt(5)
    v_mfma_f32_16x16x32_bf16 v[56:59], a[60:63], v[120:123], v[56:59]
    buffer_load_dwordx4 v[144:147], v6, s[12:15], s17 offen offset:1024 sc1
    v_max3_u32 v18, v18, v120, v121
    v_mfma_f32_16x16x32_bf16 v[60:63], a[64:67], v[120:123], v[60:63]
    ds_read_b64_tr_b16 a[36:37], v8 offset:32000
    ds_read_b64_tr_b16 a[38:39], v9 offset:32000
    v_mfma_f32_16x16x32_bf16 v[64:67], a[68:71], v[120:123], v[64:67]
    ds_read_b64_tr_b16 a[40:41], v8 offset:32008
    ds_read_b64_tr_b16 a[42:43], v9 offset:32008
    v_mfma_f32_16x16x32_bf16 v[68:71], a[72:75], v[120:123], v[68:71]
    ds_read_b64_tr_b16 a[44:45], v8 offset:32016
    ds_read_b64_tr_b16 a[46:47], v9 offset:32016
    v_mfma_f32_16x16x32_bf16 v[72:75], a[76:79], v[120:123], v[72:75]
    v_max3_u32 v18, v18, v122, v123
    s_waitcnt vmcnt(5)
    v_mfma_f32_16x16x32_bf16 v[56:59], a[80:83], v[124:127], v[56:59]
    buffer_load_dwordx4 v[148:151], v6, s[12:15], s17 offen offset:2048 sc1
    v_max3_u32 v18, v18, v124, v125
    v_mfma_f32_16x16x32_bf16 v[60:63], a[84:87], v[124:127], v[60:63]
    ds_read_b64_tr_b16 a[48:49], v8 offset:32024
    ds_read_b64_tr_b16 a[50:51], v9 offset:32024
    v_mfma_f32_16x16x32_bf16 v[64:67], a[88:91], v[124:127], v[64:67]
    ds_read_b64_tr_b16 a[52:53], v8 offset:32032
    ds_read_b64_tr_b16 a[54:55], v9 offset:32032
    v_mfma_f32_16x16x32_bf16 v[68:71], a[92:95], v[124:127], v[68:71]
    ds_read_b64_tr_b16 a[56:57], v8 offset:38400
    ds_read_b64_tr_b16 a[58:59], v9 offset:38400
    v_mfma_f32_16x16x32_bf16 v[72:75], a[96:99], v[124:127], v[72:75]
    v_max3_u32 v18, v18, v126, v127
    s_waitcnt vmcnt(5)
    v_mfma_f32_16x16x32_bf16 v[56:59], a[100:103], v[128:131], v[56:59]
    buffer_load_dwordx4 v[152:155], v6, s[12:15], s17 offen offset:3072 sc1
    v_max3_u32 v18, v18, v128, v129
    v_mfma_f32_16x16x32_bf16 v[60:63], a[104:107], v[128:131], v[60:63]
    ds_read_b64_tr_b16 a[60:61], v8 offset:38408
    ds_read_b64_tr_b16 a[62:63], v9 offset:38408
    v_mfma_f32_16x16x32_bf16 v[64:67], a[108:111], v[128:131], v[64:67]
    ds_read_b64_tr_b16 a[64:65], v8 offset:38416
    ds_read_b64_tr_b16 a[66:67], v9 offset:38416
    v_mfma_f32_16x16x32_bf16 v[68:71], a[112:115], v[128:131], v[68:71]
    ds_read_b64_tr_b16 a[68:69], v8 offset:38424
    ds_read_b64_tr_b16 a[70:71], v9 offset:38424
    v_mfma_f32_16x16x32_bf16 v[72:75], a[116:119], v[128:131], v[72:75]
    v_max3_u32 v18, v18, v130, v131
    s_waitcnt vmcnt(5)
    v_mfma_f32_16x16x32_bf16 v[56:59], a[120:123], v[132:135], v[56:59]
    buffer_load_dwordx4 v[156:159], v6, s[12:15], s18 offen offset:0 sc1
    v_max3_u32 v18, v18, v132, v133
    v_mfma_f32_16x16x32_bf16 v[60:63], a[124:127], v[132:135], v[60:63]
    ds_read_b64_tr_b16 a[72:73], v8 offset:38432
    ds_read_b64_tr_b16 a[74:75], v9 offset:38432
    v_mfma_f32_16x16x32_bf16 v[64:67], a[128:131], v[132:135], v[64:67]
    ds_read_b64_tr_b16 a[76:77], v8 offset:44800
    ds_read_b64_tr_b16 a[78:79], v9 offset:44800
    v_mfma_f32_16x16x32_bf16 v[68:71], a[132:135], v[132:135], v[68:71]
    ds_read_b64_tr_b16 a[80:81], v8 offset:44808
    ds_read_b64_tr_b16 a[82:83], v9 offset:44808
    v_mfma_f32_16x16x32_bf16 v[72:75], a[136:139], v[132:135], v[72:75]
    v_max3_u32 v18, v18, v134, v135
    s_waitcnt vmcnt(5)
    v_mfma_f32_16x16x32_bf16 v[56:59], a[140:143], v[136:139], v[56:59]
    buffer_load_dwordx4 v[160:163], v6, s[12:15], s18 offen offset:1024 sc1
    v_max3_u32 v18, v18, v136, v137
    v_mfma_f32_16x16x32_bf16 v[60:63], a[144:147], v[136:139], v[60:63]
    ds_read_b64_tr_b16 a[84:85], v8 offset:44816
    ds_read_b64_tr_b16 a[86:87], v9 offset:44816
    v_mfma_f32_16x16x32_bf16 v[64:67], a[148:151], v[136:139], v[64:67]
    ds_read_b64_tr_b16 a[88:89], v8 offset:44824
    ds_read_b64_tr_b16 a[90:91], v9 offset:44824
    v_mfma_f32_16x16x32_bf16 v[68:71], a[152:155], v[136:139], v[68:71]
    ds_read_b64_tr_b16 a[92:93], v8 offset:44832
    ds_read_b64_tr_b16 a[94:95], v9 offset:44832
    v_mfma_f32_16x16x32_bf16 v[72:75], a[156:159], v[136:139], v[72:75]
    v_max3_u32 v18, v18, v138, v139
    s_waitcnt vmcnt(5)
    v_mfma_f32_16x16x32_bf16 v[56:59], a[160:163], v[140:143], v[56:59]
    buffer_load_dwordx4 v[164:167], v6, s[12:15], s18 offen offset:2048 sc1
    v_max3_u32 v18, v18, v140, v141
    v_mfma_f32_16x16x32_bf16 v[60:63], a[164:167], v[140:143], v[60:63]
    ds_read_b64_tr_b16 a[96:97], v10 offset:0
    ds_read_b64_tr_b16 a[98:99], v10 offset:6400
    v_mfma_f32_16x16x32_bf16 v[64:67], a[168:171], v[140:143], v[64:67]
    ds_read_b64_tr_b16 a[100:101], v10 offset:8
    ds_read_b64_tr_b16 a[102:103], v10 offset:6408
    v_mfma_f32_16x16x32_bf16 v[68:71], a[172:175], v[140:143], v[68:71]
    ds_read_b64_tr_b16 a[104:105], v10 offset:16
    ds_read_b64_tr_b16 a[106:107], v10 offset:6416
    v_mfma_f32_16x16x32_bf16 v[72:75], a[176:179], v[140:143], v[72:75]
    v_max3_u32 v18, v18, v142, v143
    s_waitcnt vmcnt(5)
    v_mfma_f32_16x16x32_bf16 v[56:59], a[180:183], v[144:147], v[56:59]
    buffer_load_dwordx4 v[168:171], v6, s[12:15], s18 offen offset:3072 sc1
    v_max3_u32 v18, v18, v144, v145
    v_mfma_f32_16x16x32_bf16 v[60:63], a[184:187], v[144:147], v[60:63]
    ds_read_b64_tr_b16 a[108:109], v10 offset:24
    ds_read_b64_tr_b16 a[110:111], v10 offset:6424
    v_mfma_f32_16x16x32_bf16 v[64:67], a[188:191], v[144:147], v[64:67]
    ds_read_b64_tr_b16 a[112:113], v10 offset:32
    ds_read_b64_tr_b16 a[114:115], v10 offset:6432
    v_mfma_f32_16x16x32_bf16 v[68:71], a[192:195], v[144:147], v[68:71]
    ds_read_b64_tr_b16 a[116:117], v10 offset:25600
    ds_read_b64_tr_b16 a[118:119], v10 offset:32000
    v_mfma_f32_16x16x32_bf16 v[72:75], a[196:199], v[144:147], v[72:75]
    v_max3_u32 v18, v18, v146, v147
    s_waitcnt vmcnt(5)
    v_mfma_f32_16x16x32_bf16 v[56:59], a[200:203], v[148:151], v[56:59]
    buffer_load_dwordx2 v[172:173], v7, s[12:15], 0 offen offset:0 sc1
    buffer_load_dwordx2 v[174:175], v7, s[12:15], 0 offen offset:256 sc1
    v_max3_u32 v18, v18, v148, v149
    v_mfma_f32_16x16x32_bf16 v[60:63], a[204:207], v[148:151], v[60:63]
    ds_read_b64_tr_b16 a[120:121], v10 offset:25608
    ds_read_b64_tr_b16 a[122:123], v10 offset:32008
    v_mfma_f32_16x16x32_bf16 v[64:67], a[208:211], v[148:151], v[64:67]
    ds_read_b64_tr_b16 a[124:125], v10 offset:25616
    ds_read_b64_tr_b16 a[126:127], v10 offset:32016
    v_mfma_f32_16x16x32_bf16 v[68:71], a[212:215], v[148:151], v[68:71]
    ds_read_b64_tr_b16 a[128:129], v10 offset:25624
    ds_read_b64_tr_b16 a[130:131], v10 offset:32024
    v_mfma_f32_16x16x32_bf16 v[72:75], a[216:219], v[148:151], v[72:75]
    v_max3_u32 v18, v18, v150, v151
    s_waitcnt vmcnt(6) lgkmcnt(12)
    v_mfma_f32_16x16x32_bf16 v[56:59], a[220:223], v[152:155], v[56:59]
    buffer_load_dwordx2 v[176:177], v7, s[12:15], 0 offen offset:1024 sc1
    buffer_load_dwordx2 v[178:179], v7, s[12:15], 0 offen offset:1280 sc1
    v_max3_u32 v18, v18, v152, v153
    v_mfma_f32_16x16x32_bf16 v[60:63], a[0:3], v[152:155], v[60:63]
    ds_read_b64_tr_b16 a[132:133], v10 offset:25632
    ds_read_b64_tr_b16 a[134:135], v10 offset:32032
    v_mfma_f32_16x16x32_bf16 v[64:67], a[4:7], v[152:155], v[64:67]
    ds_read_b64_tr_b16 a[136:137], v11 offset:0
    ds_read_b64_tr_b16 a[138:139], v11 offset:6400
    v_mfma_f32_16x16x32_bf16 v[68:71], a[8:11], v[152:155], v[68:71]
    ds_read_b64_tr_b16 a[140:141], v11 offset:8
    ds_read_b64_tr_b16 a[142:143], v11 offset:6408
    v_mfma_f32_16x16x32_bf16 v[72:75], a[12:15], v[152:155], v[72:75]
    v_max3_u32 v18, v18, v154, v155
    s_waitcnt vmcnt(7) lgkmcnt(12)
    v_mfma_f32_16x16x32_bf16 v[56:59], a[16:19], v[156:159], v[56:59]
    buffer_load_dwordx2 v[180:181], v7, s[12:15], 0 offen offset:2048 sc1
    buffer_load_dwordx2 v[182:183], v7, s[12:15], 0 offen offset:2304 sc1
    v_max3_u32 v18, v18, v156, v157
    v_mfma_f32_16x16x32_bf16 v[60:63], a[20:23], v[156:159], v[60:63]
    ds_read_b64_tr_b16 a[144:145], v11 offset:16
    ds_read_b64_tr_b16 a[146:147], v11 offset:6416
    v_mfma_f32_16x16x32_bf16 v[64:67], a[24:27], v[156:159], v[64:67]
    ds_read_b64_tr_b16 a[148:149], v11 offset:24
    ds_read_b64_tr_b16 a[150:151], v11 offset:6424
    v_mfma_f32_16x16x32_bf16 v[68:71], a[28:31], v[156:159], v[68:71]
    ds_read_b64_tr_b16 a[152:153], v11 offset:32
    ds_read_b64_tr_b16 a[154:155], v11 offset:6432
    v_mfma_f32_16x16x32_bf16 v[72:75], a[32:35], v[156:159], v[72:75]
    v_max3_u32 v18, v18, v158, v159
    s_waitcnt vmcnt(8) lgkmcnt(12)
    v_mfma_f32_16x16x32_bf16 v[56:59], a[36:39], v[160:163], v[56:59]
    buffer_load_dwordx2 v[184:185], v7, s[12:15], 0 offen offset:3072 sc1
    buffer_load_dwordx2 v[186:187], v7, s[12:15], 0 offen offset:3328 sc1
    v_max3_u32 v18, v18, v160, v161
    v_mfma_f32_16x16x32_bf16 v[60:63], a[40:43], v[160:163], v[60:63]
    ds_read_b64_tr_b16 a[156:157], v11 offset:25600
    ds_read_b64_tr_b16 a[158:159], v11 offset:32000
    v_mfma_f32_16x16x32_bf16 v[64:67], a[44:47], v[160:163], v[64:67]
    ds_read_b64_tr_b16 a[160:161], v11 offset:25608
    ds_read_b64_tr_b16 a[162:163], v11 offset:32008
    v_mfma_f32_16x16x32_bf16 v[68:71], a[48:51], v[160:163], v[68:71]
    ds_read_b64_tr_b16 a[164:165], v11 offset:25616
    ds_read_b64_tr_b16 a[166:167], v11 offset:32016
    v_mfma_f32_16x16x32_bf16 v[72:75], a[52:55], v[160:163], v[72:75]
    v_max3_u32 v18, v18, v162, v163
    s_waitcnt vmcnt(9) lgkmcnt(12)
    v_mfma_f32_16x16x32_bf16 v[56:59], a[56:59], v[164:167], v[56:59]
    v_max3_u32 v18, v18, v164, v165
    v_mfma_f32_16x16x32_bf16 v[60:63], a[60:63], v[164:167], v[60:63]
    ds_read_b64_tr_b16 a[168:169], v11 offset:25624
    ds_read_b64_tr_b16 a[170:171], v11 offset:32024
    v_mfma_f32_16x16x32_bf16 v[64:67], a[64:67], v[164:167], v[64:67]
    ds_read_b64_tr_b16 a[172:173], v11 offset:25632
    ds_read_b64_tr_b16 a[174:175], v11 offset:32032
    v_mfma_f32_16x16x32_bf16 v[68:71], a[68:71], v[164:167], v[68:71]
    v_mfma_f32_16x16x32_bf16 v[72:75], a[72:75], v[164:167], v[72:75]
    v_max3_u32 v18, v18, v166, v167
    s_waitcnt vmcnt(8) lgkmcnt(12)
    v_mfma_f32_16x16x32_bf16 v[56:59], a[76:79], v[168:171], v[56:59]
    v_max3_u32 v18, v18, v168, v169
    v_mfma_f32_16x16x32_bf16 v[60:63], a[80:83], v[168:171], v[60:63]
    v_mfma_f32_16x16x32_bf16 v[64:67], a[84:87], v[168:171], v[64:67]
    v_mfma_f32_16x16x32_bf16 v[68:71], a[88:91], v[168:171], v[68:71]
    v_mfma_f32_16x16x32_bf16 v[72:75], a[92:95], v[168:171], v[72:75]
    v_max3_u32 v18, v18, v170, v171
    s_waitcnt vmcnt(6) lgkmcnt(12)
    v_mfma_f32_16x16x32_bf16 v[56:59], a[96:99], v[172:175], v[56:59]
    v_max3_u32 v18, v18, v172, v173
    v_mfma_f32_16x16x32_bf16 v[60:63], a[100:103], v[172:175], v[60:63]
    v_mfma_f32_16x16x32_bf16 v[64:67], a[104:107], v[172:175], v[64:67]
    v_mfma_f32_16x16x32_bf16 v[68:71], a[108:111], v[172:175], v[68:71]
    v_mfma_f32_16x16x32_bf16 v[72:75], a[112:115], v[172:175], v[72:75]
    v_max3_u32 v18, v18, v174, v175
    s_waitcnt vmcnt(4) lgkmcnt(12)
    v_mfma_f32_16x16x32_bf16 v[56:59], a[116:119], v[176:179], v[56:59]
    v_max3_u32 v18, v18, v176, v177
    v_mfma_f32_16x16x32_bf16 v[60:63], a[120:123], v[176:179], v[60:63]
    v_mfma_f32_16x16x32_bf16 v[64:67], a[124:127], v[176:179], v[64:67]
    v_mfma_f32_16x16x32_bf16 v[68:71], a[128:131], v[176:179], v[68:71]
    v_mfma_f32_16x16x32_bf16 v[72:75], a[132:135], v[176:179], v[72:75]
    v_max3_u32 v18, v18, v178, v179
    s_waitcnt vmcnt(2) lgkmcnt(10)
    v_mfma_f32_16x16x32_bf16 v[56:59], a[136:139], v[180:183], v[56:59]
    v_max3_u32 v18, v18, v180, v181
    v_mfma_f32_16x16x32_bf16 v[60:63], a[140:143], v[180:183], v[60:63]
    v_mfma_f32_16x16x32_bf16 v[64:67], a[144:147], v[180:183], v[64:67]
    v_mfma_f32_16x16x32_bf16 v[68:71], a[148:151], v[180:183], v[68:71]
    v_mfma_f32_16x16x32_bf16 v[72:75], a[152:155], v[180:183], v[72:75]
    v_max3_u32 v18, v18, v182, v183
    s_waitcnt vmcnt(0) lgkmcnt(0)
    v_mfma_f32_16x16x32_bf16 v[56:59], a[156:159], v[184:187], v[56:59]
    v_max3_u32 v18, v18, v184, v185
    v_mfma_f32_16x16x32_bf16 v[60:63], a[160:163], v[184:187], v[60:63]
    v_mfma_f32_16x16x32_bf16 v[64:67], a[164:167], v[184:187], v[64:67]
    v_mfma_f32_16x16x32_bf16 v[68:71], a[168:171], v[184:187], v[68:71]
    v_mfma_f32_16x16x32_bf16 v[72:75], a[172:175], v[184:187], v[72:75]
    v_max3_u32 v18, v18, v186, v187
    v_cmp_eq_u32 vcc, -1, v18
PAD_5:
    s_cbranch_execz PAD_1
    s_cbranch_vccnz C_redo_15
C_gemmok_17:
    s_nop 0
    v_pk_add_f32 v[80:81], v[56:57], v[58:59]
    v_pk_mul_f32 v[82:83], v[56:57], v[56:57]
    v_pk_mul_f32 v[84:85], v[56:57], v[34:35]
    v_pk_fma_f32 v[82:83], v[58:59], v[58:59], v[82:83]
    v_pk_fma_f32 v[84:85], v[58:59], v[36:37], v[84:85]
    v_pk_add_f32 v[80:81], v[80:81], v[60:61]
    v_pk_fma_f32 v[82:83], v[60:61], v[60:61], v[82:83]
    v_pk_fma_f32 v[84:85], v[60:61], v[38:39], v[84:85]
    v_pk_add_f32 v[80:81], v[80:81], v[62:63]
    v_pk_fma_f32 v[82:83], v[62:63], v[62:63], v[82:83]
    v_pk_fma_f32 v[84:85], v[62:63], v[40:41], v[84:85]
    v_pk_add_f32 v[80:81], v[80:81], v[64:65]
    v_pk_fma_f32 v[82:83], v[64:65], v[64:65], v[82:83]
    v_pk_fma_f32 v[84:85], v[64:65], v[42:43], v[84:85]
    v_pk_add_f32 v[80:81], v[80:81], v[66:67]
    v_pk_fma_f32 v[82:83], v[66:67], v[66:67], v[82:83]
    v_pk_fma_f32 v[84:85], v[66:67], v[44:45], v[84:85]
    v_pk_add_f32 v[80:81], v[80:81], v[68:69]
    v_pk_fma_f32 v[82:83], v[68:69], v[68:69], v[82:83]
    v_pk_fma_f32 v[84:85], v[68:69], v[46:47], v[84:85]
    v_pk_add_f32 v[80:81], v[80:81], v[70:71]
    v_pk_fma_f32 v[82:83], v[70:71], v[70:71], v[82:83]
    v_pk_fma_f32 v[84:85], v[70:71], v[48:49], v[84:85]
    v_pk_add_f32 v[80:81], v[80:81], v[72:73]
    v_pk_fma_f32 v[82:83], v[72:73], v[72:73], v[82:83]
    v_pk_fma_f32 v[84:85], v[72:73], v[50:51], v[84:85]
    v_pk_add_f32 v[80:81], v[80:81], v[74:75]
    v_pk_fma_f32 v[82:83], v[74:75], v[74:75], v[82:83]
    v_pk_fma_f32 v[84:85], v[74:75], v[52:53], v[84:85]
    v_add_f32 v76, v80, v81
    v_add_f32 v77, v82, v83
    v_add_f32 v78, v84, v85
    v_mov_b32 v80, v76
    v_mov_b32 v81, v77
    v_mov_b32 v82, v78
    v_mov_b32 v83, v79
    v_permlane16_swap_b32 v76, v80
    v_permlane16_swap_b32 v77, v81
    v_permlane16_swap_b32 v78, v82
    v_permlane16_swap_b32 v79, v83
    v_add_f32 v76, v76, v80
    v_add_f32 v77, v77, v81
    v_add_f32 v78, v78, v82
    v_add_f32 v79, v79, v83
    v_mov_b32 v80, v76
    v_mov_b32 v81, v77
    v_mov_b32 v82, v78
    v_mov_b32 v83, v79
    v_permlane32_swap_b32 v76, v80
    v_permlane32_swap_b32 v77, v81
    v_permlane32_swap_b32 v78, v82
    v_permlane32_swap_b32 v79, v83
    v_add_f32 v76, v76, v80
    v_add_f32 v77, v77, v81
    v_add_f32 v78, v78, v82
    v_add_f32 v79, v79, v83
    s_cmp_eq_u32 s10, 0
    s_cbranch_scc1 C_stslow_21
    buffer_store_dwordx4 v[76:79], v15, s[12:15], s45 offen
C_stok_22:
    ds_read_b64_tr_b16 a[188:189], v4 offset:0
    ds_read_b64_tr_b16 a[190:191], v4 offset:128
    ds_read_b64_tr_b16 a[192:193], v4 offset:1024
    ds_read_b64_tr_b16 a[194:195], v4 offset:1152
    ds_read_b64_tr_b16 a[196:197], v4 offset:2048
    ds_read_b64_tr_b16 a[198:199], v4 offset:2176
    ds_read_b64_tr_b16 a[200:201], v4 offset:3072
    ds_read_b64_tr_b16 a[202:203], v4 offset:3200
    ds_read_b64_tr_b16 a[204:205], v4 offset:4096
    ds_read_b64_tr_b16 a[206:207], v4 offset:4224
    ds_read_b64_tr_b16 a[208:209], v4 offset:5120
    ds_read_b64_tr_b16 a[210:211], v4 offset:5248
    ds_read_b64_tr_b16 a[212:213], v4 offset:6144
    ds_read_b64_tr_b16 a[214:215], v4 offset:6272
    ds_read_b64_tr_b16 a[216:217], v4 offset:7168
    ds_read_b64_tr_b16 a[218:219], v4 offset:7296
    ds_read_b64_tr_b16 a[220:221], v4 offset:8192
    ds_read_b64_tr_b16 a[222:223], v4 offset:8320
    v_cvt_pk_bf16_f32 v98, v56, v57
    v_cvt_pk_bf16_f32 v99, v58, v59
    v_cvt_pk_bf16_f32 v100, v60, v61
    v_cvt_pk_bf16_f32 v101, v62, v63
    v_cvt_pk_bf16_f32 v102, v64, v65
    v_cvt_pk_bf16_f32 v103, v66, v67
    v_cvt_pk_bf16_f32 v104, v68, v69
    v_cvt_pk_bf16_f32 v105, v70, v71
    v_cvt_pk_bf16_f32 v106, v72, v73
    v_cvt_pk_bf16_f32 v107, v74, v75
    s_mov_b32 s47, 65536
C_st_23:
    buffer_load_dwordx4 v[80:83], v16, s[12:15], s44 offen sc1
    buffer_load_dwordx4 v[84:87], v17, s[12:15], s44 offen sc1
    s_sub_u32 s47, s47, 1
    s_waitcnt vmcnt(0)
    s_cbranch_scc1 C_st_ok_25
    v_max_u32 v18, v80, v81
    v_max3_u32 v18, v18, v82, v83
    v_max3_u32 v18, v18, v84, v85
    v_max3_u32 v18, v18, v86, v87
    v_cmp_eq_u32 vcc, -1, v18
    s_cbranch_vccnz C_st_23
C_st_ok_25:
    v_add_f32 v76, v80, v84
    v_add_f32 v77, v81, v85
    v_add_f32 v78, v82, v86
    v_add_f32 v79, v83, v87
    v_mov_b32 v80, v76
    v_mov_b32 v81, v77
    v_mov_b32 v82, v78
    v_mov_b32 v83, v79
    v_permlane16_swap_b32 v76, v80
    v_permlane16_swap_b32 v77, v81
    v_permlane16_swap_b32 v78, v82
    v_permlane16_swap_b32 v79, v83
    v_add_f32 v76, v76, v80
    v_add_f32 v77, v77, v81
    v_add_f32 v78, v78, v82
    v_add_f32 v79, v79, v83
    v_mov_b32 v80, v76
    v_mov_b32 v81, v77
    v_mov_b32 v82, v78
    v_mov_b32 v83, v79
    v_permlane32_swap_b32 v76, v80
    v_permlane32_swap_b32 v77, v81
    v_permlane32_swap_b32 v78, v82
    v_permlane32_swap_b32 v79, v83
    v_add_f32 v76, v76, v80
    v_add_f32 v77, v77, v81
    v_add_f32 v78, v78, v82
    v_add_f32 v79, v79, v83
    v_mul_f32 v21, 0x3acccccd, v76
    v_mul_f32 v15, v21, v21
    v_mov_b32 v16, 0x3acccccd
    v_fma_f32 v15, v77, v16, -v15
    v_max_f32 v15, 0, v15
    v_add_f32 v15, 0x3727c5ac, v15
    v_rsq_f32 v22, v15
    v_fma_f32 v16, -v21, v79, v78
    v_mul_f32 v16, v16, v22
    v_ashrrev_i32 v17, 31, v16
    v_or_b32 v17, 0x80000000, v17
    v_xor_b32 v17, v17, v16
    v_min_u32 v17, 0xfffff7ff, v17
    v_and_b32 v17, 0xfffff800, v17
    v_or_b32 v12, v12, v17
    v_mov_b32 v80, v12
    s_nop 1
    v_max_u32_dpp v80, v80, v80 row_ror:8 row_mask:0xf bank_mask:0xf
    s_nop 1
    v_max_u32_dpp v80, v80, v80 row_ror:4 row_mask:0xf bank_mask:0xf
    s_nop 1
    v_max_u32_dpp v80, v80, v80 row_ror:2 row_mask:0xf bank_mask:0xf
    s_nop 1
    v_max_u32_dpp v80, v80, v80 row_ror:1 row_mask:0xf bank_mask:0xf
    v_cmp_eq_u32 vcc, v80, v12
    v_mov_b32 v15, s58
    v_mov_b32 v16, 102400
    v_cndmask_b32 v81, v12, 0, vcc
    s_nop 1
    v_max_u32_dpp v81, v81, v81 row_ror:8 row_mask:0xf bank_mask:0xf
    s_nop 1
    v_max_u32_dpp v81, v81, v81 row_ror:4 row_mask:0xf bank_mask:0xf
    s_nop 1
    v_max_u32_dpp v81, v81, v81 row_ror:2 row_mask:0xf bank_mask:0xf
    s_nop 1
    v_max_u32_dpp v81, v81, v81 row_ror:1 row_mask:0xf bank_mask:0xf
    ds_write_b64 v15, v[80:81] offset:2048
    s_waitcnt lgkmcnt(0)
    s_barrier
    ds_read_b64 v[80:81], v16 offset:2048
    ds_read_b64 v[82:83], v16 offset:17408
    ds_read_b64 v[84:85], v16 offset:32768
    ds_read_b64 v[86:87], v16 offset:48128
    v_sub_f32 v15, v56, v21
    v_sub_f32 v16, v57, v21
    v_mul_f32 v15, v15, v22
    v_mul_f32 v16, v16, v22
    v_cvt_pk_bf16_f32 v88, v15, v16
    v_sub_f32 v15, v58, v21
    v_sub_f32 v16, v59, v21
    v_mul_f32 v15, v15, v22
    v_mul_f32 v16, v16, v22
    v_cvt_pk_bf16_f32 v89, v15, v16
    v_sub_f32 v15, v60, v21
    v_sub_f32 v16, v61, v21
    v_mul_f32 v15, v15, v22
    v_mul_f32 v16, v16, v22
    v_cvt_pk_bf16_f32 v90, v15, v16
    v_sub_f32 v15, v62, v21
    v_sub_f32 v16, v63, v21
    v_mul_f32 v15, v15, v22
    v_mul_f32 v16, v16, v22
    v_cvt_pk_bf16_f32 v91, v15, v16
    s_waitcnt lgkmcnt(0)
    v_mov_b32 v76, v80
    v_mov_b32 v77, v81
    v_med3_u32 v77, v76, v77, v82
    v_max_u32 v76, v76, v82
    v_med3_u32 v77, v76, v77, v83
    v_max_u32 v76, v76, v83
    v_med3_u32 v77, v76, v77, v84
    v_max_u32 v76, v76, v84
    v_med3_u32 v77, v76, v77, v85
    v_max_u32 v76, v76, v85
    v_med3_u32 v77, v76, v77, v86
    v_max_u32 v76, v76, v86
    v_med3_u32 v77, v76, v77, v87
    v_max_u32 v76, v76, v87
    s_lshl_b32 s44, s40, 3
    s_add_u32 s44, s44, s49
    s_cmp_lg_u32 s44, 7
    s_cbranch_scc1 C_nock_26
    s_lshl_b32 s44, s48, 7
    s_add_u32 s44, s44, 11993088
    s_mov_b64 exec, 1
    buffer_store_dwordx2 v[76:77], v2, s[12:15], s44 offen sc1
    s_mov_b64 exec, -1
C_nock_26:
    v_sub_f32 v15, v64, v21
    v_sub_f32 v16, v65, v21
    v_mul_f32 v15, v15, v22
    v_mul_f32 v16, v16, v22
    v_cvt_pk_bf16_f32 v92, v15, v16
    v_sub_f32 v15, v66, v21
    v_sub_f32 v16, v67, v21
    v_mul_f32 v15, v15, v22
    v_mul_f32 v16, v16, v22
    v_cvt_pk_bf16_f32 v93, v15, v16
    v_sub_f32 v15, v68, v21
    v_sub_f32 v16, v69, v21
    v_mul_f32 v15, v15, v22
    v_mul_f32 v16, v16, v22
    v_cvt_pk_bf16_f32 v94, v15, v16
    v_sub_f32 v15, v70, v21
    v_sub_f32 v16, v71, v21
    v_mul_f32 v15, v15, v22
    v_mul_f32 v16, v16, v22
    v_cvt_pk_bf16_f32 v95, v15, v16
    v_sub_f32 v15, v72, v21
    v_sub_f32 v16, v73, v21
    v_mul_f32 v15, v15, v22
    v_mul_f32 v16, v16, v22
    v_cvt_pk_bf16_f32 v96, v15, v16
    v_sub_f32 v15, v74, v21
    v_sub_f32 v16, v75, v21
    v_mul_f32 v15, v15, v22
    v_mul_f32 v16, v16, v22
    v_cvt_pk_bf16_f32 v97, v15, v16
    v_cmp_eq_u32 vcc, v77, v12
    v_mul_u32_u24 v15, 40, v14
    v_add_u32 v16, 3072, v15
    v_cndmask_b32 v15, v15, v16, vcc
    v_cmp_le_u32 vcc, v77, v12
    s_mul_i32 s44, s48, 6144
    s_mul_i32 s45, s49, 384
    s_add_u32 s44, s44, s45
    s_add_u32 s44, s44, 11796480
    s_and_saveexec_b64 s[54:55], vcc
    s_cbranch_execz C_nocand_27
    buffer_store_dwordx4 v[88:91], v15, s[12:15], s44 offen sc1
    buffer_store_dwordx4 v[92:95], v15, s[12:15], s44 offen offset:16 sc1
    buffer_store_dwordx2 v[96:97], v15, s[12:15], s44 offen offset:32 sc1
    buffer_store_dwordx4 v[98:101], v15, s[12:15], s44 offen offset:160 sc1
    buffer_store_dwordx4 v[102:105], v15, s[12:15], s44 offen offset:176 sc1
    buffer_store_dwordx2 v[106:107], v15, s[12:15], s44 offen offset:192 sc1
C_nocand_27:
    s_mov_b64 exec, -1
    v_lshlrev_b32 v15, 16, v88
    v_and_b32 v16, 0xffff0000, v88
    v_add_f32 v15, v15, v56
    v_add_f32 v16, v16, v57
    v_cvt_pk_bf16_f32 v24, v15, v16
    v_lshlrev_b32 v15, 16, v89
    v_and_b32 v16, 0xffff0000, v89
    v_add_f32 v15, v15, v58
    v_add_f32 v16, v16, v59
    v_cvt_pk_bf16_f32 v25, v15, v16
    v_lshlrev_b32 v15, 16, v90
    v_and_b32 v16, 0xffff0000, v90
    v_add_f32 v15, v15, v60
    v_add_f32 v16, v16, v61
    v_cvt_pk_bf16_f32 v26, v15, v16
    v_lshlrev_b32 v15, 16, v91
    v_and_b32 v16, 0xffff0000, v91
    v_add_f32 v15, v15, v62
    v_add_f32 v16, v16, v63
    v_cvt_pk_bf16_f32 v27, v15, v16
    v_lshlrev_b32 v15, 16, v92
    v_and_b32 v16, 0xffff0000, v92
    v_add_f32 v15, v15, v64
    v_add_f32 v16, v16, v65
    v_cvt_pk_bf16_f32 v28, v15, v16
    v_lshlrev_b32 v15, 16, v93
    v_and_b32 v16, 0xffff0000, v93
    v_add_f32 v15, v15, v66
    v_add_f32 v16, v16, v67
    v_cvt_pk_bf16_f32 v29, v15, v16
    v_lshlrev_b32 v15, 16, v94
    v_and_b32 v16, 0xffff0000, v94
    v_add_f32 v15, v15, v68
    v_add_f32 v16, v16, v69
    v_cvt_pk_bf16_f32 v30, v15, v16
    v_lshlrev_b32 v15, 16, v95
    v_and_b32 v16, 0xffff0000, v95
    v_add_f32 v15, v15, v70
    v_add_f32 v16, v16, v71
    v_cvt_pk_bf16_f32 v31, v15, v16
    v_lshlrev_b32 v15, 16, v96
    v_and_b32 v16, 0xffff0000, v96
    v_add_f32 v15, v15, v72
    v_add_f32 v16, v16, v73
    v_cvt_pk_bf16_f32 v32, v15, v16
    v_lshlrev_b32 v15, 16, v97
    v_and_b32 v16, 0xffff0000, v97
    v_add_f32 v15, v15, v74
    v_add_f32 v16, v16, v75
    v_cvt_pk_bf16_f32 v33, v15, v16
    v_cmp_gt_u32 s[54:55], v77, v12
    v_and_b32 v15, 31, v1
    v_lshlrev_b32 v15, 7, v15
    s_mov_b32 s44, 11993088
    s_cmp_eq_u32 s42, 2
    s_cselect_b64 s[54:55], s[54:55], 0
    s_mov_b64 exec, s[54:55]
    s_cbranch_execz C_noout_28
    buffer_store_dwordx4 v[24:27], v3, s[20:23], 0 offen
    buffer_store_dwordx4 v[28:31], v3, s[20:23], 0 offen offset:16
    buffer_store_dwordx2 v[32:33], v3, s[20:23], 0 offen offset:32
C_noout_28:
    s_mov_b64 exec, -1
    s_mov_b32 s47, 65536
C_ck_29:
    buffer_load_dwordx2 v[80:81], v15, s[12:15], s44 offen sc1
    s_sub_u32 s47, s47, 1
    s_waitcnt vmcnt(0)
    s_cbranch_scc1 C_ck_ok_31
    v_max_u32 v18, v80, v81
    v_cmp_eq_u32 vcc, -1, v18
    s_cbranch_vccnz C_ck_29
C_ck_ok_31:
    v_mov_b32 v76, v80
    s_nop 1
    v_max_u32_dpp v76, v76, v76 row_ror:8 row_mask:0xf bank_mask:0xf
    s_nop 1
    v_max_u32_dpp v76, v76, v76 row_ror:4 row_mask:0xf bank_mask:0xf
    s_nop 1
    v_max_u32_dpp v76, v76, v76 row_ror:2 row_mask:0xf bank_mask:0xf
    s_nop 1
    v_max_u32_dpp v76, v76, v76 row_ror:1 row_mask:0xf bank_mask:0xf
    v_mov_b32 v78, v76
    s_nop 1
    v_permlane16_swap_b32 v76, v78
    v_max_u32 v76, v76, v78
    v_cmp_eq_u32 vcc, v76, v80
    v_readfirstlane_b32 s50, v76
    s_nop 0
    v_cndmask_b32 v77, v80, v81, vcc
    s_nop 1
    v_max_u32_dpp v77, v77, v77 row_ror:8 row_mask:0xf bank_mask:0xf
    s_nop 1
    v_max_u32_dpp v77, v77, v77 row_ror:4 row_mask:0xf bank_mask:0xf
    s_nop 1
    v_max_u32_dpp v77, v77, v77 row_ror:2 row_mask:0xf bank_mask:0xf
    s_nop 1
    v_max_u32_dpp v77, v77, v77 row_ror:1 row_mask:0xf bank_mask:0xf
    v_mov_b32 v78, v77
    s_nop 1
    v_permlane16_swap_b32 v77, v78
    v_max_u32 v77, v77, v78
    s_nop 0
    v_readfirstlane_b32 s51, v77
    s_not_b32 s44, s50
    s_bfe_u32 s44, s44, 0x50006
    s_not_b32 s45, s51
    s_bfe_u32 s45, s45, 0x50006
    s_mul_i32 s52, s44, 6144
    s_mul_i32 s53, s45, 6144
    s_cmp_eq_u32 s44, s45
    s_cselect_b32 s44, 3072, 0
    s_add_u32 s53, s53, s44
    v_and_b32 v15, 1, v1
    v_cmp_eq_u32 vcc, 1, v15
    v_mov_b32 v16, s52
    v_mov_b32 v17, s53
    v_cndmask_b32 v20, v16, v17, vcc
    v_mov_b32 v16, s50
    v_mov_b32 v17, s51
    v_cndmask_b32 v23, v16, v17, vcc
    v_cmp_gt_u32 vcc, s51, v12
    s_andn2_b64 s[54:55], vcc, s[54:55]
    s_mov_b32 s56, 0x30003
    s_mov_b32 s57, 0x30003
    s_cmp_lg_u32 s42, 0
    s_cbranch_scc1 C_notE_32
    v_lshrrev_b32 v15, 1, v14
    v_and_b32 v16, 1, v14
    v_mul_u32_u24 v17, 384, v15
    v_lshl_add_u32 v17, v16, 4, v17
    v_add_u32 v20, v20, v17
    s_mul_i32 s44, s40, 768
    s_add_u32 s44, s44, 11796480
    s_mov_b64 exec, s[56:57]
    s_mov_b32 s47, 65536
E_cr_35:
    buffer_load_dwordx4 v[108:111], v20, s[12:15], s44 offen offset:0 sc1
    buffer_load_dwordx4 v[112:115], v20, s[12:15], s44 offen offset:32 sc1
    buffer_load_dwordx4 v[116:119], v20, s[12:15], s44 offen offset:64 sc1
    buffer_load_dwordx4 v[120:123], v20, s[12:15], s44 offen offset:96 sc1
    buffer_load_dwordx4 v[124:127], v20, s[12:15], s44 offen offset:128 sc1
    s_sub_u32 s47, s47, 1
    s_waitcnt vmcnt(0)
    s_cbranch_scc1 E_cr_ok_37
    v_max_u32 v18, v108, v109
    v_max3_u32 v18, v18, v110, v111
    v_max3_u32 v18, v18, v112, v113
    v_max3_u32 v18, v18, v114, v115
    v_max3_u32 v18, v18, v116, v117
    v_max3_u32 v18, v18, v118, v119
    v_max3_u32 v18, v18, v120, v121
    v_max3_u32 v18, v18, v122, v123
    v_max3_u32 v18, v18, v124, v125
    v_max3_u32 v18, v18, v126, v127
    v_cmp_eq_u32 vcc, -1, v18
    s_cbranch_vccnz E_cr_35
E_cr_ok_37:
    s_mov_b64 exec, -1
    v_mfma_f32_16x16x32_bf16 v[76:79], a[188:191], v[108:111], 0
    v_mfma_f32_16x16x32_bf16 v[80:83], a[192:195], v[108:111], 0
    v_mfma_f32_16x16x32_bf16 v[76:79], a[196:199], v[112:115], v[76:79]
    v_mfma_f32_16x16x32_bf16 v[80:83], a[200:203], v[112:115], v[80:83]
    v_mfma_f32_16x16x32_bf16 v[76:79], a[204:207], v[116:119], v[76:79]
    v_mfma_f32_16x16x32_bf16 v[80:83], a[208:211], v[116:119], v[80:83]
    v_mfma_f32_16x16x32_bf16 v[76:79], a[212:215], v[120:123], v[76:79]
    v_mfma_f32_16x16x32_bf16 v[80:83], a[216:219], v[120:123], v[80:83]
    v_mfma_f32_16x16x32_bf16 v[76:79], a[220:223], v[124:127], v[76:79]
    v_mfma_f32_16x16x32_bf16 v[80:83], a[224:227], v[124:127], v[80:83]
    v_lshlrev_b32 v15, 4, v1
    v_add_u32 v16, s58, v15
    v_add_u32 v15, 102400, v15
    s_nop 4
    ds_write_b128 v16, v[76:79] offset:0
    ds_write_b128 v16, v[80:83] offset:1024
    s_waitcnt lgkmcnt(0)
    s_barrier
    s_cmp_lg_u32 s40, 0
    s_cbranch_scc1 C_outonly_34
    ds_read_b128 v[140:143], v15 offset:0
    ds_read_b128 v[144:147], v15 offset:15360
    ds_read_b128 v[148:151], v15 offset:30720
    ds_read_b128 v[152:155], v15 offset:46080
    ds_read_b128 v[156:159], v15 offset:1024
    ds_read_b128 v[160:163], v15 offset:16384
    ds_read_b128 v[164:167], v15 offset:31744
    ds_read_b128 v[168:171], v15 offset:47104
    s_waitcnt lgkmcnt(0)
    v_pk_add_f32 v[140:141], v[140:141], v[144:145]
    v_pk_add_f32 v[148:149], v[148:149], v[152:153]
    v_pk_add_f32 v[140:141], v[140:141], v[148:149]
    v_pk_add_f32 v[142:143], v[142:143], v[146:147]
    v_pk_add_f32 v[150:151], v[150:151], v[154:155]
    v_pk_add_f32 v[142:143], v[142:143], v[150:151]
    v_pk_add_f32 v[156:157], v[156:157], v[160:161]
    v_pk_add_f32 v[164:165], v[164:165], v[168:169]
    v_pk_add_f32 v[156:157], v[156:157], v[164:165]
    v_pk_add_f32 v[158:159], v[158:159], v[162:163]
    v_pk_add_f32 v[166:167], v[166:167], v[170:171]
    v_pk_add_f32 v[158:159], v[158:159], v[166:167]
    v_cvt_pk_bf16_f32 v15, v140, v141
    v_lshlrev_b32 v140, 16, v15
    v_and_b32 v141, 0xffff0000, v15
    v_cvt_pk_bf16_f32 v15, v142, v143
    v_lshlrev_b32 v142, 16, v15
    v_and_b32 v143, 0xffff0000, v15
    v_cvt_pk_bf16_f32 v15, v156, v157
    v_lshlrev_b32 v156, 16, v15
    v_and_b32 v157, 0xffff0000, v15
    v_cvt_pk_bf16_f32 v15, v158, v159
    v_lshlrev_b32 v158, 16, v15
    v_and_b32 v159, 0xffff0000, v15
    v_mul_f32 v144, 0xbfb8aa3b, v140
    v_mul_f32 v145, 0xbfb8aa3b, v141
    v_mul_f32 v146, 0xbfb8aa3b, v142
    v_mul_f32 v147, 0xbfb8aa3b, v143
    v_exp_f32 v144, v144
    v_exp_f32 v145, v145
    v_exp_f32 v146, v146
    v_exp_f32 v147, v147
    v_add_f32 v144, 1.0, v144
    v_add_f32 v145, 1.0, v145
    v_add_f32 v146, 1.0, v146
    v_add_f32 v147, 1.0, v147
    v_rcp_f32 v144, v144
    v_rcp_f32 v145, v145
    v_rcp_f32 v146, v146
    v_rcp_f32 v147, v147
    v_mul_f32 v140, v140, v144
    v_mul_f32 v141, v141, v145
    v_mul_f32 v142, v142, v146
    v_mul_f32 v143, v143, v147
    v_cvt_pk_bf16_f32 v15, v140, v141
    v_lshlrev_b32 v140, 16, v15
    v_and_b32 v141, 0xffff0000, v15
    v_mul_f32 v140, v140, v156
    v_mul_f32 v141, v141, v157
    v_cvt_pk_bf16_f32 v76, v140, v141
    v_cvt_pk_bf16_f32 v15, v142, v143
    v_lshlrev_b32 v142, 16, v15
    v_and_b32 v143, 0xffff0000, v15
    v_mul_f32 v142, v142, v158
    v_mul_f32 v143, v143, v159
    v_cvt_pk_bf16_f32 v77, v142, v143
    v_and_b32 v15, 1, v1
    v_lshlrev_b32 v15, 5, v15
    v_lshl_add_u32 v15, v14, 3, v15
    s_lshl_b32 s44, s43, 7
    s_add_u32 s44, s44, 11997184
    s_mov_b64 exec, s[56:57]
    buffer_store_dwordx2 v[76:77], v15, s[12:15], s44 offen sc1
C_outonly_34:
    s_barrier
    s_mov_b64 exec, s[54:55]
    s_cbranch_execz C_noout_38
    buffer_store_dwordx4 v[24:27], v3, s[20:23], 0 offen
    buffer_store_dwordx4 v[28:31], v3, s[20:23], 0 offen offset:16
    buffer_store_dwordx2 v[32:33], v3, s[20:23], 0 offen offset:32
C_noout_38:
    s_mov_b64 exec, -1
    s_branch C_end_33
PAD_6:
    s_cbranch_execz PAD_2
C_notE_32:
    s_cmp_eq_u32 s42, 1
    s_cbranch_scc1 C_isF_39
    s_mov_b64 exec, s[54:55]
    s_cbranch_execz C_noout_40
    buffer_store_dwordx4 v[24:27], v3, s[20:23], 0 offen
    buffer_store_dwordx4 v[28:31], v3, s[20:23], 0 offen offset:16
    buffer_store_dwordx2 v[32:33], v3, s[20:23], 0 offen offset:32
C_noout_40:
    s_mov_b64 exec, -1
    s_branch C_end_33
C_isF_39:
    s_mul_i32 s44, s43, 52429
    s_lshr_b32 s44, s44, 18
    s_mul_i32 s44, s44, 224
    s_lshl_b32 s45, s43, 5
    s_add_u32 s44, s44, s45
    s_add_u32 s44, s44, 11796480
    v_lshl_add_u32 v20, v14, 3, v20
    v_not_b32 v17, v23
    v_and_b32 v16, 2047, v17
    v_mul_u32_u24 v22, 1280, v16
    v_lshl_add_u32 v22, v14, 3, v22
    v_add_u32 v22, s45, v22
    v_ashrrev_i32 v17, 31, v17
    v_or_b32 v17, 0x80000000, v17
    v_xor_b32 v16, v17, v23
    v_mul_f32 v16, 0xbfb8aa3b, v16
    v_exp_f32 v16, v16
    v_and_b32 v15, 1, v1
    v_add_f32 v16, 1.0, v16
    v_rcp_f32 v21, v16
    v_lshlrev_b32 v15, 5, v15
    v_lshrrev_b32 v16, 1, v14
    v_lshl_add_u32 v15, v16, 7, v15
    v_and_b32 v16, 1, v14
    v_lshl_add_u32 v15, v16, 4, v15
    s_mov_b64 exec, s[56:57]
    s_mov_b32 s47, 65536
F_cr_41:
    buffer_load_dwordx2 v[88:89], v20, s[12:15], s44 offen sc1
    buffer_load_dwordx2 v[90:91], v20, s[12:15], s44 offen offset:160 sc1
    s_sub_u32 s47, s47, 1
    s_waitcnt vmcnt(0)
    s_cbranch_scc1 F_cr_ok_43
    v_max_u32 v18, v88, v89
    v_max3_u32 v18, v18, v90, v91
    v_cmp_eq_u32 vcc, -1, v18
    s_cbranch_vccnz F_cr_41
F_cr_ok_43:
    s_mov_b64 exec, s[54:55]
    s_cbranch_execz C_noout_44
    buffer_store_dwordx4 v[24:27], v3, s[20:23], 0 offen
    buffer_store_dwordx4 v[28:31], v3, s[20:23], 0 offen offset:16
    buffer_store_dwordx2 v[32:33], v3, s[20:23], 0 offen offset:32
C_noout_44:
    s_mov_b64 exec, -1
    s_mov_b64 exec, s[56:57]
    s_mul_i32 s44, s40, 3072
    s_add_u32 s44, s44, 11997184
    s_mov_b32 s47, 65536
    s_sleep 26
F_ac_45:
    buffer_load_dwordx4 v[108:111], v15, s[12:15], s44 offen offset:0 sc1
    buffer_load_dwordx4 v[112:115], v15, s[12:15], s44 offen offset:256 sc1
    buffer_load_dwordx4 v[116:119], v15, s[12:15], s44 offen offset:512 sc1
    buffer_load_dwordx4 v[120:123], v15, s[12:15], s44 offen offset:768 sc1
    buffer_load_dwordx4 v[124:127], v15, s[12:15], s44 offen offset:1024 sc1
    buffer_load_dwordx4 v[128:131], v15, s[12:15], s44 offen offset:1280 sc1
    buffer_load_dwordx4 v[132:135], v15, s[12:15], s44 offen offset:1536 sc1
    buffer_load_dwordx4 v[136:139], v15, s[12:15], s44 offen offset:1792 sc1
    buffer_load_dwordx4 v[140:143], v15, s[12:15], s44 offen offset:2048 sc1
    buffer_load_dwordx4 v[144:147], v15, s[12:15], s44 offen offset:2304 sc1
    buffer_load_dwordx4 v[148:151], v15, s[12:15], s44 offen offset:2560 sc1
    buffer_load_dwordx4 v[152:155], v15, s[12:15], s44 offen offset:2816 sc1
    s_sub_u32 s47, s47, 1
    s_waitcnt vmcnt(0)
    s_cbranch_scc1 F_ac_ok_47
    v_max_u32 v18, v108, v109
    v_max3_u32 v18, v18, v110, v111
    v_max3_u32 v18, v18, v112, v113
    v_max3_u32 v18, v18, v114, v115
    v_max3_u32 v18, v18, v116, v117
    v_max3_u32 v18, v18, v118, v119
    v_max3_u32 v18, v18, v120, v121
    v_max3_u32 v18, v18, v122, v123
    v_max3_u32 v18, v18, v124, v125
    v_max3_u32 v18, v18, v126, v127
    v_max3_u32 v18, v18, v128, v129
    v_max3_u32 v18, v18, v130, v131
    v_max3_u32 v18, v18, v132, v133
    v_max3_u32 v18, v18, v134, v135
    v_max3_u32 v18, v18, v136, v137
    v_max3_u32 v18, v18, v138, v139
    v_max3_u32 v18, v18, v140, v141
    v_max3_u32 v18, v18, v142, v143
    v_max3_u32 v18, v18, v144, v145
    v_max3_u32 v18, v18, v146, v147
    v_max3_u32 v18, v18, v148, v149
    v_max3_u32 v18, v18, v150, v151
    v_max3_u32 v18, v18, v152, v153
    v_max3_u32 v18, v18, v154, v155
    v_cmp_eq_u32 vcc, -1, v18
    s_cbranch_vccnz F_ac_45
F_ac_ok_47:
    s_mov_b64 exec, -1
    v_mfma_f32_16x16x32_bf16 v[76:79], a[188:191], v[108:111], 0
    v_mfma_f32_16x16x32_bf16 v[76:79], a[192:195], v[112:115], v[76:79]
    v_mfma_f32_16x16x32_bf16 v[76:79], a[196:199], v[116:119], v[76:79]
    v_mfma_f32_16x16x32_bf16 v[76:79], a[200:203], v[120:123], v[76:79]
    v_mfma_f32_16x16x32_bf16 v[76:79], a[204:207], v[124:127], v[76:79]
    v_mfma_f32_16x16x32_bf16 v[76:79], a[208:211], v[128:131], v[76:79]
    v_mfma_f32_16x16x32_bf16 v[76:79], a[212:215], v[132:135], v[76:79]
    v_mfma_f32_16x16x32_bf16 v[76:79], a[216:219], v[136:139], v[76:79]
    v_mfma_f32_16x16x32_bf16 v[76:79], a[220:223], v[140:143], v[76:79]
    v_mfma_f32_16x16x32_bf16 v[76:79], a[224:227], v[144:147], v[76:79]
    v_mfma_f32_16x16x32_bf16 v[76:79], a[228:231], v[148:151], v[76:79]
    v_mfma_f32_16x16x32_bf16 v[76:79], a[232:235], v[152:155], v[76:79]
    v_lshlrev_b32 v15, 4, v1
    v_add_u32 v16, s58, v15
    v_add_u32 v15, 102400, v15
    s_nop 4
    ds_write_b128 v16, v[76:79] offset:0
    s_waitcnt lgkmcnt(0)
    s_barrier
    s_cmp_lg_u32 s40, 0
    s_cbranch_scc1 C_end_33
    ds_read_b128 v[156:159], v15 offset:0
    ds_read_b128 v[160:163], v15 offset:15360
    ds_read_b128 v[164:167], v15 offset:30720
    ds_read_b128 v[168:171], v15 offset:46080
    s_waitcnt lgkmcnt(0)
    v_pk_add_f32 v[156:157], v[156:157], v[160:161]
    v_pk_add_f32 v[164:165], v[164:165], v[168:169]
    v_pk_add_f32 v[156:157], v[156:157], v[164:165]
    v_pk_add_f32 v[158:159], v[158:159], v[162:163]
    v_pk_add_f32 v[166:167], v[166:167], v[170:171]
    v_pk_add_f32 v[158:159], v[158:159], v[166:167]
    v_lshlrev_b32 v15, 16, v88
    v_and_b32 v16, 0xffff0000, v88
    v_fmac_f32 v15, v156, v21
    v_fmac_f32 v16, v157, v21
    v_cvt_pk_bf16_f32 v17, v15, v16
    v_lshlrev_b32 v15, 16, v17
    v_and_b32 v16, 0xffff0000, v17
    v_lshlrev_b32 v160, 16, v90
    v_and_b32 v161, 0xffff0000, v90
    v_add_f32 v15, v15, v160
    v_add_f32 v16, v16, v161
    v_cvt_pk_bf16_f32 v76, v15, v16
    v_lshlrev_b32 v15, 16, v89
    v_and_b32 v16, 0xffff0000, v89
    v_fmac_f32 v15, v158, v21
    v_fmac_f32 v16, v159, v21
    v_cvt_pk_bf16_f32 v17, v15, v16
    v_lshlrev_b32 v15, 16, v17
    v_and_b32 v16, 0xffff0000, v17
    v_lshlrev_b32 v160, 16, v91
    v_and_b32 v161, 0xffff0000, v91
    v_add_f32 v15, v15, v160
    v_add_f32 v16, v16, v161
    v_cvt_pk_bf16_f32 v77, v15, v16
    s_mov_b64 exec, s[56:57]
PAD_7:
    s_cbranch_execz PAD_3
    buffer_store_dwordx2 v[76:77], v22, s[20:23], 0 offen
C_end_33:
sequential_preLN__mha_block__moe_arch_mod__prompt_kernel_done:
    s_endpgm
A_rsre_6:
    s_mov_b32 s47, 65536
A_rs_48:
    buffer_load_dwordx4 v[56:59], v42, s[12:15], 0 offen sc1
    buffer_load_dword v41, v2, s[16:19], 0 offen sc1
    s_sub_u32 s47, s47, 1
    s_waitcnt vmcnt(0)
    s_cbranch_scc1 A_rs_ok_50
    v_xor_b32 v3, v58, v41
    v_xor_b32 v4, v59, v41
    v_and_b32 v5, 1, v41
    v_xor_b32 v5, 1, v5
    v_or3_b32 v3, v3, v4, v5
    v_cmp_ne_u32 vcc, 0, v3
    s_cbranch_vccnz A_rs_48
A_rs_ok_50:
    s_branch A_rsok_5
A_rsre_8:
    s_mov_b32 s47, 65536
A_rs_51:
    buffer_load_dwordx4 v[56:59], v42, s[12:15], 0 offen sc1
    buffer_load_dword v41, v2, s[16:19], 0 offen sc1
    s_sub_u32 s47, s47, 1
    s_waitcnt vmcnt(0)
    s_cbranch_scc1 A_rs_ok_53
    v_xor_b32 v3, v58, v41
    v_xor_b32 v4, v59, v41
    v_and_b32 v5, 1, v41
    v_xor_b32 v5, 1, v5
    v_or3_b32 v3, v3, v4, v5
    v_cmp_ne_u32 vcc, 0, v3
    s_cbranch_vccnz A_rs_51
A_rs_ok_53:
    s_branch A_rsok_7
B_flre_14:
    s_mov_b32 s47, 65536
B_allfl_54:
    buffer_load_dword v34, v27, s[12:15], 0 offen sc1
    buffer_load_dword v35, v26, s[12:15], 0 offen sc1
    s_sub_u32 s47, s47, 1
    s_waitcnt vmcnt(0)
    s_cbranch_scc1 B_allfl_ok_56
    v_xor_b32 v34, s10, v34
    v_xor_b32 v35, s10, v35
    v_or_b32 v15, v34, v35
    v_and_b32 v15, 0xffffffe1, v15
    v_cmp_ne_u32 vcc, 0, v15
    s_cbranch_vccnz B_allfl_54
B_allfl_ok_56:
    s_branch B_flok_13
C_redo_15:
    s_cmp_eq_u32 s51, 0
    s_cbranch_scc1 C_gemmok_17
    s_sub_u32 s51, s51, 1
    v_subrev_u32 v8, 51200, v8
    v_subrev_u32 v9, 51200, v9
    s_nop 7
    s_branch C_again_16
C_stslow_21:
    buffer_store_dwordx4 v[76:79], v15, s[12:15], s45 offen sc1
    s_branch C_stok_22
sequential_preLN__mha_block__moe_arch_mod__prompt_kernel_slow:
    s_nop 7
    s_lshl_b32 s44, s51, 14
    s_mul_i32 s45, s51, 40960
    v_subrev_u32 v19, s44, v19
    v_subrev_u32 v20, s44, v20
    v_subrev_u32 v22, s45, v22
    s_mov_b32 s52, 0
    s_mov_b32 s53, 0
    v_mov_b32 v124, 0xff7fffff
    v_mov_b32 v125, 0xff7fffff
    v_mov_b32 v180, 0
    v_mov_b32 v181, 0
    v_mov_b32 v182, 0
    v_mov_b32 v183, 0
    v_mov_b32 v184, 0
    v_mov_b32 v185, 0
    v_mov_b32 v186, 0
    v_mov_b32 v187, 0
    v_mov_b32 v188, 0
    v_mov_b32 v189, 0
    v_mov_b32 v190, 0
    v_mov_b32 v191, 0
    v_mov_b32 v192, 0
    v_mov_b32 v193, 0
    v_mov_b32 v194, 0
    v_mov_b32 v195, 0
    v_mov_b32 v196, 0
    v_mov_b32 v197, 0
    v_mov_b32 v198, 0
    v_mov_b32 v199, 0
    v_mov_b32 v200, 0
    v_mov_b32 v201, 0
    v_mov_b32 v202, 0
    v_mov_b32 v203, 0
    v_mov_b32 v204, 0
    v_mov_b32 v205, 0
    v_mov_b32 v206, 0
    v_mov_b32 v207, 0
    v_mov_b32 v208, 0
    v_mov_b32 v209, 0
    v_mov_b32 v210, 0
    v_mov_b32 v211, 0
slow_loop_57:
    buffer_load_dwordx4 a[8:11], v19, s[12:15], s52 offen offset:0 sc1
    buffer_load_dwordx2 a[74:75], v20, s[12:15], s52 offen offset:0 sc1
    buffer_load_dwordx4 a[12:15], v19, s[12:15], s52 offen offset:512 sc1
    s_mov_b64 exec, s[62:63]
    buffer_load_dwordx4 a[40:43], v22, s[12:15], s53 offen offset:0 sc1
    buffer_load_dwordx4 a[44:47], v22, s[12:15], s53 offen offset:640 sc1
    buffer_load_dwordx4 a[48:51], v22, s[12:15], s53 offen offset:1280 sc1
    buffer_load_dwordx4 a[52:55], v22, s[12:15], s53 offen offset:1920 sc1
    s_mov_b64 exec, -1
    s_waitcnt vmcnt(0)
    v_mfma_f32_32x32x4_2b_bf16 v[92:123], a[74:75], v[58:59], 0 cbsz:1 abid:0
    s_nop 15
    s_nop 1
    v_mfma_f32_32x32x16_bf16 v[92:107], a[8:11], v[48:51], v[92:107]
    s_nop 11
    v_max3_f32 v15, v92, v93, v124
    v_max3_f32 v15, v94, v95, v15
    v_max3_f32 v15, v96, v97, v15
    v_max3_f32 v15, v98, v99, v15
    v_max3_f32 v15, v100, v101, v15
    v_max3_f32 v15, v102, v103, v15
    v_max3_f32 v15, v104, v105, v15
    v_max3_f32 v15, v106, v107, v15
    v_mov_b32 v16, v15
    s_nop 1
    v_permlane32_swap_b32 v15, v16
    v_max_f32 v15, v15, v16
    v_sub_f32 v16, v124, v15
    v_exp_f32 v16, v16
    v_mov_b32 v124, v15
    v_sub_f32 v92, v92, v15
    v_sub_f32 v93, v93, v15
    v_sub_f32 v94, v94, v15
    v_sub_f32 v95, v95, v15
    v_sub_f32 v96, v96, v15
    v_sub_f32 v97, v97, v15
    v_sub_f32 v98, v98, v15
    v_sub_f32 v99, v99, v15
    v_sub_f32 v100, v100, v15
    v_sub_f32 v101, v101, v15
    v_sub_f32 v102, v102, v15
    v_sub_f32 v103, v103, v15
    v_sub_f32 v104, v104, v15
    v_sub_f32 v105, v105, v15
    v_sub_f32 v106, v106, v15
    v_sub_f32 v107, v107, v15
    v_exp_f32 v92, v92
    v_exp_f32 v93, v93
    v_exp_f32 v94, v94
    v_exp_f32 v95, v95
    v_exp_f32 v96, v96
    v_exp_f32 v97, v97
    v_exp_f32 v98, v98
    v_exp_f32 v99, v99
    v_exp_f32 v100, v100
    v_exp_f32 v101, v101
    v_exp_f32 v102, v102
    v_exp_f32 v103, v103
    v_exp_f32 v104, v104
    v_exp_f32 v105, v105
    v_exp_f32 v106, v106
    v_exp_f32 v107, v107
    v_mul_f32 v180, v180, v16
    v_mul_f32 v181, v181, v16
    v_mul_f32 v182, v182, v16
    v_mul_f32 v183, v183, v16
    v_mul_f32 v184, v184, v16
    v_mul_f32 v185, v185, v16
    v_mul_f32 v186, v186, v16
    v_mul_f32 v187, v187, v16
    v_mul_f32 v188, v188, v16
    v_mul_f32 v189, v189, v16
    v_mul_f32 v190, v190, v16
    v_mul_f32 v191, v191, v16
    v_mul_f32 v192, v192, v16
    v_mul_f32 v193, v193, v16
    v_mul_f32 v194, v194, v16
    v_mul_f32 v195, v195, v16
    s_nop 1
    v_smfmac_f32_32x32x32_bf16 v[180:195], a[40:43], v[92:99], v18
    v_smfmac_f32_32x32x32_bf16 v[180:195], a[44:47], v[100:107], v18
    v_mfma_f32_32x32x16_bf16 v[108:123], a[8:11], v[52:55], v[108:123]
    s_nop 11
    v_max3_f32 v15, v108, v109, v125
    v_max3_f32 v15, v110, v111, v15
    v_max3_f32 v15, v112, v113, v15
    v_max3_f32 v15, v114, v115, v15
    v_max3_f32 v15, v116, v117, v15
    v_max3_f32 v15, v118, v119, v15
    v_max3_f32 v15, v120, v121, v15
    v_max3_f32 v15, v122, v123, v15
    v_mov_b32 v16, v15
    s_nop 1
    v_permlane32_swap_b32 v15, v16
    v_max_f32 v15, v15, v16
    v_sub_f32 v16, v125, v15
    v_exp_f32 v16, v16
    v_mov_b32 v125, v15
    v_sub_f32 v108, v108, v15
    v_sub_f32 v109, v109, v15
    v_sub_f32 v110, v110, v15
    v_sub_f32 v111, v111, v15
    v_sub_f32 v112, v112, v15
    v_sub_f32 v113, v113, v15
    v_sub_f32 v114, v114, v15
    v_sub_f32 v115, v115, v15
    v_sub_f32 v116, v116, v15
    v_sub_f32 v117, v117, v15
    v_sub_f32 v118, v118, v15
    v_sub_f32 v119, v119, v15
    v_sub_f32 v120, v120, v15
    v_sub_f32 v121, v121, v15
    v_sub_f32 v122, v122, v15
    v_sub_f32 v123, v123, v15
    v_exp_f32 v108, v108
    v_exp_f32 v109, v109
    v_exp_f32 v110, v110
    v_exp_f32 v111, v111
    v_exp_f32 v112, v112
    v_exp_f32 v113, v113
    v_exp_f32 v114, v114
    v_exp_f32 v115, v115
    v_exp_f32 v116, v116
    v_exp_f32 v117, v117
    v_exp_f32 v118, v118
    v_exp_f32 v119, v119
    v_exp_f32 v120, v120
    v_exp_f32 v121, v121
    v_exp_f32 v122, v122
    v_exp_f32 v123, v123
    v_mul_f32 v196, v196, v16
    v_mul_f32 v197, v197, v16
    v_mul_f32 v198, v198, v16
    v_mul_f32 v199, v199, v16
    v_mul_f32 v200, v200, v16
    v_mul_f32 v201, v201, v16
    v_mul_f32 v202, v202, v16
    v_mul_f32 v203, v203, v16
    v_mul_f32 v204, v204, v16
    v_mul_f32 v205, v205, v16
    v_mul_f32 v206, v206, v16
    v_mul_f32 v207, v207, v16
    v_mul_f32 v208, v208, v16
    v_mul_f32 v209, v209, v16
    v_mul_f32 v210, v210, v16
    v_mul_f32 v211, v211, v16
    s_nop 1
    v_smfmac_f32_32x32x32_bf16 v[196:211], a[40:43], v[108:115], v18
    v_smfmac_f32_32x32x32_bf16 v[196:211], a[44:47], v[116:123], v18
    v_mfma_f32_32x32x4_2b_bf16 v[92:123], a[74:75], v[58:59], 0 cbsz:1 abid:1
    s_nop 15
    s_nop 1
    v_mfma_f32_32x32x16_bf16 v[92:107], a[12:15], v[48:51], v[92:107]
    s_nop 11
    v_max3_f32 v15, v92, v93, v124
    v_max3_f32 v15, v94, v95, v15
    v_max3_f32 v15, v96, v97, v15
    v_max3_f32 v15, v98, v99, v15
    v_max3_f32 v15, v100, v101, v15
    v_max3_f32 v15, v102, v103, v15
    v_max3_f32 v15, v104, v105, v15
    v_max3_f32 v15, v106, v107, v15
    v_mov_b32 v16, v15
    s_nop 1
    v_permlane32_swap_b32 v15, v16
    v_max_f32 v15, v15, v16
    v_sub_f32 v16, v124, v15
    v_exp_f32 v16, v16
    v_mov_b32 v124, v15
    v_sub_f32 v92, v92, v15
    v_sub_f32 v93, v93, v15
    v_sub_f32 v94, v94, v15
    v_sub_f32 v95, v95, v15
    v_sub_f32 v96, v96, v15
    v_sub_f32 v97, v97, v15
    v_sub_f32 v98, v98, v15
    v_sub_f32 v99, v99, v15
    v_sub_f32 v100, v100, v15
    v_sub_f32 v101, v101, v15
    v_sub_f32 v102, v102, v15
    v_sub_f32 v103, v103, v15
    v_sub_f32 v104, v104, v15
    v_sub_f32 v105, v105, v15
    v_sub_f32 v106, v106, v15
    v_sub_f32 v107, v107, v15
    v_exp_f32 v92, v92
    v_exp_f32 v93, v93
    v_exp_f32 v94, v94
    v_exp_f32 v95, v95
    v_exp_f32 v96, v96
    v_exp_f32 v97, v97
    v_exp_f32 v98, v98
    v_exp_f32 v99, v99
    v_exp_f32 v100, v100
    v_exp_f32 v101, v101
    v_exp_f32 v102, v102
    v_exp_f32 v103, v103
    v_exp_f32 v104, v104
    v_exp_f32 v105, v105
    v_exp_f32 v106, v106
    v_exp_f32 v107, v107
    v_mul_f32 v180, v180, v16
    v_mul_f32 v181, v181, v16
    v_mul_f32 v182, v182, v16
    v_mul_f32 v183, v183, v16
    v_mul_f32 v184, v184, v16
    v_mul_f32 v185, v185, v16
    v_mul_f32 v186, v186, v16
    v_mul_f32 v187, v187, v16
    v_mul_f32 v188, v188, v16
    v_mul_f32 v189, v189, v16
    v_mul_f32 v190, v190, v16
    v_mul_f32 v191, v191, v16
    v_mul_f32 v192, v192, v16
    v_mul_f32 v193, v193, v16
    v_mul_f32 v194, v194, v16
    v_mul_f32 v195, v195, v16
    s_nop 1
    v_smfmac_f32_32x32x32_bf16 v[180:195], a[48:51], v[92:99], v18
    v_smfmac_f32_32x32x32_bf16 v[180:195], a[52:55], v[100:107], v18
    v_mfma_f32_32x32x16_bf16 v[108:123], a[12:15], v[52:55], v[108:123]
    s_nop 11
    v_max3_f32 v15, v108, v109, v125
    v_max3_f32 v15, v110, v111, v15
    v_max3_f32 v15, v112, v113, v15
    v_max3_f32 v15, v114, v115, v15
    v_max3_f32 v15, v116, v117, v15
    v_max3_f32 v15, v118, v119, v15
    v_max3_f32 v15, v120, v121, v15
    v_max3_f32 v15, v122, v123, v15
    v_mov_b32 v16, v15
    s_nop 1
    v_permlane32_swap_b32 v15, v16
    v_max_f32 v15, v15, v16
    v_sub_f32 v16, v125, v15
    v_exp_f32 v16, v16
    v_mov_b32 v125, v15
    v_sub_f32 v108, v108, v15
    v_sub_f32 v109, v109, v15
    v_sub_f32 v110, v110, v15
    v_sub_f32 v111, v111, v15
    v_sub_f32 v112, v112, v15
    v_sub_f32 v113, v113, v15
    v_sub_f32 v114, v114, v15
    v_sub_f32 v115, v115, v15
    v_sub_f32 v116, v116, v15
    v_sub_f32 v117, v117, v15
    v_sub_f32 v118, v118, v15
    v_sub_f32 v119, v119, v15
    v_sub_f32 v120, v120, v15
    v_sub_f32 v121, v121, v15
    v_sub_f32 v122, v122, v15
    v_sub_f32 v123, v123, v15
    v_exp_f32 v108, v108
    v_exp_f32 v109, v109
    v_exp_f32 v110, v110
    v_exp_f32 v111, v111
    v_exp_f32 v112, v112
    v_exp_f32 v113, v113
    v_exp_f32 v114, v114
    v_exp_f32 v115, v115
    v_exp_f32 v116, v116
    v_exp_f32 v117, v117
    v_exp_f32 v118, v118
    v_exp_f32 v119, v119
    v_exp_f32 v120, v120
    v_exp_f32 v121, v121
    v_exp_f32 v122, v122
    v_exp_f32 v123, v123
    v_mul_f32 v196, v196, v16
    v_mul_f32 v197, v197, v16
    v_mul_f32 v198, v198, v16
    v_mul_f32 v199, v199, v16
    v_mul_f32 v200, v200, v16
    v_mul_f32 v201, v201, v16
    v_mul_f32 v202, v202, v16
    v_mul_f32 v203, v203, v16
    v_mul_f32 v204, v204, v16
    v_mul_f32 v205, v205, v16
    v_mul_f32 v206, v206, v16
    v_mul_f32 v207, v207, v16
    v_mul_f32 v208, v208, v16
    v_mul_f32 v209, v209, v16
    v_mul_f32 v210, v210, v16
    v_mul_f32 v211, v211, v16
    s_nop 1
    v_smfmac_f32_32x32x32_bf16 v[196:211], a[48:51], v[108:115], v18
    v_smfmac_f32_32x32x32_bf16 v[196:211], a[52:55], v[116:123], v18
    s_add_u32 s52, s52, 1024
    s_add_u32 s53, s53, 2560
    s_cmp_lt_u32 s52, 32768
    s_cbranch_scc1 slow_loop_57
    s_mov_b32 s44, 40960
    s_nop 11
    v_mov_b32 v60, v188
    v_mov_b32 v61, v188
    s_nop 1
    v_permlane32_swap_b32 v61, v60
    v_rcp_f32 v61, v60
    s_nop 0
    v_pk_mul_f32 v[180:181], v[180:181], v[60:61] op_sel:[0,1] op_sel_hi:[1,1]
    v_pk_mul_f32 v[182:183], v[182:183], v[60:61] op_sel:[0,1] op_sel_hi:[1,1]
    v_pk_mul_f32 v[184:185], v[184:185], v[60:61] op_sel:[0,1] op_sel_hi:[1,1]
    v_pk_mul_f32 v[186:187], v[186:187], v[60:61] op_sel:[0,1] op_sel_hi:[1,1]
    v_pk_mul_f32 v[188:189], v[188:189], v[60:61] op_sel:[0,1] op_sel_hi:[1,1]
    v_pk_mul_f32 v[190:191], v[190:191], v[60:61] op_sel:[0,1] op_sel_hi:[1,1]
    v_cvt_pk_bf16_f32 v180, v180, v181
    v_cvt_pk_bf16_f32 v181, v182, v183
    v_cvt_pk_bf16_f32 v182, v184, v185
    v_cvt_pk_bf16_f32 v183, v186, v187
    v_cvt_pk_bf16_f32 v184, v188, v189
    v_cvt_pk_bf16_f32 v185, v190, v191
    buffer_store_dwordx4 v[180:183], v32, s[12:15], 0 offen sc1
    v_mov_b32 v62, v204
    v_mov_b32 v63, v204
    s_nop 1
    v_permlane32_swap_b32 v63, v62
    v_rcp_f32 v63, v62
    s_nop 0
    v_pk_mul_f32 v[196:197], v[196:197], v[62:63] op_sel:[0,1] op_sel_hi:[1,1]
    v_pk_mul_f32 v[198:199], v[198:199], v[62:63] op_sel:[0,1] op_sel_hi:[1,1]
    v_pk_mul_f32 v[200:201], v[200:201], v[62:63] op_sel:[0,1] op_sel_hi:[1,1]
    v_pk_mul_f32 v[202:203], v[202:203], v[62:63] op_sel:[0,1] op_sel_hi:[1,1]
    v_pk_mul_f32 v[204:205], v[204:205], v[62:63] op_sel:[0,1] op_sel_hi:[1,1]
    v_pk_mul_f32 v[206:207], v[206:207], v[62:63] op_sel:[0,1] op_sel_hi:[1,1]
    v_cvt_pk_bf16_f32 v196, v196, v197
    v_cvt_pk_bf16_f32 v197, v198, v199
    v_cvt_pk_bf16_f32 v198, v200, v201
    v_cvt_pk_bf16_f32 v199, v202, v203
    v_cvt_pk_bf16_f32 v200, v204, v205
    v_cvt_pk_bf16_f32 v201, v206, v207
    buffer_store_dwordx4 v[196:199], v32, s[12:15], s44 offen sc1
    s_branch sequential_preLN__mha_block__moe_arch_mod__prompt_kernel_norm
CODE_END:
.section .rodata,"a"
.p2align 6
.amdhsa_kernel sequential_preLN__mha_block__moe_arch_mod__prompt_kernel
  .amdhsa_next_free_vgpr 512
  .amdhsa_next_free_sgpr 102
  .amdhsa_accum_offset 256
  .amdhsa_group_segment_fixed_size 0
  .amdhsa_kernarg_size 88
  .amdhsa_user_sgpr_count 2
  .amdhsa_user_sgpr_kernarg_segment_ptr 1
  .amdhsa_system_sgpr_workgroup_id_x 1
.end_amdhsa_kernel
```
